```python
import torch

def _softmax(x, axis=-1):
    return torch.softmax(x, dim=axis)

def _gelu(x):
    return torch.nn.functional.gelu(x, approximate='tanh')

def _silu(x):
    return torch.nn.functional.silu(x)

def _sigmoid(x):
    return torch.sigmoid(x)

def _layernorm(x, axis=-1, eps=1e-05):
    m = x.mean(dim=axis, keepdim=True)
    v = x.var(dim=axis, keepdim=True, unbiased=False)
    return (x - m) / torch.sqrt(v + eps)

def _scatter_add(tgt, idx, src, axis=0):
    return tgt.clone().index_add_(axis, idx, src)

def _segment_sum(src, seg, n):
    out = torch.zeros((n,) + src.shape[1:], dtype=src.dtype)
    return out.index_add_(0, seg, src)

def _pad(x, pw):
    flat = tuple((v for pair in reversed(pw) for v in pair))
    return torch.nn.functional.pad(x, flat)
kernel_name = 'adaLN_cond__grouped_kv_mqa__glu_gated_reglu__prompt'

def setup_inputs():

    _w = lambda a: (lambda t: t.to(torch.bfloat16) if t.is_floating_point() else t)(torch.as_tensor(a))

    def _A_setup():
        B, S, D, H = (1, 2048, 512, 32)
        Dh = D // H
        return {'x': _w((lambda *s: torch.randn(*s, dtype=torch.bfloat16) * 0.05)(B, S, D)), 'wq': _w((lambda *s: torch.randn(*s, dtype=torch.bfloat16) * 0.1)(D, H * Dh)), 'wk': _w((lambda *s: torch.randn(*s, dtype=torch.bfloat16) * 0.1)(D, Dh)), 'wv': _w((lambda *s: torch.randn(*s, dtype=torch.bfloat16) * 0.1)(D, Dh)), 'wo': _w((lambda *s: torch.randn(*s, dtype=torch.bfloat16) * 0.1)(H * Dh, D))}
    _A_in = _A_setup()

    def _B_setup():
        B, S, D, F = (1, 2048, 512, 1792)
        return {'x': _w((lambda *s: torch.randn(*s, dtype=torch.bfloat16) * 0.05)(B, S, D)), 'W_gate': _w((lambda *s: torch.randn(*s, dtype=torch.bfloat16) * 1.6)(D, F) * (2.0 / D) ** 0.5), 'W_up': _w((lambda *s: torch.randn(*s, dtype=torch.bfloat16) * 1.6)(D, F) * (2.0 / D) ** 0.5), 'W_down': _w((lambda *s: torch.randn(*s, dtype=torch.bfloat16) * 1.6)(F, D) * (1.0 / F) ** 0.5)}
    _B_in = _B_setup()
    return {'A_x': _A_in['x'], 'A_wq': _A_in['wq'], 'A_wk': _A_in['wk'], 'A_wv': _A_in['wv'], 'A_wo': _A_in['wo'], 'B_x': _B_in['x'], 'B_W_gate': _B_in['W_gate'], 'B_W_up': _B_in['W_up'], 'B_W_down': _B_in['W_down'], 'c': _w((lambda *s: torch.randn(*s, dtype=torch.bfloat16) * 0.2)(1, 512) * 8.0), 'w_mod': _w((lambda *s: torch.randn(*s, dtype=torch.bfloat16) * 0.2)(512, 6 * 512) * 512 ** (-0.5) * 8.0)}

def reference(A_x, A_wq, A_wk, A_wv, A_wo, B_x, B_W_gate, B_W_up, B_W_down, c, w_mod):

    def _A_ref(x, wq, wk, wv, wo):
        B, S, D = x.shape
        H = 32
        Dh = D // H
        q = (lambda x, *d: x.permute(*d))((x @ wq).reshape(B, S, H, Dh), 0, 2, 1, 3)
        k = x @ wk
        v = x @ wv
        scores = torch.einsum('bhqd,bkd->bhqk', q, k) * Dh ** (-0.5)
        p = _softmax(scores, axis=-1)
        o = torch.einsum('bhqk,bkd->bhqd', p, v)
        return (lambda x, *d: x.permute(*d))(o, 0, 2, 1, 3).reshape(B, S, H * Dh) @ wo

    def _B_ref(x, W_gate, W_up, W_down):
        gate = torch.einsum('bsd,df->bsf', x, W_gate)
        up = torch.einsum('bsd,df->bsf', x, W_up)
        gate = gate * (lambda x, dt: x.to(dt))(gate > 0, gate.dtype)
        h = gate * up
        return torch.einsum('bsf,fd->bsd', h, W_down)
    x = A_x
    mod = (_silu(c) @ w_mod).reshape(c.shape[0], 6, 1, -1)
    sa, ca, ga, sb, cb, gb = (mod[:, 0].clone(), mod[:, 1].clone(), mod[:, 2].clone(), mod[:, 3].clone(), mod[:, 4].clone(), mod[:, 5].clone())
    h = _layernorm(x, axis=-1) * (1 + ca) + sa
    x = x + ga * _A_ref(h, A_wq, A_wk, A_wv, A_wo)
    h = _layernorm(x, axis=-1) * (1 + cb) + sb
    x = x + gb * _B_ref(h, B_W_gate, B_W_up, B_W_down)
    return x
```

```asm
; @launch kernel=mod_kernel grid=(129,1,1) block=(512,1,1) lds=34816
; @launch kernel=qkv_kernel grid=(256,1,1) block=(768,1,1) lds=66048
; @launch kernel=attn_kernel grid=(256,1,1) block=(512,1,1) lds=163840
; @launch kernel=ffn1_kernel grid=(256,1,1) block=(512,1,1) lds=159488
; @launch kernel=ffn2_kernel grid=(256,1,1) block=(256,1,1) lds=65536
.amdgcn_target "amdgcn-amd-amdhsa--gfx950"
.text
.globl mod_kernel
.p2align 8
.type mod_kernel,@function
mod_kernel:
    s_load_dwordx16 s[16:31], s[0:1], 0
    s_load_dwordx8 s[32:39], s[0:1], 64
    s_load_dwordx4 s[40:43], s[0:1], 96
    s_cmp_ge_u32 s2, 129
    s_cbranch_scc1 KA_END
    v_and_b32 v1, 63, v0
    v_lshrrev_b32 v2, 6, v0
    s_nop 0
    v_readfirstlane_b32 s3, v2
    s_waitcnt lgkmcnt(0)
    s_mov_b32 s4, s2
    s_cmp_lt_u32 s2, 96
    s_cbranch_scc1 KA_MODA
    s_sub_u32 s4, s2, 96
    s_cmp_lt_u32 s4, 16
    s_cbranch_scc1 KA_PWO
    s_sub_u32 s4, s4, 16
    s_branch KA_PQKV
KA_MODA:
    s_lshr_b32 s5, s2, 3
    s_lshl_b32 s5, s5, 3
    s_add_u32 s5, s5, s3
    s_cmp_lt_u32 s5, 64
    s_cbranch_scc0 KA_NOXPF
    s_and_b32 s6, s2, 7
    s_lshl_b32 s6, s6, 18
    s_lshl_b32 s5, s5, 12
    s_add_u32 s5, s5, s6
    s_add_u32 s6, s16, s5
    s_addc_u32 s7, s17, 0
    v_lshlrev_b32 v3, 6, v1
    global_load_dword v60, v3, s[6:7]
KA_NOXPF:
    v_and_b32 v3, 3, v0
    v_lshrrev_b32 v4, 2, v0
    v_lshlrev_b32 v6, 1, v4
    s_mov_b32 s7, 6144
    v_mul_lo_u32 v7, v4, s7
    s_lshl_b32 s8, s4, 6
    v_lshlrev_b32 v8, 4, v3
    v_add3_u32 v7, v7, v8, s8
    s_mov_b32 s10, s36
    s_mov_b32 s11, s37
    global_load_dwordx4 v[16:19], v7, s[10:11]
    s_add_u32 s10, s10, 786432
    s_addc_u32 s11, s11, 0
    global_load_dwordx4 v[20:23], v7, s[10:11]
    s_add_u32 s10, s10, 786432
    s_addc_u32 s11, s11, 0
    global_load_dwordx4 v[24:27], v7, s[10:11]
    s_add_u32 s10, s10, 786432
    s_addc_u32 s11, s11, 0
    global_load_dwordx4 v[28:31], v7, s[10:11]
    global_load_ushort v10, v6, s[34:35] offset:0
    global_load_ushort v11, v6, s[34:35] offset:256
    global_load_ushort v12, v6, s[34:35] offset:512
    global_load_ushort v13, v6, s[34:35] offset:768
    s_waitcnt vmcnt(0)
    v_lshlrev_b32 v10, 16, v10
    v_lshlrev_b32 v11, 16, v11
    v_lshlrev_b32 v12, 16, v12
    v_lshlrev_b32 v13, 16, v13
    v_mul_f32 v32, 0xbfb8aa3b, v10
    v_mul_f32 v33, 0xbfb8aa3b, v11
    v_mul_f32 v34, 0xbfb8aa3b, v12
    v_mul_f32 v35, 0xbfb8aa3b, v13
    v_exp_f32 v32, v32
    v_exp_f32 v33, v33
    v_exp_f32 v34, v34
    v_exp_f32 v35, v35
    s_nop 0
    v_add_f32 v32, 1.0, v32
    v_add_f32 v33, 1.0, v33
    v_add_f32 v34, 1.0, v34
    v_add_f32 v35, 1.0, v35
    v_rcp_f32 v32, v32
    v_rcp_f32 v33, v33
    v_rcp_f32 v34, v34
    v_rcp_f32 v35, v35
    s_nop 0
    v_mul_f32 v10, v10, v32
    v_mul_f32 v11, v11, v33
    v_mul_f32 v12, v12, v34
    v_mul_f32 v13, v13, v35
    v_cvt_pk_bf16_f32 v10, v10, v10
    v_lshlrev_b32 v10, 16, v10
    v_cvt_pk_bf16_f32 v11, v11, v11
    v_lshlrev_b32 v11, 16, v11
    v_cvt_pk_bf16_f32 v12, v12, v12
    v_lshlrev_b32 v12, 16, v12
    v_cvt_pk_bf16_f32 v13, v13, v13
    v_lshlrev_b32 v13, 16, v13
    v_mov_b32 v40, 0
    v_mov_b32 v41, 0
    v_mov_b32 v42, 0
    v_mov_b32 v43, 0
    v_mov_b32 v44, 0
    v_mov_b32 v45, 0
    v_mov_b32 v46, 0
    v_mov_b32 v47, 0
    v_lshlrev_b32 v48, 16, v16
    v_and_b32 v49, 0xffff0000, v16
    v_lshlrev_b32 v50, 16, v17
    v_and_b32 v51, 0xffff0000, v17
    v_lshlrev_b32 v52, 16, v18
    v_and_b32 v53, 0xffff0000, v18
    v_lshlrev_b32 v54, 16, v19
    v_and_b32 v55, 0xffff0000, v19
    v_fmac_f32 v40, v10, v48
    v_fmac_f32 v41, v10, v49
    v_fmac_f32 v42, v10, v50
    v_fmac_f32 v43, v10, v51
    v_fmac_f32 v44, v10, v52
    v_fmac_f32 v45, v10, v53
    v_fmac_f32 v46, v10, v54
    v_fmac_f32 v47, v10, v55
    v_lshlrev_b32 v48, 16, v20
    v_and_b32 v49, 0xffff0000, v20
    v_lshlrev_b32 v50, 16, v21
    v_and_b32 v51, 0xffff0000, v21
    v_lshlrev_b32 v52, 16, v22
    v_and_b32 v53, 0xffff0000, v22
    v_lshlrev_b32 v54, 16, v23
    v_and_b32 v55, 0xffff0000, v23
    v_fmac_f32 v40, v11, v48
    v_fmac_f32 v41, v11, v49
    v_fmac_f32 v42, v11, v50
    v_fmac_f32 v43, v11, v51
    v_fmac_f32 v44, v11, v52
    v_fmac_f32 v45, v11, v53
    v_fmac_f32 v46, v11, v54
    v_fmac_f32 v47, v11, v55
    v_lshlrev_b32 v48, 16, v24
    v_and_b32 v49, 0xffff0000, v24
    v_lshlrev_b32 v50, 16, v25
    v_and_b32 v51, 0xffff0000, v25
    v_lshlrev_b32 v52, 16, v26
    v_and_b32 v53, 0xffff0000, v26
    v_lshlrev_b32 v54, 16, v27
    v_and_b32 v55, 0xffff0000, v27
    v_fmac_f32 v40, v12, v48
    v_fmac_f32 v41, v12, v49
    v_fmac_f32 v42, v12, v50
    v_fmac_f32 v43, v12, v51
    v_fmac_f32 v44, v12, v52
    v_fmac_f32 v45, v12, v53
    v_fmac_f32 v46, v12, v54
    v_fmac_f32 v47, v12, v55
    v_lshlrev_b32 v48, 16, v28
    v_and_b32 v49, 0xffff0000, v28
    v_lshlrev_b32 v50, 16, v29
    v_and_b32 v51, 0xffff0000, v29
    v_lshlrev_b32 v52, 16, v30
    v_and_b32 v53, 0xffff0000, v30
    v_lshlrev_b32 v54, 16, v31
    v_and_b32 v55, 0xffff0000, v31
    v_fmac_f32 v40, v13, v48
    v_fmac_f32 v41, v13, v49
    v_fmac_f32 v42, v13, v50
    v_fmac_f32 v43, v13, v51
    v_fmac_f32 v44, v13, v52
    v_fmac_f32 v45, v13, v53
    v_fmac_f32 v46, v13, v54
    v_fmac_f32 v47, v13, v55
    v_lshlrev_b32 v9, 5, v0
    ds_write_b128 v9, v[40:43]
    ds_write_b128 v9, v[44:47] offset:16
    s_waitcnt lgkmcnt(0)
    s_barrier
    v_and_b32 v3, 31, v0
    v_lshrrev_b32 v4, 5, v0
    v_lshrrev_b32 v5, 3, v3
    v_and_b32 v6, 7, v3
    v_lshlrev_b32 v7, 10, v4
    v_lshl_add_u32 v7, v5, 5, v7
    v_lshl_add_u32 v7, v6, 2, v7
    ds_read_b32 v16, v7 offset:0
    ds_read_b32 v17, v7 offset:128
    ds_read_b32 v18, v7 offset:256
    ds_read_b32 v19, v7 offset:384
    ds_read_b32 v20, v7 offset:512
    ds_read_b32 v21, v7 offset:640
    ds_read_b32 v22, v7 offset:768
    ds_read_b32 v23, v7 offset:896
    s_waitcnt lgkmcnt(0)
    v_add_f32 v16, v16, v20
    v_add_f32 v17, v17, v21
    v_add_f32 v18, v18, v22
    v_add_f32 v19, v19, v23
    v_add_f32 v16, v16, v18
    v_add_f32 v17, v17, v19
    v_add_f32 v16, v16, v17
    v_lshlrev_b32 v8, 2, v0
    ds_write_b32 v8, v16 offset:16384
    s_waitcnt lgkmcnt(0)
    s_barrier
    s_cmp_lg_u32 s3, 0
    s_cbranch_scc1 KA_END
    v_lshlrev_b32 v8, 2, v3
    ds_read_b32 v16, v8 offset:16384
    ds_read_b32 v17, v8 offset:16512
    ds_read_b32 v18, v8 offset:16640
    ds_read_b32 v19, v8 offset:16768
    ds_read_b32 v20, v8 offset:16896
    ds_read_b32 v21, v8 offset:17024
    ds_read_b32 v22, v8 offset:17152
    ds_read_b32 v23, v8 offset:17280
    ds_read_b32 v24, v8 offset:17408
    ds_read_b32 v25, v8 offset:17536
    ds_read_b32 v26, v8 offset:17664
    ds_read_b32 v27, v8 offset:17792
    ds_read_b32 v28, v8 offset:17920
    ds_read_b32 v29, v8 offset:18048
    ds_read_b32 v30, v8 offset:18176
    ds_read_b32 v31, v8 offset:18304
    s_waitcnt lgkmcnt(0)
    v_add_f32 v16, v16, v24
    v_add_f32 v17, v17, v25
    v_add_f32 v18, v18, v26
    v_add_f32 v19, v19, v27
    v_add_f32 v20, v20, v28
    v_add_f32 v21, v21, v29
    v_add_f32 v22, v22, v30
    v_add_f32 v23, v23, v31
    v_add_f32 v16, v16, v20
    v_add_f32 v17, v17, v21
    v_add_f32 v18, v18, v22
    v_add_f32 v19, v19, v23
    v_add_f32 v16, v16, v18
    v_add_f32 v17, v17, v19
    v_add_f32 v16, v16, v17
    v_cvt_pk_bf16_f32 v16, v16, v16
    v_lshlrev_b32 v16, 16, v16
    s_lshr_b32 s5, s4, 4
    s_cmp_eq_u32 s5, 1
    s_cselect_b32 s6, 1, 0
    s_cmp_eq_u32 s5, 4
    s_cselect_b32 s7, 1, 0
    s_or_b32 s6, s6, s7
    s_cmp_eq_u32 s6, 0
    s_cbranch_scc1 KA_MOD2
    v_add_f32 v16, 1.0, v16
    v_cvt_pk_bf16_f32 v16, v16, v16
    v_lshlrev_b32 v16, 16, v16
KA_MOD2:
    s_lshl_b32 s5, s4, 7
    v_add_u32 v8, s5, v8
    s_add_u32 s10, s42, 49152
    s_addc_u32 s11, s43, 0
    v_cmp_gt_u32 vcc, 32, v1
    s_and_saveexec_b64 s[12:13], vcc
    global_store_dword v8, v16, s[10:11]
    s_endpgm
KA_PWD:
    s_mul_i32 s5, s4, 9363
    s_lshr_b32 s5, s5, 16
    s_mul_i32 s6, s5, 7
    s_sub_u32 s6, s4, s6
    s_lshl_b32 s6, s6, 4
    s_lshl_b32 s7, s3, 1
    s_add_u32 s6, s6, s7
    v_lshrrev_b32 v3, 2, v1
    v_and_b32 v4, 3, v1
    s_lshl_b32 s7, s6, 4
    v_add_u32 v3, s7, v3
    v_lshlrev_b32 v3, 10, v3
    v_lshl_add_u32 v3, v4, 4, v3
    s_lshl_b32 s7, s5, 7
    v_add_u32 v3, s7, v3
    s_add_u32 s8, s32, 16384
    s_addc_u32 s9, s33, 0
    global_load_dwordx4 v[16:19], v3, s[32:33]
    global_load_dwordx4 v[20:23], v3, s[32:33] offset:64
    global_load_dwordx4 v[24:27], v3, s[8:9]
    global_load_dwordx4 v[28:31], v3, s[8:9] offset:64
    s_lshl_b32 s9, s3, 12
    v_lshlrev_b32 v15, 4, v1
    v_add_u32 v10, s9, v15
    v_lshrrev_b32 v11, 5, v1
    v_bfe_u32 v12, v1, 2, 2
    v_bfe_u32 v13, v1, 4, 1
    v_and_b32 v14, 3, v1
    v_lshlrev_b32 v11, 2, v11
    v_add_u32 v11, v11, v12
    v_lshlrev_b32 v11, 6, v11
    v_lshl_add_u32 v11, v13, 5, v11
    v_lshl_add_u32 v11, v14, 3, v11
    v_add_u32 v11, s9, v11
    s_mul_i32 s7, s5, 224
    s_add_u32 s7, s7, s6
    s_lshl_b32 s7, s7, 10
    s_add_u32 s7, s7, 6946816
    s_add_u32 s50, s42, s7
    s_addc_u32 s51, s43, 0
    s_add_u32 s52, s50, 114688
    s_addc_u32 s53, s51, 0
    s_waitcnt vmcnt(3)
    ds_write_b128 v10, v[16:19] offset:0
    s_waitcnt vmcnt(2)
    ds_write_b128 v10, v[20:23] offset:1024
    s_waitcnt vmcnt(1)
    ds_write_b128 v10, v[24:27] offset:2048
    s_waitcnt vmcnt(0)
    ds_write_b128 v10, v[28:31] offset:3072
    s_waitcnt lgkmcnt(0)
    ds_read_b64_tr_b16 v[32:33], v11 offset:0
    ds_read_b64_tr_b16 v[34:35], v11 offset:512
    ds_read_b64_tr_b16 v[36:37], v11 offset:1024
    ds_read_b64_tr_b16 v[38:39], v11 offset:1536
    ds_read_b64_tr_b16 v[40:41], v11 offset:2048
    ds_read_b64_tr_b16 v[42:43], v11 offset:2560
    ds_read_b64_tr_b16 v[44:45], v11 offset:3072
    ds_read_b64_tr_b16 v[46:47], v11 offset:3584
    s_waitcnt lgkmcnt(6)
    global_store_dwordx4 v15, v[32:35], s[50:51] offset:0
    s_waitcnt lgkmcnt(4)
    global_store_dwordx4 v15, v[36:39], s[52:53] offset:0
    s_waitcnt lgkmcnt(2)
    global_store_dwordx4 v15, v[40:43], s[50:51] offset:1024
    s_waitcnt lgkmcnt(0)
    global_store_dwordx4 v15, v[44:47], s[52:53] offset:1024
    s_endpgm
KA_PWO:
    s_lshr_b32 s5, s3, 2
    s_lshl_b32 s6, s4, 1
    s_add_u32 s5, s5, s6
    s_and_b32 s6, s3, 3
    s_lshl_b32 s6, s6, 2
    v_lshrrev_b32 v3, 1, v1
    s_lshl_b32 s7, s6, 5
    v_add_u32 v3, s7, v3
    v_lshlrev_b32 v3, 10, v3
    v_and_b32 v4, 1, v1
    v_lshl_add_u32 v3, v4, 4, v3
    s_lshl_b32 s7, s5, 5
    v_add_u32 v3, s7, v3
    s_mov_b32 s8, s24
    s_mov_b32 s9, s25
    global_load_dwordx4 v[16:19], v3, s[8:9]
    s_add_u32 s8, s8, 32768
    s_addc_u32 s9, s9, 0
    global_load_dwordx4 v[20:23], v3, s[8:9]
    s_add_u32 s8, s8, 32768
    s_addc_u32 s9, s9, 0
    global_load_dwordx4 v[24:27], v3, s[8:9]
    s_add_u32 s8, s8, 32768
    s_addc_u32 s9, s9, 0
    global_load_dwordx4 v[28:31], v3, s[8:9]
    s_lshl_b32 s6, s3, 12
    v_lshlrev_b32 v10, 4, v1
    v_add_u32 v10, s6, v10
    v_lshrrev_b32 v11, 4, v1
    v_bfe_u32 v12, v1, 2, 2
    v_and_b32 v14, 3, v1
    v_lshlrev_b32 v11, 3, v11
    v_add_u32 v11, v11, v12
    v_lshlrev_b32 v11, 5, v11
    v_lshl_add_u32 v11, v14, 3, v11
    v_add_u32 v11, s6, v11
    s_lshl_b32 s7, s5, 4
    s_and_b32 s8, s3, 3
    s_lshl_b32 s8, s8, 2
    s_add_u32 s7, s7, s8
    s_lshl_b32 s7, s7, 10
    s_add_u32 s7, s7, 2752512
    s_add_u32 s50, s42, s7
    s_addc_u32 s51, s43, 0
    s_waitcnt vmcnt(3)
    ds_write_b128 v10, v[16:19] offset:0
    s_waitcnt vmcnt(2)
    ds_write_b128 v10, v[20:23] offset:1024
    s_waitcnt vmcnt(1)
    ds_write_b128 v10, v[24:27] offset:2048
    s_waitcnt vmcnt(0)
    ds_write_b128 v10, v[28:31] offset:3072
    s_waitcnt lgkmcnt(0)
    ds_read_b64_tr_b16 v[32:33], v11 offset:0
    ds_read_b64_tr_b16 v[34:35], v11 offset:128
    ds_read_b64_tr_b16 v[36:37], v11 offset:1024
    ds_read_b64_tr_b16 v[38:39], v11 offset:1152
    ds_read_b64_tr_b16 v[40:41], v11 offset:2048
    ds_read_b64_tr_b16 v[42:43], v11 offset:2176
    ds_read_b64_tr_b16 v[44:45], v11 offset:3072
    ds_read_b64_tr_b16 v[46:47], v11 offset:3200
    v_lshlrev_b32 v15, 4, v1
    s_waitcnt lgkmcnt(6)
    global_store_dwordx4 v15, v[32:35], s[50:51] offset:0
    s_waitcnt lgkmcnt(4)
    global_store_dwordx4 v15, v[36:39], s[50:51] offset:1024
    s_waitcnt lgkmcnt(2)
    global_store_dwordx4 v15, v[40:43], s[50:51] offset:2048
    s_waitcnt lgkmcnt(0)
    global_store_dwordx4 v15, v[44:47], s[50:51] offset:3072
    s_endpgm
KA_PQKV:
    s_lshl_b32 s7, s4, 6
    s_add_u32 s44, s18, s7
    s_addc_u32 s45, s19, 0
    s_add_u32 s46, s44, 32
    s_addc_u32 s47, s45, 0
    s_mov_b32 s48, 1024
    s_cmp_lt_u32 s4, 16
    s_cbranch_scc1 KA_PQKV2
    s_mov_b32 s44, s20
    s_mov_b32 s45, s21
    s_mov_b32 s46, s22
    s_mov_b32 s47, s23
    s_mov_b32 s48, 32
KA_PQKV2:
    s_lshl_b32 s49, s3, 2
    s_lshl_b32 s7, s4, 5
    s_add_u32 s7, s7, s49
    s_lshl_b32 s7, s7, 10
    s_add_u32 s7, s7, 2162688
    s_add_u32 s50, s42, s7
    s_addc_u32 s51, s43, 0
    s_mov_b32 s52, 1024
    s_mov_b32 s53, 0
    s_branch KA_PGO
KA_PGU:
    s_lshr_b32 s5, s4, 2
    s_and_b32 s6, s4, 3
    s_lshl_b32 s6, s6, 3
    s_add_u32 s6, s6, s3
    v_lshrrev_b32 v3, 2, v1
    v_and_b32 v4, 3, v1
    s_lshl_b32 s7, s6, 4
    v_add_u32 v3, s7, v3
    s_movk_i32 s7, 3584
    v_mul_lo_u32 v3, v3, s7
    v_and_b32 v5, 1, v4
    v_lshl_add_u32 v3, v5, 4, v3
    s_mul_i32 s7, s5, 224
    v_add_u32 v3, s7, v3
    v_cmp_lt_u32 vcc, 1, v4
    v_mov_b32 v6, s28
    v_mov_b32 v7, s29
    v_mov_b32 v8, s30
    v_mov_b32 v9, s31
    v_cndmask_b32 v6, v6, v8, vcc
    v_cndmask_b32 v7, v7, v9, vcc
    v_add_co_u32 v6, vcc, v6, v3
    s_nop 1
    v_addc_co_u32 v7, vcc, 0, v7, vcc
    global_load_dwordx4 v[16:19], v[6:7], off offset:0
    global_load_dwordx4 v[20:23], v[6:7], off offset:32
    global_load_dwordx4 v[24:27], v[6:7], off offset:64
    global_load_dwordx4 v[28:31], v[6:7], off offset:96
    global_load_dwordx4 v[32:35], v[6:7], off offset:128
    global_load_dwordx4 v[36:39], v[6:7], off offset:160
    global_load_dwordx4 v[40:43], v[6:7], off offset:192
    s_lshl_b32 s9, s3, 12
    v_lshlrev_b32 v15, 4, v1
    v_add_u32 v10, s9, v15
    v_lshrrev_b32 v11, 5, v1
    v_bfe_u32 v12, v1, 2, 2
    v_bfe_u32 v13, v1, 4, 1
    v_and_b32 v14, 3, v1
    v_lshlrev_b32 v11, 3, v11
    v_add_u32 v11, v11, v12
    v_lshlrev_b32 v11, 6, v11
    v_lshl_add_u32 v11, v13, 5, v11
    v_lshl_add_u32 v11, v14, 3, v11
    v_add_u32 v11, s9, v11
    s_lshl_b32 s7, s5, 5
    s_add_u32 s7, s7, s6
    s_mul_i32 s7, s7, 7168
    s_add_u32 s7, s7, 3276800
    s_add_u32 s50, s42, s7
    s_addc_u32 s51, s43, 0
    s_waitcnt vmcnt(6)
    ds_write_b128 v10, v[16:19] offset:0
    s_waitcnt vmcnt(5)
    ds_write_b128 v10, v[20:23] offset:1024
    s_waitcnt vmcnt(4)
    ds_write_b128 v10, v[24:27] offset:2048
    s_waitcnt vmcnt(3)
    ds_write_b128 v10, v[28:31] offset:3072
    s_waitcnt lgkmcnt(0)
    ds_read_b64_tr_b16 v[48:49], v11 offset:0
    ds_read_b64_tr_b16 v[50:51], v11 offset:256
    ds_read_b64_tr_b16 v[52:53], v11 offset:1024
    ds_read_b64_tr_b16 v[54:55], v11 offset:1280
    ds_read_b64_tr_b16 v[56:57], v11 offset:2048
    ds_read_b64_tr_b16 v[58:59], v11 offset:2304
    ds_read_b64_tr_b16 v[60:61], v11 offset:3072
    ds_read_b64_tr_b16 v[62:63], v11 offset:3328
    s_waitcnt lgkmcnt(0)
    global_store_dwordx4 v15, v[48:51], s[50:51] offset:0
    global_store_dwordx4 v15, v[52:55], s[50:51] offset:1024
    global_store_dwordx4 v15, v[56:59], s[50:51] offset:2048
    global_store_dwordx4 v15, v[60:63], s[50:51] offset:3072
    s_waitcnt vmcnt(6)
    ds_write_b128 v10, v[32:35] offset:0
    s_waitcnt vmcnt(5)
    ds_write_b128 v10, v[36:39] offset:1024
    s_waitcnt vmcnt(4)
    ds_write_b128 v10, v[40:43] offset:2048
    s_waitcnt lgkmcnt(0)
    ds_read_b64_tr_b16 v[64:65], v11 offset:0
    ds_read_b64_tr_b16 v[66:67], v11 offset:256
    ds_read_b64_tr_b16 v[68:69], v11 offset:1024
    ds_read_b64_tr_b16 v[70:71], v11 offset:1280
    ds_read_b64_tr_b16 v[72:73], v11 offset:2048
    ds_read_b64_tr_b16 v[74:75], v11 offset:2304
    s_waitcnt lgkmcnt(0)
    s_add_u32 s50, s50, 4096
    s_addc_u32 s51, s51, 0
    global_store_dwordx4 v15, v[64:67], s[50:51] offset:0
    global_store_dwordx4 v15, v[68:71], s[50:51] offset:1024
    global_store_dwordx4 v15, v[72:75], s[50:51] offset:2048
    s_endpgm
KA_PGO:
    v_lshrrev_b32 v3, 2, v1
    v_and_b32 v4, 3, v1
    s_lshl_b32 s5, s49, 4
    v_add_u32 v3, s5, v3
    v_mul_lo_u32 v3, v3, s48
    v_and_b32 v5, 1, v4
    v_lshl_add_u32 v3, v5, 4, v3
    v_cmp_lt_u32 vcc, 1, v4
    v_mov_b32 v6, s44
    v_mov_b32 v7, s45
    v_mov_b32 v8, s46
    v_mov_b32 v9, s47
    v_cndmask_b32 v6, v6, v8, vcc
    v_cndmask_b32 v7, v7, v9, vcc
    v_add_co_u32 v6, vcc, v6, v3
    s_nop 1
    v_addc_co_u32 v7, vcc, 0, v7, vcc
    s_lshl_b32 s5, s48, 4
    global_load_dwordx4 v[16:19], v[6:7], off
    v_add_co_u32 v6, vcc, s5, v6
    s_nop 1
    v_addc_co_u32 v7, vcc, 0, v7, vcc
    global_load_dwordx4 v[20:23], v[6:7], off
    v_add_co_u32 v6, vcc, s5, v6
    s_nop 1
    v_addc_co_u32 v7, vcc, 0, v7, vcc
    global_load_dwordx4 v[24:27], v[6:7], off
    v_add_co_u32 v6, vcc, s5, v6
    s_nop 1
    v_addc_co_u32 v7, vcc, 0, v7, vcc
    global_load_dwordx4 v[28:31], v[6:7], off
    s_lshl_b32 s6, s3, 12
    v_lshlrev_b32 v10, 4, v1
    v_add_u32 v10, s6, v10
    v_lshrrev_b32 v11, 5, v1
    v_bfe_u32 v12, v1, 2, 2
    v_bfe_u32 v13, v1, 4, 1
    v_and_b32 v14, 3, v1
    s_cmp_eq_u32 s53, 0
    s_cselect_b32 s7, 3, 2
    s_cselect_b32 s8, 1, 2
    s_lshl_b32 s8, s8, 8
    v_lshlrev_b32 v11, s7, v11
    v_add_u32 v11, v11, v12
    v_lshlrev_b32 v11, 6, v11
    v_lshl_add_u32 v11, v13, 5, v11
    v_lshl_add_u32 v11, v14, 3, v11
    v_add_u32 v11, s6, v11
    v_add_u32 v12, s8, v11
    s_waitcnt vmcnt(3)
    ds_write_b128 v10, v[16:19] offset:0
    s_waitcnt vmcnt(2)
    ds_write_b128 v10, v[20:23] offset:1024
    s_waitcnt vmcnt(1)
    ds_write_b128 v10, v[24:27] offset:2048
    s_waitcnt vmcnt(0)
    ds_write_b128 v10, v[28:31] offset:3072
    s_waitcnt lgkmcnt(0)
    ds_read_b64_tr_b16 v[32:33], v11 offset:0
    ds_read_b64_tr_b16 v[34:35], v12 offset:0
    ds_read_b64_tr_b16 v[36:37], v11 offset:1024
    ds_read_b64_tr_b16 v[38:39], v12 offset:1024
    ds_read_b64_tr_b16 v[40:41], v11 offset:2048
    ds_read_b64_tr_b16 v[42:43], v12 offset:2048
    ds_read_b64_tr_b16 v[44:45], v11 offset:3072
    ds_read_b64_tr_b16 v[46:47], v12 offset:3072
    v_lshlrev_b32 v15, 4, v1
    s_waitcnt lgkmcnt(6)
    global_store_dwordx4 v15, v[32:35], s[50:51]
    s_add_u32 s50, s50, s52
    s_addc_u32 s51, s51, 0
    s_waitcnt lgkmcnt(4)
    global_store_dwordx4 v15, v[36:39], s[50:51]
    s_add_u32 s50, s50, s52
    s_addc_u32 s51, s51, 0
    s_waitcnt lgkmcnt(2)
    global_store_dwordx4 v15, v[40:43], s[50:51]
    s_add_u32 s50, s50, s52
    s_addc_u32 s51, s51, 0
    s_waitcnt lgkmcnt(0)
    global_store_dwordx4 v15, v[44:47], s[50:51]
KA_END:
    s_endpgm
.globl qkv_kernel
.p2align 8
.type qkv_kernel,@function
qkv_kernel:
    s_load_dwordx16 s[16:31], s[0:1], 0
    s_load_dwordx8 s[32:39], s[0:1], 64
    s_load_dwordx4 s[40:43], s[0:1], 96
    s_cmp_ge_u32 s2, 256
    s_cbranch_scc1 KB_END
    v_and_b32 v1, 63, v0
    v_lshrrev_b32 v2, 6, v0
    s_nop 0
    v_readfirstlane_b32 s3, v2
    s_waitcnt lgkmcnt(0)
    s_branch KB_MAIN
KB_MAIN:
    s_mov_b32 s4, s2
    s_and_b32 s5, s4, 7
    s_lshl_b32 s5, s5, 3
    s_lshr_b32 s6, s4, 3
    s_and_b32 s7, s6, 7
    s_add_u32 s5, s5, s7
    s_lshr_b32 s6, s6, 3
    s_and_b32 s7, s3, 3
    s_lshr_b32 s8, s3, 2
    v_lshlrev_b32 v4, 4, v1
    s_mov_b32 s86, s7
    s_mov_b32 s87, s6
    s_cmp_lt_u32 s3, 8
    s_cbranch_scc1 KB_QW
    s_and_b32 s7, s3, 1
    s_lshr_b32 s8, s3, 1
    s_and_b32 s8, s8, 1
    s_add_u32 s86, s7, 4
    s_mov_b32 s6, 4
    s_cmp_eq_u32 s87, 0
    s_cselect_b32 s9, 1, 0
    s_branch KB_WSEL
KB_QW:
    s_lshr_b32 s9, s4, 3
    s_cmp_lt_u32 s9, 32
    s_cbranch_scc0 KB_NOPF
    s_cmp_lt_u32 s3, 4
    s_cbranch_scc0 KB_NOPF
    s_lshl_b32 s9, s9, 14
    s_lshl_b32 s10, s3, 12
    s_add_u32 s9, s9, s10
    s_add_u32 s9, s9, 2162688
    s_add_u32 s10, s42, s9
    s_addc_u32 s11, s43, 0
    v_lshlrev_b32 v5, 6, v1
    global_load_dword v15, v5, s[10:11]
KB_NOPF:
    s_lshl_b32 s9, s5, 5
    s_lshl_b32 s10, s3, 2
    s_add_u32 s9, s9, s10
    s_lshl_b32 s9, s9, 10
    s_add_u32 s10, s16, s9
    s_addc_u32 s11, s17, 0
    global_load_dwordx4 v[32:35], v4, s[10:11] offset:0
    global_load_dwordx4 v[36:39], v4, s[10:11] offset:1024
    global_load_dwordx4 v[40:43], v4, s[10:11] offset:2048
    global_load_dwordx4 v[44:47], v4, s[10:11] offset:3072
    v_lshlrev_b32 v8, 5, v1
    s_add_u32 s10, s42, 49152
    s_addc_u32 s11, s43, 0
    global_load_dwordx4 v[16:19], v8, s[10:11]
    global_load_dwordx4 v[20:23], v8, s[10:11] offset:16
    global_load_dwordx4 v[24:27], v8, s[10:11] offset:2048
    global_load_dwordx4 v[28:31], v8, s[10:11] offset:2064
    s_mov_b32 s9, 1
KB_WSEL:
    s_cmp_eq_u32 s9, 0
    s_cbranch_scc1 KB_NOW
    s_lshl_b32 s10, s6, 2
    s_add_u32 s10, s10, s7
    s_cmp_lt_u32 s6, 4
    s_cselect_b32 s10, s10, 16
    s_lshl_b32 s10, s10, 5
    s_lshl_b32 s11, s8, 4
    s_add_u32 s10, s10, s11
    s_lshl_b32 s10, s10, 10
    s_add_u32 s10, s10, 2162688
    s_add_u32 s10, s42, s10
    s_addc_u32 s11, s43, 0
    s_mov_b32 s88, s10
    s_mov_b32 s89, s11
    s_cmp_ge_u32 s3, 8
    s_cbranch_scc0 KB_LN0
    global_load_dwordx4 v[64:67], v4, s[88:89] offset:0
    global_load_dwordx4 v[68:71], v4, s[88:89] offset:1024
    global_load_dwordx4 v[72:75], v4, s[88:89] offset:2048
    global_load_dwordx4 v[76:79], v4, s[88:89] offset:3072
    s_add_u32 s88, s88, 4096
    s_addc_u32 s89, s89, 0
    global_load_dwordx4 v[80:83], v4, s[88:89] offset:0
    global_load_dwordx4 v[84:87], v4, s[88:89] offset:1024
    global_load_dwordx4 v[88:91], v4, s[88:89] offset:2048
    global_load_dwordx4 v[92:95], v4, s[88:89] offset:3072
    s_add_u32 s88, s88, 4096
    s_addc_u32 s89, s89, 0
    global_load_dwordx4 v[96:99], v4, s[88:89] offset:0
    global_load_dwordx4 v[100:103], v4, s[88:89] offset:1024
    global_load_dwordx4 v[104:107], v4, s[88:89] offset:2048
    global_load_dwordx4 v[108:111], v4, s[88:89] offset:3072
    s_add_u32 s88, s88, 4096
    s_addc_u32 s89, s89, 0
    global_load_dwordx4 v[112:115], v4, s[88:89] offset:0
    global_load_dwordx4 v[116:119], v4, s[88:89] offset:1024
    global_load_dwordx4 v[120:123], v4, s[88:89] offset:2048
    global_load_dwordx4 v[124:127], v4, s[88:89] offset:3072
    s_branch KB_HB
KB_LN0:
    s_waitcnt vmcnt(4)
    global_load_dwordx4 v[64:67], v4, s[88:89] offset:0
    global_load_dwordx4 v[68:71], v4, s[88:89] offset:1024
    global_load_dwordx4 v[72:75], v4, s[88:89] offset:2048
    global_load_dwordx4 v[76:79], v4, s[88:89] offset:3072
    s_add_u32 s88, s88, 4096
    s_addc_u32 s89, s89, 0
    s_branch KB_LN
KB_NOW:
    s_branch KB_HB
KB_LN:
    v_and_b32 v63, 0xffff0000, v47
    v_lshlrev_b32 v62, 16, v47
    v_and_b32 v61, 0xffff0000, v46
    v_lshlrev_b32 v60, 16, v46
    v_and_b32 v59, 0xffff0000, v45
    v_lshlrev_b32 v58, 16, v45
    v_and_b32 v57, 0xffff0000, v44
    v_lshlrev_b32 v56, 16, v44
    v_and_b32 v55, 0xffff0000, v43
    v_lshlrev_b32 v54, 16, v43
    v_and_b32 v53, 0xffff0000, v42
    v_lshlrev_b32 v52, 16, v42
    v_and_b32 v51, 0xffff0000, v41
    v_lshlrev_b32 v50, 16, v41
    v_and_b32 v49, 0xffff0000, v40
    v_lshlrev_b32 v48, 16, v40
    v_and_b32 v47, 0xffff0000, v39
    v_lshlrev_b32 v46, 16, v39
    v_and_b32 v45, 0xffff0000, v38
    v_lshlrev_b32 v44, 16, v38
    v_and_b32 v43, 0xffff0000, v37
    v_lshlrev_b32 v42, 16, v37
    v_and_b32 v41, 0xffff0000, v36
    v_lshlrev_b32 v40, 16, v36
    v_and_b32 v39, 0xffff0000, v35
    v_lshlrev_b32 v38, 16, v35
    v_and_b32 v37, 0xffff0000, v34
    v_lshlrev_b32 v36, 16, v34
    v_and_b32 v35, 0xffff0000, v33
    v_lshlrev_b32 v34, 16, v33
    v_and_b32 v33, 0xffff0000, v32
    v_lshlrev_b32 v32, 16, v32
    v_add_f32 v12, v32, v33
    v_add_f32 v12, v12, v34
    v_add_f32 v12, v12, v35
    v_add_f32 v12, v12, v36
    v_add_f32 v12, v12, v37
    v_add_f32 v12, v12, v38
    v_add_f32 v12, v12, v39
    v_add_f32 v13, v40, v41
    v_add_f32 v13, v13, v42
    v_add_f32 v13, v13, v43
    v_add_f32 v13, v13, v44
    v_add_f32 v13, v13, v45
    v_add_f32 v13, v13, v46
    v_add_f32 v13, v13, v47
    v_add_f32 v14, v48, v49
    v_add_f32 v14, v14, v50
    v_add_f32 v14, v14, v51
    v_add_f32 v14, v14, v52
    v_add_f32 v14, v14, v53
    v_add_f32 v14, v14, v54
    v_add_f32 v14, v14, v55
    v_add_f32 v15, v56, v57
    v_add_f32 v15, v15, v58
    v_add_f32 v15, v15, v59
    v_add_f32 v15, v15, v60
    v_add_f32 v15, v15, v61
    v_add_f32 v15, v15, v62
    v_add_f32 v15, v15, v63
    global_load_dwordx4 v[80:83], v4, s[88:89] offset:0
    global_load_dwordx4 v[84:87], v4, s[88:89] offset:1024
    global_load_dwordx4 v[88:91], v4, s[88:89] offset:2048
    global_load_dwordx4 v[92:95], v4, s[88:89] offset:3072
    s_add_u32 s88, s88, 4096
    s_addc_u32 s89, s89, 0
    v_add_f32_dpp v12, v12, v12 quad_perm:[1,0,3,2] row_mask:0xf bank_mask:0xf
    v_add_f32_dpp v13, v13, v13 quad_perm:[1,0,3,2] row_mask:0xf bank_mask:0xf
    v_add_f32_dpp v14, v14, v14 quad_perm:[1,0,3,2] row_mask:0xf bank_mask:0xf
    v_add_f32_dpp v15, v15, v15 quad_perm:[1,0,3,2] row_mask:0xf bank_mask:0xf
    s_nop 0
    v_add_f32_dpp v12, v12, v12 quad_perm:[2,3,0,1] row_mask:0xf bank_mask:0xf
    v_add_f32_dpp v13, v13, v13 quad_perm:[2,3,0,1] row_mask:0xf bank_mask:0xf
    v_add_f32_dpp v14, v14, v14 quad_perm:[2,3,0,1] row_mask:0xf bank_mask:0xf
    v_add_f32_dpp v15, v15, v15 quad_perm:[2,3,0,1] row_mask:0xf bank_mask:0xf
    s_nop 0
    v_add_f32_dpp v12, v12, v12 row_half_mirror row_mask:0xf bank_mask:0xf
    v_add_f32_dpp v13, v13, v13 row_half_mirror row_mask:0xf bank_mask:0xf
    v_add_f32_dpp v14, v14, v14 row_half_mirror row_mask:0xf bank_mask:0xf
    v_add_f32_dpp v15, v15, v15 row_half_mirror row_mask:0xf bank_mask:0xf
    s_nop 0
    v_add_f32_dpp v12, v12, v12 row_mirror row_mask:0xf bank_mask:0xf
    v_add_f32_dpp v13, v13, v13 row_mirror row_mask:0xf bank_mask:0xf
    v_add_f32_dpp v14, v14, v14 row_mirror row_mask:0xf bank_mask:0xf
    v_add_f32_dpp v15, v15, v15 row_mirror row_mask:0xf bank_mask:0xf
    s_nop 0
    v_readlane_b32 s44, v12, 0
    v_readlane_b32 s45, v12, 16
    v_readlane_b32 s46, v12, 32
    v_readlane_b32 s47, v12, 48
    v_readlane_b32 s48, v13, 0
    v_readlane_b32 s49, v13, 16
    v_readlane_b32 s50, v13, 32
    v_readlane_b32 s51, v13, 48
    v_readlane_b32 s52, v14, 0
    v_readlane_b32 s53, v14, 16
    v_readlane_b32 s54, v14, 32
    v_readlane_b32 s55, v14, 48
    v_readlane_b32 s56, v15, 0
    v_readlane_b32 s57, v15, 16
    v_readlane_b32 s58, v15, 32
    v_readlane_b32 s59, v15, 48
    s_nop 1
    v_mov_b32 v12, s44
    v_mov_b32 v13, s48
    v_mov_b32 v14, s52
    v_mov_b32 v15, s56
    v_add_f32 v12, s45, v12
    v_add_f32 v13, s49, v13
    v_add_f32 v14, s53, v14
    v_add_f32 v15, s57, v15
    v_add_f32 v12, s46, v12
    v_add_f32 v13, s50, v13
    v_add_f32 v14, s54, v14
    v_add_f32 v15, s58, v15
    v_add_f32 v12, s47, v12
    v_add_f32 v13, s51, v13
    v_add_f32 v14, s55, v14
    v_add_f32 v15, s59, v15
    v_mul_f32 v12, 0x3b000000, v12
    v_mul_f32 v13, 0x3b000000, v13
    v_mul_f32 v14, 0x3b000000, v14
    v_mul_f32 v15, 0x3b000000, v15
    global_load_dwordx4 v[96:99], v4, s[88:89] offset:0
    global_load_dwordx4 v[100:103], v4, s[88:89] offset:1024
    global_load_dwordx4 v[104:107], v4, s[88:89] offset:2048
    global_load_dwordx4 v[108:111], v4, s[88:89] offset:3072
    s_add_u32 s88, s88, 4096
    s_addc_u32 s89, s89, 0
    v_sub_f32 v32, v32, v12
    v_sub_f32 v33, v33, v12
    v_sub_f32 v34, v34, v12
    v_sub_f32 v35, v35, v12
    v_sub_f32 v36, v36, v12
    v_sub_f32 v37, v37, v12
    v_sub_f32 v38, v38, v12
    v_sub_f32 v39, v39, v12
    v_sub_f32 v40, v40, v13
    v_sub_f32 v41, v41, v13
    v_sub_f32 v42, v42, v13
    v_sub_f32 v43, v43, v13
    v_sub_f32 v44, v44, v13
    v_sub_f32 v45, v45, v13
    v_sub_f32 v46, v46, v13
    v_sub_f32 v47, v47, v13
    v_sub_f32 v48, v48, v14
    v_sub_f32 v49, v49, v14
    v_sub_f32 v50, v50, v14
    v_sub_f32 v51, v51, v14
    v_sub_f32 v52, v52, v14
    v_sub_f32 v53, v53, v14
    v_sub_f32 v54, v54, v14
    v_sub_f32 v55, v55, v14
    v_sub_f32 v56, v56, v15
    v_sub_f32 v57, v57, v15
    v_sub_f32 v58, v58, v15
    v_sub_f32 v59, v59, v15
    v_sub_f32 v60, v60, v15
    v_sub_f32 v61, v61, v15
    v_sub_f32 v62, v62, v15
    v_sub_f32 v63, v63, v15
    v_mul_f32 v12, v32, v32
    v_fmac_f32 v12, v33, v33
    v_fmac_f32 v12, v34, v34
    v_fmac_f32 v12, v35, v35
    v_fmac_f32 v12, v36, v36
    v_fmac_f32 v12, v37, v37
    v_fmac_f32 v12, v38, v38
    v_fmac_f32 v12, v39, v39
    v_mul_f32 v13, v40, v40
    v_fmac_f32 v13, v41, v41
    v_fmac_f32 v13, v42, v42
    v_fmac_f32 v13, v43, v43
    v_fmac_f32 v13, v44, v44
    v_fmac_f32 v13, v45, v45
    v_fmac_f32 v13, v46, v46
    v_fmac_f32 v13, v47, v47
    v_mul_f32 v14, v48, v48
    v_fmac_f32 v14, v49, v49
    v_fmac_f32 v14, v50, v50
    v_fmac_f32 v14, v51, v51
    v_fmac_f32 v14, v52, v52
    v_fmac_f32 v14, v53, v53
    v_fmac_f32 v14, v54, v54
    v_fmac_f32 v14, v55, v55
    v_mul_f32 v15, v56, v56
    v_fmac_f32 v15, v57, v57
    v_fmac_f32 v15, v58, v58
    v_fmac_f32 v15, v59, v59
    v_fmac_f32 v15, v60, v60
    v_fmac_f32 v15, v61, v61
    v_fmac_f32 v15, v62, v62
    v_fmac_f32 v15, v63, v63
    global_load_dwordx4 v[112:115], v4, s[88:89] offset:0
    global_load_dwordx4 v[116:119], v4, s[88:89] offset:1024
    global_load_dwordx4 v[120:123], v4, s[88:89] offset:2048
    global_load_dwordx4 v[124:127], v4, s[88:89] offset:3072
    v_add_f32_dpp v12, v12, v12 quad_perm:[1,0,3,2] row_mask:0xf bank_mask:0xf
    v_add_f32_dpp v13, v13, v13 quad_perm:[1,0,3,2] row_mask:0xf bank_mask:0xf
    v_add_f32_dpp v14, v14, v14 quad_perm:[1,0,3,2] row_mask:0xf bank_mask:0xf
    v_add_f32_dpp v15, v15, v15 quad_perm:[1,0,3,2] row_mask:0xf bank_mask:0xf
    s_nop 0
    v_add_f32_dpp v12, v12, v12 quad_perm:[2,3,0,1] row_mask:0xf bank_mask:0xf
    v_add_f32_dpp v13, v13, v13 quad_perm:[2,3,0,1] row_mask:0xf bank_mask:0xf
    v_add_f32_dpp v14, v14, v14 quad_perm:[2,3,0,1] row_mask:0xf bank_mask:0xf
    v_add_f32_dpp v15, v15, v15 quad_perm:[2,3,0,1] row_mask:0xf bank_mask:0xf
    s_nop 0
    v_add_f32_dpp v12, v12, v12 row_half_mirror row_mask:0xf bank_mask:0xf
    v_add_f32_dpp v13, v13, v13 row_half_mirror row_mask:0xf bank_mask:0xf
    v_add_f32_dpp v14, v14, v14 row_half_mirror row_mask:0xf bank_mask:0xf
    v_add_f32_dpp v15, v15, v15 row_half_mirror row_mask:0xf bank_mask:0xf
    s_nop 0
    v_add_f32_dpp v12, v12, v12 row_mirror row_mask:0xf bank_mask:0xf
    v_add_f32_dpp v13, v13, v13 row_mirror row_mask:0xf bank_mask:0xf
    v_add_f32_dpp v14, v14, v14 row_mirror row_mask:0xf bank_mask:0xf
    v_add_f32_dpp v15, v15, v15 row_mirror row_mask:0xf bank_mask:0xf
    s_nop 0
    v_readlane_b32 s44, v12, 0
    v_readlane_b32 s45, v12, 16
    v_readlane_b32 s46, v12, 32
    v_readlane_b32 s47, v12, 48
    v_readlane_b32 s48, v13, 0
    v_readlane_b32 s49, v13, 16
    v_readlane_b32 s50, v13, 32
    v_readlane_b32 s51, v13, 48
    v_readlane_b32 s52, v14, 0
    v_readlane_b32 s53, v14, 16
    v_readlane_b32 s54, v14, 32
    v_readlane_b32 s55, v14, 48
    v_readlane_b32 s56, v15, 0
    v_readlane_b32 s57, v15, 16
    v_readlane_b32 s58, v15, 32
    v_readlane_b32 s59, v15, 48
    s_nop 1
    v_mov_b32 v12, s44
    v_mov_b32 v13, s48
    v_mov_b32 v14, s52
    v_mov_b32 v15, s56
    v_add_f32 v12, s45, v12
    v_add_f32 v13, s49, v13
    v_add_f32 v14, s53, v14
    v_add_f32 v15, s57, v15
    v_add_f32 v12, s46, v12
    v_add_f32 v13, s50, v13
    v_add_f32 v14, s54, v14
    v_add_f32 v15, s58, v15
    v_add_f32 v12, s47, v12
    v_add_f32 v13, s51, v13
    v_add_f32 v14, s55, v14
    v_add_f32 v15, s59, v15
    v_mov_b32 v8, 0x3727c5ac
    v_mov_b32 v9, 0x3727c5ac
    v_mov_b32 v10, 0x3727c5ac
    v_mov_b32 v11, 0x3727c5ac
    v_fmac_f32 v8, 0x3b000000, v12
    v_fmac_f32 v9, 0x3b000000, v13
    v_fmac_f32 v10, 0x3b000000, v14
    v_fmac_f32 v11, 0x3b000000, v15
    v_rsq_f32 v8, v8
    v_rsq_f32 v9, v9
    v_rsq_f32 v10, v10
    v_rsq_f32 v11, v11
    s_nop 0
    v_mul_f32 v32, v32, v8
    v_mul_f32 v33, v33, v8
    v_mul_f32 v34, v34, v8
    v_mul_f32 v35, v35, v8
    v_mul_f32 v36, v36, v8
    v_mul_f32 v37, v37, v8
    v_mul_f32 v38, v38, v8
    v_mul_f32 v39, v39, v8
    v_mul_f32 v40, v40, v9
    v_mul_f32 v41, v41, v9
    v_mul_f32 v42, v42, v9
    v_mul_f32 v43, v43, v9
    v_mul_f32 v44, v44, v9
    v_mul_f32 v45, v45, v9
    v_mul_f32 v46, v46, v9
    v_mul_f32 v47, v47, v9
    v_mul_f32 v48, v48, v10
    v_mul_f32 v49, v49, v10
    v_mul_f32 v50, v50, v10
    v_mul_f32 v51, v51, v10
    v_mul_f32 v52, v52, v10
    v_mul_f32 v53, v53, v10
    v_mul_f32 v54, v54, v10
    v_mul_f32 v55, v55, v10
    v_mul_f32 v56, v56, v11
    v_mul_f32 v57, v57, v11
    v_mul_f32 v58, v58, v11
    v_mul_f32 v59, v59, v11
    v_mul_f32 v60, v60, v11
    v_mul_f32 v61, v61, v11
    v_mul_f32 v62, v62, v11
    v_mul_f32 v63, v63, v11
    v_cvt_pk_bf16_f32 v32, v32, v32
    v_lshlrev_b32 v32, 16, v32
    v_cvt_pk_bf16_f32 v33, v33, v33
    v_lshlrev_b32 v33, 16, v33
    v_cvt_pk_bf16_f32 v34, v34, v34
    v_lshlrev_b32 v34, 16, v34
    v_cvt_pk_bf16_f32 v35, v35, v35
    v_lshlrev_b32 v35, 16, v35
    v_cvt_pk_bf16_f32 v36, v36, v36
    v_lshlrev_b32 v36, 16, v36
    v_cvt_pk_bf16_f32 v37, v37, v37
    v_lshlrev_b32 v37, 16, v37
    v_cvt_pk_bf16_f32 v38, v38, v38
    v_lshlrev_b32 v38, 16, v38
    v_cvt_pk_bf16_f32 v39, v39, v39
    v_lshlrev_b32 v39, 16, v39
    v_cvt_pk_bf16_f32 v40, v40, v40
    v_lshlrev_b32 v40, 16, v40
    v_cvt_pk_bf16_f32 v41, v41, v41
    v_lshlrev_b32 v41, 16, v41
    v_cvt_pk_bf16_f32 v42, v42, v42
    v_lshlrev_b32 v42, 16, v42
    v_cvt_pk_bf16_f32 v43, v43, v43
    v_lshlrev_b32 v43, 16, v43
    v_cvt_pk_bf16_f32 v44, v44, v44
    v_lshlrev_b32 v44, 16, v44
    v_cvt_pk_bf16_f32 v45, v45, v45
    v_lshlrev_b32 v45, 16, v45
    v_cvt_pk_bf16_f32 v46, v46, v46
    v_lshlrev_b32 v46, 16, v46
    v_cvt_pk_bf16_f32 v47, v47, v47
    v_lshlrev_b32 v47, 16, v47
    v_cvt_pk_bf16_f32 v48, v48, v48
    v_lshlrev_b32 v48, 16, v48
    v_cvt_pk_bf16_f32 v49, v49, v49
    v_lshlrev_b32 v49, 16, v49
    v_cvt_pk_bf16_f32 v50, v50, v50
    v_lshlrev_b32 v50, 16, v50
    v_cvt_pk_bf16_f32 v51, v51, v51
    v_lshlrev_b32 v51, 16, v51
    v_cvt_pk_bf16_f32 v52, v52, v52
    v_lshlrev_b32 v52, 16, v52
    v_cvt_pk_bf16_f32 v53, v53, v53
    v_lshlrev_b32 v53, 16, v53
    v_cvt_pk_bf16_f32 v54, v54, v54
    v_lshlrev_b32 v54, 16, v54
    v_cvt_pk_bf16_f32 v55, v55, v55
    v_lshlrev_b32 v55, 16, v55
    v_cvt_pk_bf16_f32 v56, v56, v56
    v_lshlrev_b32 v56, 16, v56
    v_cvt_pk_bf16_f32 v57, v57, v57
    v_lshlrev_b32 v57, 16, v57
    v_cvt_pk_bf16_f32 v58, v58, v58
    v_lshlrev_b32 v58, 16, v58
    v_cvt_pk_bf16_f32 v59, v59, v59
    v_lshlrev_b32 v59, 16, v59
    v_cvt_pk_bf16_f32 v60, v60, v60
    v_lshlrev_b32 v60, 16, v60
    v_cvt_pk_bf16_f32 v61, v61, v61
    v_lshlrev_b32 v61, 16, v61
    v_cvt_pk_bf16_f32 v62, v62, v62
    v_lshlrev_b32 v62, 16, v62
    v_cvt_pk_bf16_f32 v63, v63, v63
    v_lshlrev_b32 v63, 16, v63
    s_waitcnt vmcnt(16)
    s_mul_i32 s10, s3, 4160
    v_add_u32 v3, s10, v4
    v_fma_f32 v32, v32, v24, v16
    v_fma_f32 v33, v33, v25, v17
    v_fma_f32 v34, v34, v26, v18
    v_fma_f32 v35, v35, v27, v19
    v_fma_f32 v36, v36, v28, v20
    v_fma_f32 v37, v37, v29, v21
    v_fma_f32 v38, v38, v30, v22
    v_fma_f32 v39, v39, v31, v23
    v_fma_f32 v40, v40, v24, v16
    v_fma_f32 v41, v41, v25, v17
    v_fma_f32 v42, v42, v26, v18
    v_fma_f32 v43, v43, v27, v19
    v_fma_f32 v44, v44, v28, v20
    v_fma_f32 v45, v45, v29, v21
    v_fma_f32 v46, v46, v30, v22
    v_fma_f32 v47, v47, v31, v23
    v_fma_f32 v48, v48, v24, v16
    v_fma_f32 v49, v49, v25, v17
    v_fma_f32 v50, v50, v26, v18
    v_fma_f32 v51, v51, v27, v19
    v_fma_f32 v52, v52, v28, v20
    v_fma_f32 v53, v53, v29, v21
    v_fma_f32 v54, v54, v30, v22
    v_fma_f32 v55, v55, v31, v23
    v_fma_f32 v56, v56, v24, v16
    v_fma_f32 v57, v57, v25, v17
    v_fma_f32 v58, v58, v26, v18
    v_fma_f32 v59, v59, v27, v19
    v_fma_f32 v60, v60, v28, v20
    v_fma_f32 v61, v61, v29, v21
    v_fma_f32 v62, v62, v30, v22
    v_fma_f32 v63, v63, v31, v23
    v_cvt_pk_bf16_f32 v32, v32, v33
    v_cvt_pk_bf16_f32 v33, v34, v35
    v_cvt_pk_bf16_f32 v34, v36, v37
    v_cvt_pk_bf16_f32 v35, v38, v39
    ds_write_b128 v3, v[32:35] offset:0
    v_cvt_pk_bf16_f32 v40, v40, v41
    v_cvt_pk_bf16_f32 v41, v42, v43
    v_cvt_pk_bf16_f32 v42, v44, v45
    v_cvt_pk_bf16_f32 v43, v46, v47
    ds_write_b128 v3, v[40:43] offset:1040
    v_cvt_pk_bf16_f32 v48, v48, v49
    v_cvt_pk_bf16_f32 v49, v50, v51
    v_cvt_pk_bf16_f32 v50, v52, v53
    v_cvt_pk_bf16_f32 v51, v54, v55
    ds_write_b128 v3, v[48:51] offset:2080
    v_cvt_pk_bf16_f32 v56, v56, v57
    v_cvt_pk_bf16_f32 v57, v58, v59
    v_cvt_pk_bf16_f32 v58, v60, v61
    v_cvt_pk_bf16_f32 v59, v62, v63
    ds_write_b128 v3, v[56:59] offset:3120
    s_waitcnt lgkmcnt(0)
KB_HB:
    s_barrier
    v_and_b32 v6, 31, v1
    v_lshrrev_b32 v7, 5, v1
    s_mov_b32 s10, 1040
    v_mul_lo_u32 v8, v6, s10
    v_lshl_add_u32 v8, v7, 4, v8
    s_lshl_b32 s10, s8, 9
    v_add_u32 v8, s10, v8
    v_mov_b32 v32, 0
    v_mov_b32 v33, 0
    v_mov_b32 v34, 0
    v_mov_b32 v35, 0
    v_mov_b32 v36, 0
    v_mov_b32 v37, 0
    v_mov_b32 v38, 0
    v_mov_b32 v39, 0
    v_mov_b32 v40, 0
    v_mov_b32 v41, 0
    v_mov_b32 v42, 0
    v_mov_b32 v43, 0
    v_mov_b32 v44, 0
    v_mov_b32 v45, 0
    v_mov_b32 v46, 0
    v_mov_b32 v47, 0
    s_cmp_eq_u32 s9, 0
    s_cbranch_scc1 KB_RED
    s_cmp_eq_u32 s6, 4
    s_cselect_b32 s10, 1, 0
    s_cmp_eq_u32 s7, 1
    s_cselect_b32 s11, 1, 0
    s_and_b32 s13, s10, s11
    s_cmp_eq_u32 s13, 1
    s_cbranch_scc1 KB_GV
    ds_read_b128 v[16:19], v8 offset:0
    ds_read_b128 v[20:23], v8 offset:32
    ds_read_b128 v[24:27], v8 offset:64
    ds_read_b128 v[28:31], v8 offset:96
    s_waitcnt vmcnt(15) lgkmcnt(3)
    v_mfma_f32_32x32x16_bf16 v[32:47], v[64:67], v[16:19], v[32:47]
    ds_read_b128 v[16:19], v8 offset:128
    s_waitcnt vmcnt(14) lgkmcnt(3)
    v_mfma_f32_32x32x16_bf16 v[32:47], v[68:71], v[20:23], v[32:47]
    ds_read_b128 v[20:23], v8 offset:160
    s_waitcnt vmcnt(13) lgkmcnt(3)
    v_mfma_f32_32x32x16_bf16 v[32:47], v[72:75], v[24:27], v[32:47]
    ds_read_b128 v[24:27], v8 offset:192
    s_waitcnt vmcnt(12) lgkmcnt(3)
    v_mfma_f32_32x32x16_bf16 v[32:47], v[76:79], v[28:31], v[32:47]
    ds_read_b128 v[28:31], v8 offset:224
    s_waitcnt vmcnt(11) lgkmcnt(3)
    v_mfma_f32_32x32x16_bf16 v[32:47], v[80:83], v[16:19], v[32:47]
    ds_read_b128 v[16:19], v8 offset:256
    s_waitcnt vmcnt(10) lgkmcnt(3)
    v_mfma_f32_32x32x16_bf16 v[32:47], v[84:87], v[20:23], v[32:47]
    ds_read_b128 v[20:23], v8 offset:288
    s_waitcnt vmcnt(9) lgkmcnt(3)
    v_mfma_f32_32x32x16_bf16 v[32:47], v[88:91], v[24:27], v[32:47]
    ds_read_b128 v[24:27], v8 offset:320
    s_waitcnt vmcnt(8) lgkmcnt(3)
    v_mfma_f32_32x32x16_bf16 v[32:47], v[92:95], v[28:31], v[32:47]
    ds_read_b128 v[28:31], v8 offset:352
    s_waitcnt vmcnt(7) lgkmcnt(3)
    v_mfma_f32_32x32x16_bf16 v[32:47], v[96:99], v[16:19], v[32:47]
    ds_read_b128 v[16:19], v8 offset:384
    s_waitcnt vmcnt(6) lgkmcnt(3)
    v_mfma_f32_32x32x16_bf16 v[32:47], v[100:103], v[20:23], v[32:47]
    ds_read_b128 v[20:23], v8 offset:416
    s_waitcnt vmcnt(5) lgkmcnt(3)
    v_mfma_f32_32x32x16_bf16 v[32:47], v[104:107], v[24:27], v[32:47]
    ds_read_b128 v[24:27], v8 offset:448
    s_waitcnt vmcnt(4) lgkmcnt(3)
    v_mfma_f32_32x32x16_bf16 v[32:47], v[108:111], v[28:31], v[32:47]
    ds_read_b128 v[28:31], v8 offset:480
    s_waitcnt vmcnt(3) lgkmcnt(3)
    v_mfma_f32_32x32x16_bf16 v[32:47], v[112:115], v[16:19], v[32:47]
    s_waitcnt vmcnt(2) lgkmcnt(2)
    v_mfma_f32_32x32x16_bf16 v[32:47], v[116:119], v[20:23], v[32:47]
    s_waitcnt vmcnt(1) lgkmcnt(1)
    v_mfma_f32_32x32x16_bf16 v[32:47], v[120:123], v[24:27], v[32:47]
    s_waitcnt vmcnt(0) lgkmcnt(0)
    v_mfma_f32_32x32x16_bf16 v[32:47], v[124:127], v[28:31], v[32:47]
    s_branch KB_RED
KB_GV:
    ds_read_b128 v[16:19], v8 offset:0
    ds_read_b128 v[20:23], v8 offset:32
    ds_read_b128 v[24:27], v8 offset:64
    ds_read_b128 v[28:31], v8 offset:96
    s_waitcnt vmcnt(15) lgkmcnt(3)
    v_mfma_f32_32x32x16_bf16 v[32:47], v[16:19], v[64:67], v[32:47]
    ds_read_b128 v[16:19], v8 offset:128
    s_waitcnt vmcnt(14) lgkmcnt(3)
    v_mfma_f32_32x32x16_bf16 v[32:47], v[20:23], v[68:71], v[32:47]
    ds_read_b128 v[20:23], v8 offset:160
    s_waitcnt vmcnt(13) lgkmcnt(3)
    v_mfma_f32_32x32x16_bf16 v[32:47], v[24:27], v[72:75], v[32:47]
    ds_read_b128 v[24:27], v8 offset:192
    s_waitcnt vmcnt(12) lgkmcnt(3)
    v_mfma_f32_32x32x16_bf16 v[32:47], v[28:31], v[76:79], v[32:47]
    ds_read_b128 v[28:31], v8 offset:224
    s_waitcnt vmcnt(11) lgkmcnt(3)
    v_mfma_f32_32x32x16_bf16 v[32:47], v[16:19], v[80:83], v[32:47]
    ds_read_b128 v[16:19], v8 offset:256
    s_waitcnt vmcnt(10) lgkmcnt(3)
    v_mfma_f32_32x32x16_bf16 v[32:47], v[20:23], v[84:87], v[32:47]
    ds_read_b128 v[20:23], v8 offset:288
    s_waitcnt vmcnt(9) lgkmcnt(3)
    v_mfma_f32_32x32x16_bf16 v[32:47], v[24:27], v[88:91], v[32:47]
    ds_read_b128 v[24:27], v8 offset:320
    s_waitcnt vmcnt(8) lgkmcnt(3)
    v_mfma_f32_32x32x16_bf16 v[32:47], v[28:31], v[92:95], v[32:47]
    ds_read_b128 v[28:31], v8 offset:352
    s_waitcnt vmcnt(7) lgkmcnt(3)
    v_mfma_f32_32x32x16_bf16 v[32:47], v[16:19], v[96:99], v[32:47]
    ds_read_b128 v[16:19], v8 offset:384
    s_waitcnt vmcnt(6) lgkmcnt(3)
    v_mfma_f32_32x32x16_bf16 v[32:47], v[20:23], v[100:103], v[32:47]
    ds_read_b128 v[20:23], v8 offset:416
    s_waitcnt vmcnt(5) lgkmcnt(3)
    v_mfma_f32_32x32x16_bf16 v[32:47], v[24:27], v[104:107], v[32:47]
    ds_read_b128 v[24:27], v8 offset:448
    s_waitcnt vmcnt(4) lgkmcnt(3)
    v_mfma_f32_32x32x16_bf16 v[32:47], v[28:31], v[108:111], v[32:47]
    ds_read_b128 v[28:31], v8 offset:480
    s_waitcnt vmcnt(3) lgkmcnt(3)
    v_mfma_f32_32x32x16_bf16 v[32:47], v[16:19], v[112:115], v[32:47]
    s_waitcnt vmcnt(2) lgkmcnt(2)
    v_mfma_f32_32x32x16_bf16 v[32:47], v[20:23], v[116:119], v[32:47]
    s_waitcnt vmcnt(1) lgkmcnt(1)
    v_mfma_f32_32x32x16_bf16 v[32:47], v[24:27], v[120:123], v[32:47]
    s_waitcnt vmcnt(0) lgkmcnt(0)
    v_mfma_f32_32x32x16_bf16 v[32:47], v[28:31], v[124:127], v[32:47]
KB_RED:
    s_nop 15
    s_nop 3
    s_lshl_b32 s10, s86, 12
    s_add_u32 s10, s10, 33280
    v_add_u32 v10, s10, v4
    s_cmp_eq_u32 s8, 0
    s_cbranch_scc1 KB_R2
    ds_write_b128 v10, v[32:35] offset:0
    ds_write_b128 v10, v[36:39] offset:1024
    ds_write_b128 v10, v[40:43] offset:2048
    ds_write_b128 v10, v[44:47] offset:3072
    s_waitcnt lgkmcnt(0)
KB_R2:
    s_barrier
    s_cmp_eq_u32 s8, 0
    s_cbranch_scc0 KB_END
    s_cmp_eq_u32 s9, 0
    s_cbranch_scc1 KB_END
    ds_read_b128 v[16:19], v10 offset:0
    ds_read_b128 v[20:23], v10 offset:1024
    ds_read_b128 v[24:27], v10 offset:2048
    ds_read_b128 v[28:31], v10 offset:3072
    s_waitcnt lgkmcnt(0)
    v_add_f32 v32, v32, v16
    v_add_f32 v33, v33, v17
    v_add_f32 v34, v34, v18
    v_add_f32 v35, v35, v19
    v_add_f32 v36, v36, v20
    v_add_f32 v37, v37, v21
    v_add_f32 v38, v38, v22
    v_add_f32 v39, v39, v23
    v_add_f32 v40, v40, v24
    v_add_f32 v41, v41, v25
    v_add_f32 v42, v42, v26
    v_add_f32 v43, v43, v27
    v_add_f32 v44, v44, v28
    v_add_f32 v45, v45, v29
    v_add_f32 v46, v46, v30
    v_add_f32 v47, v47, v31
    s_cmp_lt_u32 s6, 4
    s_cbranch_scc0 KB_KV
    v_mov_b32 v9, 0x3eb8aa3b
    v_mul_f32 v32, v32, v9
    v_mul_f32 v33, v33, v9
    v_mul_f32 v34, v34, v9
    v_mul_f32 v35, v35, v9
    v_mul_f32 v36, v36, v9
    v_mul_f32 v37, v37, v9
    v_mul_f32 v38, v38, v9
    v_mul_f32 v39, v39, v9
    v_mul_f32 v40, v40, v9
    v_mul_f32 v41, v41, v9
    v_mul_f32 v42, v42, v9
    v_mul_f32 v43, v43, v9
    v_mul_f32 v44, v44, v9
    v_mul_f32 v45, v45, v9
    v_mul_f32 v46, v46, v9
    v_mul_f32 v47, v47, v9
    v_cvt_pk_bf16_f32 v16, v32, v33
    v_cvt_pk_bf16_f32 v17, v34, v35
    v_cvt_pk_bf16_f32 v18, v36, v37
    v_cvt_pk_bf16_f32 v19, v38, v39
    v_cvt_pk_bf16_f32 v20, v40, v41
    v_cvt_pk_bf16_f32 v21, v42, v43
    v_cvt_pk_bf16_f32 v22, v44, v45
    v_cvt_pk_bf16_f32 v23, v46, v47
    s_lshl_b32 s10, s5, 15
    s_lshl_b32 s11, s6, 2
    s_add_u32 s11, s11, s7
    s_lshl_b32 s11, s11, 6
    s_add_u32 s10, s10, s11
    s_add_u32 s10, s10, 8781824
    s_add_u32 s10, s42, s10
    s_addc_u32 s11, s43, 0
    v_lshlrev_b32 v10, 10, v6
    v_lshl_add_u32 v10, v7, 3, v10
    global_store_dwordx2 v10, v[16:17], s[10:11] offset:0
    global_store_dwordx2 v10, v[18:19], s[10:11] offset:16
    global_store_dwordx2 v10, v[20:21], s[10:11] offset:32
    global_store_dwordx2 v10, v[22:23], s[10:11] offset:48
    s_endpgm
KB_KV:
    s_cmp_eq_u32 s13, 1
    s_cbranch_scc1 KB_V
    v_cvt_pk_bf16_f32 v16, v32, v33
    v_cvt_pk_bf16_f32 v17, v34, v35
    v_cvt_pk_bf16_f32 v18, v36, v37
    v_cvt_pk_bf16_f32 v19, v38, v39
    s_lshl_b32 s10, s5, 10
    s_add_u32 s10, s10, 10878976
    s_add_u32 s10, s42, s10
    s_addc_u32 s11, s43, 0
    v_lshlrev_b32 v10, 4, v6
    v_lshl_add_u32 v10, v7, 3, v10
    global_store_dwordx2 v10, v[16:17], s[10:11] offset:0
    global_store_dwordx2 v10, v[18:19], s[10:11] offset:512
    s_endpgm
KB_V:
    v_cvt_pk_bf16_f32 v16, v32, v33
    v_cvt_pk_bf16_f32 v17, v34, v35
    v_cvt_pk_bf16_f32 v18, v36, v37
    v_cvt_pk_bf16_f32 v19, v38, v39
    v_cvt_pk_bf16_f32 v20, v40, v41
    v_cvt_pk_bf16_f32 v21, v42, v43
    v_cvt_pk_bf16_f32 v22, v44, v45
    v_cvt_pk_bf16_f32 v23, v46, v47
    s_lshl_b32 s10, s5, 10
    s_add_u32 s10, s10, 10944512
    s_add_u32 s10, s42, s10
    s_addc_u32 s11, s43, 0
    v_subrev_u32 v10, 16, v6
    v_lshlrev_b32 v10, 4, v10
    v_lshl_add_u32 v10, v7, 8, v10
    v_cmp_le_u32 vcc, 16, v6
    s_and_saveexec_b64 s[12:13], vcc
    global_store_dwordx4 v10, v[16:19], s[10:11] offset:0
    global_store_dwordx4 v10, v[20:23], s[10:11] offset:512
    s_endpgm
KB_PWD:
    s_mul_i32 s5, s4, 9363
    s_lshr_b32 s5, s5, 16
    s_mul_i32 s6, s5, 7
    s_sub_u32 s6, s4, s6
    s_lshl_b32 s6, s6, 4
    s_lshl_b32 s7, s3, 1
    s_add_u32 s6, s6, s7
    v_lshrrev_b32 v3, 2, v1
    v_and_b32 v4, 3, v1
    s_lshl_b32 s7, s6, 4
    v_add_u32 v3, s7, v3
    v_lshlrev_b32 v3, 10, v3
    v_lshl_add_u32 v3, v4, 4, v3
    s_lshl_b32 s7, s5, 7
    v_add_u32 v3, s7, v3
    s_add_u32 s8, s32, 16384
    s_addc_u32 s9, s33, 0
    global_load_dwordx4 v[16:19], v3, s[32:33]
    global_load_dwordx4 v[20:23], v3, s[32:33] offset:64
    global_load_dwordx4 v[24:27], v3, s[8:9]
    global_load_dwordx4 v[28:31], v3, s[8:9] offset:64
    s_lshl_b32 s9, s3, 12
    v_lshlrev_b32 v15, 4, v1
    v_add_u32 v10, s9, v15
    v_lshrrev_b32 v11, 5, v1
    v_bfe_u32 v12, v1, 2, 2
    v_bfe_u32 v13, v1, 4, 1
    v_and_b32 v14, 3, v1
    v_lshlrev_b32 v11, 2, v11
    v_add_u32 v11, v11, v12
    v_lshlrev_b32 v11, 6, v11
    v_lshl_add_u32 v11, v13, 5, v11
    v_lshl_add_u32 v11, v14, 3, v11
    v_add_u32 v11, s9, v11
    s_mul_i32 s7, s5, 224
    s_add_u32 s7, s7, s6
    s_lshl_b32 s7, s7, 10
    s_add_u32 s7, s7, 6946816
    s_add_u32 s50, s42, s7
    s_addc_u32 s51, s43, 0
    s_add_u32 s52, s50, 114688
    s_addc_u32 s53, s51, 0
    s_waitcnt vmcnt(3)
    ds_write_b128 v10, v[16:19] offset:0
    s_waitcnt vmcnt(2)
    ds_write_b128 v10, v[20:23] offset:1024
    s_waitcnt vmcnt(1)
    ds_write_b128 v10, v[24:27] offset:2048
    s_waitcnt vmcnt(0)
    ds_write_b128 v10, v[28:31] offset:3072
    s_waitcnt lgkmcnt(0)
    ds_read_b64_tr_b16 v[32:33], v11 offset:0
    ds_read_b64_tr_b16 v[34:35], v11 offset:512
    ds_read_b64_tr_b16 v[36:37], v11 offset:1024
    ds_read_b64_tr_b16 v[38:39], v11 offset:1536
    ds_read_b64_tr_b16 v[40:41], v11 offset:2048
    ds_read_b64_tr_b16 v[42:43], v11 offset:2560
    ds_read_b64_tr_b16 v[44:45], v11 offset:3072
    ds_read_b64_tr_b16 v[46:47], v11 offset:3584
    s_waitcnt lgkmcnt(6)
    global_store_dwordx4 v15, v[32:35], s[50:51] offset:0
    s_waitcnt lgkmcnt(4)
    global_store_dwordx4 v15, v[36:39], s[52:53] offset:0
    s_waitcnt lgkmcnt(2)
    global_store_dwordx4 v15, v[40:43], s[50:51] offset:1024
    s_waitcnt lgkmcnt(0)
    global_store_dwordx4 v15, v[44:47], s[52:53] offset:1024
    s_endpgm
KB_PWO:
    s_lshr_b32 s5, s3, 2
    s_lshl_b32 s6, s4, 1
    s_add_u32 s5, s5, s6
    s_and_b32 s6, s3, 3
    s_lshl_b32 s6, s6, 2
    v_lshrrev_b32 v3, 1, v1
    s_lshl_b32 s7, s6, 5
    v_add_u32 v3, s7, v3
    v_lshlrev_b32 v3, 10, v3
    v_and_b32 v4, 1, v1
    v_lshl_add_u32 v3, v4, 4, v3
    s_lshl_b32 s7, s5, 5
    v_add_u32 v3, s7, v3
    s_mov_b32 s8, s24
    s_mov_b32 s9, s25
    global_load_dwordx4 v[16:19], v3, s[8:9]
    s_add_u32 s8, s8, 32768
    s_addc_u32 s9, s9, 0
    global_load_dwordx4 v[20:23], v3, s[8:9]
    s_add_u32 s8, s8, 32768
    s_addc_u32 s9, s9, 0
    global_load_dwordx4 v[24:27], v3, s[8:9]
    s_add_u32 s8, s8, 32768
    s_addc_u32 s9, s9, 0
    global_load_dwordx4 v[28:31], v3, s[8:9]
    s_lshl_b32 s6, s3, 12
    v_lshlrev_b32 v10, 4, v1
    v_add_u32 v10, s6, v10
    v_lshrrev_b32 v11, 4, v1
    v_bfe_u32 v12, v1, 2, 2
    v_and_b32 v14, 3, v1
    v_lshlrev_b32 v11, 3, v11
    v_add_u32 v11, v11, v12
    v_lshlrev_b32 v11, 5, v11
    v_lshl_add_u32 v11, v14, 3, v11
    v_add_u32 v11, s6, v11
    s_lshl_b32 s7, s5, 4
    s_and_b32 s8, s3, 3
    s_lshl_b32 s8, s8, 2
    s_add_u32 s7, s7, s8
    s_lshl_b32 s7, s7, 10
    s_add_u32 s7, s7, 2752512
    s_add_u32 s50, s42, s7
    s_addc_u32 s51, s43, 0
    s_waitcnt vmcnt(3)
    ds_write_b128 v10, v[16:19] offset:0
    s_waitcnt vmcnt(2)
    ds_write_b128 v10, v[20:23] offset:1024
    s_waitcnt vmcnt(1)
    ds_write_b128 v10, v[24:27] offset:2048
    s_waitcnt vmcnt(0)
    ds_write_b128 v10, v[28:31] offset:3072
    s_waitcnt lgkmcnt(0)
    ds_read_b64_tr_b16 v[32:33], v11 offset:0
    ds_read_b64_tr_b16 v[34:35], v11 offset:128
    ds_read_b64_tr_b16 v[36:37], v11 offset:1024
    ds_read_b64_tr_b16 v[38:39], v11 offset:1152
    ds_read_b64_tr_b16 v[40:41], v11 offset:2048
    ds_read_b64_tr_b16 v[42:43], v11 offset:2176
    ds_read_b64_tr_b16 v[44:45], v11 offset:3072
    ds_read_b64_tr_b16 v[46:47], v11 offset:3200
    v_lshlrev_b32 v15, 4, v1
    s_waitcnt lgkmcnt(6)
    global_store_dwordx4 v15, v[32:35], s[50:51] offset:0
    s_waitcnt lgkmcnt(4)
    global_store_dwordx4 v15, v[36:39], s[50:51] offset:1024
    s_waitcnt lgkmcnt(2)
    global_store_dwordx4 v15, v[40:43], s[50:51] offset:2048
    s_waitcnt lgkmcnt(0)
    global_store_dwordx4 v15, v[44:47], s[50:51] offset:3072
    s_endpgm
KB_PQKV:
    s_lshl_b32 s7, s4, 6
    s_add_u32 s44, s18, s7
    s_addc_u32 s45, s19, 0
    s_add_u32 s46, s44, 32
    s_addc_u32 s47, s45, 0
    s_mov_b32 s48, 1024
    s_cmp_lt_u32 s4, 16
    s_cbranch_scc1 KB_PQKV2
    s_mov_b32 s44, s20
    s_mov_b32 s45, s21
    s_mov_b32 s46, s22
    s_mov_b32 s47, s23
    s_mov_b32 s48, 32
KB_PQKV2:
    s_lshl_b32 s49, s3, 2
    s_lshl_b32 s7, s4, 5
    s_add_u32 s7, s7, s49
    s_lshl_b32 s7, s7, 10
    s_add_u32 s7, s7, 2162688
    s_add_u32 s50, s42, s7
    s_addc_u32 s51, s43, 0
    s_mov_b32 s52, 1024
    s_mov_b32 s53, 0
    s_branch KB_PGO
KB_PGU:
    s_lshr_b32 s5, s4, 2
    s_and_b32 s6, s4, 3
    s_lshl_b32 s6, s6, 3
    s_add_u32 s6, s6, s3
    v_lshrrev_b32 v3, 2, v1
    v_and_b32 v4, 3, v1
    s_lshl_b32 s7, s6, 4
    v_add_u32 v3, s7, v3
    s_movk_i32 s7, 3584
    v_mul_lo_u32 v3, v3, s7
    v_and_b32 v5, 1, v4
    v_lshl_add_u32 v3, v5, 4, v3
    s_mul_i32 s7, s5, 224
    v_add_u32 v3, s7, v3
    v_cmp_lt_u32 vcc, 1, v4
    v_mov_b32 v6, s28
    v_mov_b32 v7, s29
    v_mov_b32 v8, s30
    v_mov_b32 v9, s31
    v_cndmask_b32 v6, v6, v8, vcc
    v_cndmask_b32 v7, v7, v9, vcc
    v_add_co_u32 v6, vcc, v6, v3
    s_nop 1
    v_addc_co_u32 v7, vcc, 0, v7, vcc
    global_load_dwordx4 v[16:19], v[6:7], off offset:0
    global_load_dwordx4 v[20:23], v[6:7], off offset:32
    global_load_dwordx4 v[24:27], v[6:7], off offset:64
    global_load_dwordx4 v[28:31], v[6:7], off offset:96
    global_load_dwordx4 v[32:35], v[6:7], off offset:128
    global_load_dwordx4 v[36:39], v[6:7], off offset:160
    global_load_dwordx4 v[40:43], v[6:7], off offset:192
    s_lshl_b32 s9, s3, 12
    v_lshlrev_b32 v15, 4, v1
    v_add_u32 v10, s9, v15
    v_lshrrev_b32 v11, 5, v1
    v_bfe_u32 v12, v1, 2, 2
    v_bfe_u32 v13, v1, 4, 1
    v_and_b32 v14, 3, v1
    v_lshlrev_b32 v11, 3, v11
    v_add_u32 v11, v11, v12
    v_lshlrev_b32 v11, 6, v11
    v_lshl_add_u32 v11, v13, 5, v11
    v_lshl_add_u32 v11, v14, 3, v11
    v_add_u32 v11, s9, v11
    s_lshl_b32 s7, s5, 5
    s_add_u32 s7, s7, s6
    s_mul_i32 s7, s7, 7168
    s_add_u32 s7, s7, 3276800
    s_add_u32 s50, s42, s7
    s_addc_u32 s51, s43, 0
    s_waitcnt vmcnt(6)
    ds_write_b128 v10, v[16:19] offset:0
    s_waitcnt vmcnt(5)
    ds_write_b128 v10, v[20:23] offset:1024
    s_waitcnt vmcnt(4)
    ds_write_b128 v10, v[24:27] offset:2048
    s_waitcnt vmcnt(3)
    ds_write_b128 v10, v[28:31] offset:3072
    s_waitcnt lgkmcnt(0)
    ds_read_b64_tr_b16 v[48:49], v11 offset:0
    ds_read_b64_tr_b16 v[50:51], v11 offset:256
    ds_read_b64_tr_b16 v[52:53], v11 offset:1024
    ds_read_b64_tr_b16 v[54:55], v11 offset:1280
    ds_read_b64_tr_b16 v[56:57], v11 offset:2048
    ds_read_b64_tr_b16 v[58:59], v11 offset:2304
    ds_read_b64_tr_b16 v[60:61], v11 offset:3072
    ds_read_b64_tr_b16 v[62:63], v11 offset:3328
    s_waitcnt lgkmcnt(0)
    global_store_dwordx4 v15, v[48:51], s[50:51] offset:0
    global_store_dwordx4 v15, v[52:55], s[50:51] offset:1024
    global_store_dwordx4 v15, v[56:59], s[50:51] offset:2048
    global_store_dwordx4 v15, v[60:63], s[50:51] offset:3072
    s_waitcnt vmcnt(6)
    ds_write_b128 v10, v[32:35] offset:0
    s_waitcnt vmcnt(5)
    ds_write_b128 v10, v[36:39] offset:1024
    s_waitcnt vmcnt(4)
    ds_write_b128 v10, v[40:43] offset:2048
    s_waitcnt lgkmcnt(0)
    ds_read_b64_tr_b16 v[64:65], v11 offset:0
    ds_read_b64_tr_b16 v[66:67], v11 offset:256
    ds_read_b64_tr_b16 v[68:69], v11 offset:1024
    ds_read_b64_tr_b16 v[70:71], v11 offset:1280
    ds_read_b64_tr_b16 v[72:73], v11 offset:2048
    ds_read_b64_tr_b16 v[74:75], v11 offset:2304
    s_waitcnt lgkmcnt(0)
    s_add_u32 s50, s50, 4096
    s_addc_u32 s51, s51, 0
    global_store_dwordx4 v15, v[64:67], s[50:51] offset:0
    global_store_dwordx4 v15, v[68:71], s[50:51] offset:1024
    global_store_dwordx4 v15, v[72:75], s[50:51] offset:2048
    s_endpgm
KB_PGO:
    v_lshrrev_b32 v3, 2, v1
    v_and_b32 v4, 3, v1
    s_lshl_b32 s5, s49, 4
    v_add_u32 v3, s5, v3
    v_mul_lo_u32 v3, v3, s48
    v_and_b32 v5, 1, v4
    v_lshl_add_u32 v3, v5, 4, v3
    v_cmp_lt_u32 vcc, 1, v4
    v_mov_b32 v6, s44
    v_mov_b32 v7, s45
    v_mov_b32 v8, s46
    v_mov_b32 v9, s47
    v_cndmask_b32 v6, v6, v8, vcc
    v_cndmask_b32 v7, v7, v9, vcc
    v_add_co_u32 v6, vcc, v6, v3
    s_nop 1
    v_addc_co_u32 v7, vcc, 0, v7, vcc
    s_lshl_b32 s5, s48, 4
    global_load_dwordx4 v[16:19], v[6:7], off
    v_add_co_u32 v6, vcc, s5, v6
    s_nop 1
    v_addc_co_u32 v7, vcc, 0, v7, vcc
    global_load_dwordx4 v[20:23], v[6:7], off
    v_add_co_u32 v6, vcc, s5, v6
    s_nop 1
    v_addc_co_u32 v7, vcc, 0, v7, vcc
    global_load_dwordx4 v[24:27], v[6:7], off
    v_add_co_u32 v6, vcc, s5, v6
    s_nop 1
    v_addc_co_u32 v7, vcc, 0, v7, vcc
    global_load_dwordx4 v[28:31], v[6:7], off
    s_lshl_b32 s6, s3, 12
    v_lshlrev_b32 v10, 4, v1
    v_add_u32 v10, s6, v10
    v_lshrrev_b32 v11, 5, v1
    v_bfe_u32 v12, v1, 2, 2
    v_bfe_u32 v13, v1, 4, 1
    v_and_b32 v14, 3, v1
    s_cmp_eq_u32 s53, 0
    s_cselect_b32 s7, 3, 2
    s_cselect_b32 s8, 1, 2
    s_lshl_b32 s8, s8, 8
    v_lshlrev_b32 v11, s7, v11
    v_add_u32 v11, v11, v12
    v_lshlrev_b32 v11, 6, v11
    v_lshl_add_u32 v11, v13, 5, v11
    v_lshl_add_u32 v11, v14, 3, v11
    v_add_u32 v11, s6, v11
    v_add_u32 v12, s8, v11
    s_waitcnt vmcnt(3)
    ds_write_b128 v10, v[16:19] offset:0
    s_waitcnt vmcnt(2)
    ds_write_b128 v10, v[20:23] offset:1024
    s_waitcnt vmcnt(1)
    ds_write_b128 v10, v[24:27] offset:2048
    s_waitcnt vmcnt(0)
    ds_write_b128 v10, v[28:31] offset:3072
    s_waitcnt lgkmcnt(0)
    ds_read_b64_tr_b16 v[32:33], v11 offset:0
    ds_read_b64_tr_b16 v[34:35], v12 offset:0
    ds_read_b64_tr_b16 v[36:37], v11 offset:1024
    ds_read_b64_tr_b16 v[38:39], v12 offset:1024
    ds_read_b64_tr_b16 v[40:41], v11 offset:2048
    ds_read_b64_tr_b16 v[42:43], v12 offset:2048
    ds_read_b64_tr_b16 v[44:45], v11 offset:3072
    ds_read_b64_tr_b16 v[46:47], v12 offset:3072
    v_lshlrev_b32 v15, 4, v1
    s_waitcnt lgkmcnt(6)
    global_store_dwordx4 v15, v[32:35], s[50:51]
    s_add_u32 s50, s50, s52
    s_addc_u32 s51, s51, 0
    s_waitcnt lgkmcnt(4)
    global_store_dwordx4 v15, v[36:39], s[50:51]
    s_add_u32 s50, s50, s52
    s_addc_u32 s51, s51, 0
    s_waitcnt lgkmcnt(2)
    global_store_dwordx4 v15, v[40:43], s[50:51]
    s_add_u32 s50, s50, s52
    s_addc_u32 s51, s51, 0
    s_waitcnt lgkmcnt(0)
    global_store_dwordx4 v15, v[44:47], s[50:51]
KB_END:
    s_endpgm
.globl attn_kernel
.p2align 8
.type attn_kernel,@function
attn_kernel:
    s_load_dwordx16 s[16:31], s[0:1], 0
    s_load_dwordx8 s[32:39], s[0:1], 64
    s_load_dwordx4 s[40:43], s[0:1], 96
    s_cmp_ge_u32 s2, 256
    s_cbranch_scc1 K3_END
    v_and_b32 v1, 63, v0
    v_lshrrev_b32 v2, 6, v0
    s_nop 0
    v_readfirstlane_b32 s3, v2
    s_and_b32 s4, s2, 7
    s_lshr_b32 s5, s2, 3
    s_lshl_b32 s6, s4, 8
    s_lshl_b32 s7, s5, 3
    s_add_u32 s84, s6, s7
    s_add_u32 s6, s84, s3
    v_and_b32 v104, 31, v1
    v_lshrrev_b32 v105, 5, v1
    v_lshlrev_b32 v106, 5, v104
    v_lshl_add_u32 v106, v105, 4, v106
    s_waitcnt lgkmcnt(0)
    s_lshl_b32 s7, s6, 10
    s_add_u32 s7, s7, 8781824
    s_add_u32 s8, s42, s7
    s_addc_u32 s9, s43, 0
    global_load_dwordx4 v[4:7], v106, s[8:9]
    s_add_u32 s12, s42, 10878976
    s_addc_u32 s13, s43, 0
    s_mov_b32 s14, 131072
    s_mov_b32 s15, 0x00020000
    v_lshlrev_b32 v107, 4, v0
    s_lshl_b32 s10, s3, 10
    v_lshlrev_b32 v147, 4, v0
    s_mov_b32 s88, s10
    s_add_u32 m0, s88, 0
    s_mov_b32 s11, 0
    buffer_load_dwordx4 v147, s[12:15], s11 offen lds
    s_add_u32 m0, s88, 65536
    s_mov_b32 s11, 65536
    buffer_load_dwordx4 v147, s[12:15], s11 offen lds
    s_add_u32 m0, s88, 8192
    s_mov_b32 s11, 8192
    buffer_load_dwordx4 v147, s[12:15], s11 offen lds
    s_add_u32 m0, s88, 73728
    s_mov_b32 s11, 73728
    buffer_load_dwordx4 v147, s[12:15], s11 offen lds
    v_lshlrev_b32 v2, 4, v1
    v_and_b32 v3, 15, v1
    v_lshlrev_b32 v3, 4, v3
    v_lshl_add_u32 v3, v105, 8, v3
    v_add_u32 v3, 65536, v3
    s_mov_b32 s44, 0x0000ffff
    s_mov_b32 s45, 0x0000ffff
    s_mov_b32 s46, 0
    s_mov_b32 s89, 0x49800000
    s_mov_b64 s[48:49], 0
    v_and_b32 v108, 31, v1
    v_lshlrev_b32 v108, 6, v108
    s_lshl_b32 s8, s5, 14
    s_lshl_b32 s9, s3, 11
    s_add_u32 s8, s8, s9
    s_add_u32 s8, s8, 2752512
    s_add_u32 s8, s42, s8
    s_addc_u32 s9, s43, 0
    s_lshl_b32 s7, s3, 16
    s_add_u32 s7, s7, 2752512
    s_add_u32 s56, s42, s7
    s_addc_u32 s57, s43, 0
    s_mov_b32 s58, 65536
    s_mov_b32 s59, 0x00020000
    v_lshlrev_b32 v107, 4, v1
    v_mov_b32 v88, 0x3f803f80
    v_mov_b32 v89, 0x3f803f80
    v_mov_b32 v90, 0x3f803f80
    v_mov_b32 v91, 0x3f803f80
    v_mov_b32 v92, 0x3f803f80
    v_mov_b32 v93, 0x3f803f80
    v_mov_b32 v94, 0x3f803f80
    v_mov_b32 v95, 0x3f803f80
    v_mov_b32 v96, 0x3f803f80
    v_mov_b32 v97, 0x3f803f80
    v_mov_b32 v98, 0x3f803f80
    v_mov_b32 v99, 0x3f803f80
    v_mov_b32 v100, 0x3f803f80
    v_mov_b32 v101, 0x3f803f80
    v_mov_b32 v102, 0x3f803f80
    v_mov_b32 v103, 0x3f803f80
    v_mov_b32 v8, 0
    v_mov_b32 v64, 0
    v_mov_b32 v9, 0
    v_mov_b32 v65, 0
    v_mov_b32 v10, 0
    v_mov_b32 v66, 0
    v_mov_b32 v11, 0
    v_mov_b32 v67, 0
    v_mov_b32 v12, 0
    v_mov_b32 v68, 0
    v_mov_b32 v13, 0
    v_mov_b32 v69, 0
    v_mov_b32 v14, 0
    v_mov_b32 v70, 0
    v_mov_b32 v15, 0
    v_mov_b32 v71, 0
    v_mov_b32 v16, 0
    v_mov_b32 v72, 0
    v_mov_b32 v17, 0
    v_mov_b32 v73, 0
    v_mov_b32 v18, 0
    v_mov_b32 v74, 0
    v_mov_b32 v19, 0
    v_mov_b32 v75, 0
    v_mov_b32 v20, 0
    v_mov_b32 v76, 0
    v_mov_b32 v21, 0
    v_mov_b32 v77, 0
    v_mov_b32 v22, 0
    v_mov_b32 v78, 0
    v_mov_b32 v23, 0
    v_mov_b32 v79, 0
    s_waitcnt vmcnt(0)
    s_barrier
    ds_read_b128 v[80:83], v2
    s_waitcnt lgkmcnt(0)
    v_mfma_f32_32x32x16_bf16 v[24:39], v[80:83], v[4:7], v[8:23]
    s_nop 15
    s_nop 3
    v_max3_f32 v104, v24, v25, v26
    v_max_f32 v104, v104, v27
    v_max3_f32 v104, v104, v28, v29
    v_max3_f32 v104, v104, v30, v31
    v_max3_f32 v104, v104, v32, v33
    v_max3_f32 v104, v104, v34, v35
    v_max3_f32 v104, v104, v36, v37
    v_max3_f32 v104, v104, v38, v39
    v_mov_b32 v105, v104
    s_nop 1
    v_permlane32_swap_b32 v104, v105
    s_nop 0
    v_max_f32 v104, v104, v105
    v_sub_f32 v104, 0xc2b40000, v104
    v_mov_b32 v8, v104
    v_mov_b32 v9, v104
    v_mov_b32 v10, v104
    v_mov_b32 v11, v104
    v_mov_b32 v12, v104
    v_mov_b32 v13, v104
    v_mov_b32 v14, v104
    v_mov_b32 v15, v104
    v_mov_b32 v16, v104
    v_mov_b32 v17, v104
    v_mov_b32 v18, v104
    v_mov_b32 v19, v104
    v_mov_b32 v20, v104
    v_mov_b32 v21, v104
    v_mov_b32 v22, v104
    v_mov_b32 v23, v104
K3_MAIN:
    s_cmp_eq_u32 s46, 0
    s_cbranch_scc0 K3_NOKV0
    s_add_u32 m0, s88, 16384
    s_mov_b32 s11, 16384
    buffer_load_dwordx4 v147, s[12:15], s11 offen lds
    s_add_u32 m0, s88, 81920
    s_mov_b32 s11, 81920
    buffer_load_dwordx4 v147, s[12:15], s11 offen lds
    s_add_u32 m0, s88, 24576
    s_mov_b32 s11, 24576
    buffer_load_dwordx4 v147, s[12:15], s11 offen lds
    global_load_dword v146, v108, s[8:9]
K3_NOKV0:
    s_cmp_eq_u32 s46, 0
    s_cbranch_scc0 K3_NOPRE0
    s_mov_b32 s11, 0
    buffer_load_dwordx4 v[148:151], v107, s[56:59], s11 offen
    s_mov_b32 s11, 16384
    buffer_load_dwordx4 v[152:155], v107, s[56:59], s11 offen
    s_mov_b32 s11, 32768
    buffer_load_dwordx4 v[156:159], v107, s[56:59], s11 offen
    s_mov_b32 s11, 49152
    buffer_load_dwordx4 v[160:163], v107, s[56:59], s11 offen
K3_NOPRE0:
    ds_read_b128 v[80:83], v2 offset:0
    ds_read_b128 v[84:87], v2 offset:1024
    s_mov_b64 exec, s[44:45]
    ds_read_b128 v[88:91], v3 offset:0
    ds_read_b128 v[92:95], v3 offset:512
    s_mov_b64 exec, -1
    s_waitcnt lgkmcnt(3)
    v_mfma_f32_32x32x16_bf16 v[24:39], v[80:83], v[4:7], v[8:23]
    s_setprio 3
    ds_read_b128 v[80:83], v2 offset:2048
    s_mov_b64 exec, s[44:45]
    ds_read_b128 v[96:99], v3 offset:1024
    ds_read_b128 v[100:103], v3 offset:1536
    s_mov_b64 exec, -1
    s_waitcnt lgkmcnt(3)
    v_mfma_f32_32x32x16_bf16 v[40:55], v[84:87], v[4:7], v[8:23]
    s_nop 9
    v_exp_f32 v24, v24
    v_exp_f32 v25, v25
    v_exp_f32 v26, v26
    v_exp_f32 v27, v27
    v_exp_f32 v28, v28
    v_exp_f32 v29, v29
    v_exp_f32 v30, v30
    v_exp_f32 v31, v31
    v_exp_f32 v32, v32
    v_cvt_pk_bf16_f32 v56, v24, v25
    v_exp_f32 v33, v33
    v_cvt_pk_bf16_f32 v57, v26, v27
    v_exp_f32 v34, v34
    v_cvt_pk_bf16_f32 v58, v28, v29
    v_exp_f32 v35, v35
    v_cvt_pk_bf16_f32 v59, v30, v31
    v_exp_f32 v36, v36
    v_exp_f32 v37, v37
    v_mfma_f32_32x32x16_bf16 v[64:79], v[88:91], v[56:59], v[64:79]
    v_exp_f32 v38, v38
    v_exp_f32 v39, v39
    v_cvt_pk_bf16_f32 v60, v32, v33
    v_cvt_pk_bf16_f32 v61, v34, v35
    v_cvt_pk_bf16_f32 v62, v36, v37
    v_cvt_pk_bf16_f32 v63, v38, v39
    s_nop 1
    v_mfma_f32_32x32x16_bf16 v[64:79], v[92:95], v[60:63], v[64:79]
    ds_read_b128 v[84:87], v2 offset:3072
    s_mov_b64 exec, s[44:45]
    ds_read_b128 v[88:91], v3 offset:2048
    ds_read_b128 v[92:95], v3 offset:2560
    s_mov_b64 exec, -1
    s_waitcnt lgkmcnt(3)
    v_mfma_f32_32x32x16_bf16 v[24:39], v[80:83], v[4:7], v[8:23]
    v_exp_f32 v40, v40
    v_exp_f32 v41, v41
    v_exp_f32 v42, v42
    v_exp_f32 v43, v43
    v_exp_f32 v44, v44
    v_exp_f32 v45, v45
    v_exp_f32 v46, v46
    v_exp_f32 v47, v47
    v_exp_f32 v48, v48
    v_cvt_pk_bf16_f32 v56, v40, v41
    v_exp_f32 v49, v49
    v_cvt_pk_bf16_f32 v57, v42, v43
    v_exp_f32 v50, v50
    v_cvt_pk_bf16_f32 v58, v44, v45
    v_exp_f32 v51, v51
    v_cvt_pk_bf16_f32 v59, v46, v47
    v_exp_f32 v52, v52
    v_exp_f32 v53, v53
    v_mfma_f32_32x32x16_bf16 v[64:79], v[96:99], v[56:59], v[64:79]
    v_exp_f32 v54, v54
    v_exp_f32 v55, v55
    v_cvt_pk_bf16_f32 v60, v48, v49
    v_cvt_pk_bf16_f32 v61, v50, v51
    v_cvt_pk_bf16_f32 v62, v52, v53
    v_cvt_pk_bf16_f32 v63, v54, v55
    s_nop 1
    v_mfma_f32_32x32x16_bf16 v[64:79], v[100:103], v[60:63], v[64:79]
    ds_read_b128 v[80:83], v2 offset:4096
    s_mov_b64 exec, s[44:45]
    ds_read_b128 v[96:99], v3 offset:3072
    ds_read_b128 v[100:103], v3 offset:3584
    s_mov_b64 exec, -1
    s_waitcnt lgkmcnt(3)
    v_mfma_f32_32x32x16_bf16 v[40:55], v[84:87], v[4:7], v[8:23]
    v_exp_f32 v24, v24
    v_exp_f32 v25, v25
    v_exp_f32 v26, v26
    v_exp_f32 v27, v27
    v_exp_f32 v28, v28
    v_exp_f32 v29, v29
    v_exp_f32 v30, v30
    v_exp_f32 v31, v31
    v_exp_f32 v32, v32
    v_cvt_pk_bf16_f32 v56, v24, v25
    v_exp_f32 v33, v33
    v_cvt_pk_bf16_f32 v57, v26, v27
    v_exp_f32 v34, v34
    v_cvt_pk_bf16_f32 v58, v28, v29
    v_exp_f32 v35, v35
    v_cvt_pk_bf16_f32 v59, v30, v31
    v_exp_f32 v36, v36
    v_exp_f32 v37, v37
    v_mfma_f32_32x32x16_bf16 v[64:79], v[88:91], v[56:59], v[64:79]
    v_exp_f32 v38, v38
    v_exp_f32 v39, v39
    v_cvt_pk_bf16_f32 v60, v32, v33
    v_cvt_pk_bf16_f32 v61, v34, v35
    v_cvt_pk_bf16_f32 v62, v36, v37
    v_cvt_pk_bf16_f32 v63, v38, v39
    s_nop 1
    v_mfma_f32_32x32x16_bf16 v[64:79], v[92:95], v[60:63], v[64:79]
    ds_read_b128 v[84:87], v2 offset:5120
    s_mov_b64 exec, s[44:45]
    ds_read_b128 v[88:91], v3 offset:4096
    ds_read_b128 v[92:95], v3 offset:4608
    s_mov_b64 exec, -1
    s_waitcnt lgkmcnt(3)
    v_mfma_f32_32x32x16_bf16 v[24:39], v[80:83], v[4:7], v[8:23]
    v_exp_f32 v40, v40
    v_exp_f32 v41, v41
    v_exp_f32 v42, v42
    v_exp_f32 v43, v43
    v_exp_f32 v44, v44
    v_exp_f32 v45, v45
    v_exp_f32 v46, v46
    v_exp_f32 v47, v47
    v_exp_f32 v48, v48
    v_cvt_pk_bf16_f32 v56, v40, v41
    v_exp_f32 v49, v49
    v_cvt_pk_bf16_f32 v57, v42, v43
    v_exp_f32 v50, v50
    v_cvt_pk_bf16_f32 v58, v44, v45
    v_exp_f32 v51, v51
    v_cvt_pk_bf16_f32 v59, v46, v47
    v_exp_f32 v52, v52
    v_exp_f32 v53, v53
    v_cmp_lt_f32 s[48:49], s89, v72
    v_mfma_f32_32x32x16_bf16 v[64:79], v[96:99], v[56:59], v[64:79]
    v_exp_f32 v54, v54
    v_exp_f32 v55, v55
    v_cvt_pk_bf16_f32 v60, v48, v49
    v_cvt_pk_bf16_f32 v61, v50, v51
    v_cvt_pk_bf16_f32 v62, v52, v53
    v_cvt_pk_bf16_f32 v63, v54, v55
    s_nop 1
    v_mfma_f32_32x32x16_bf16 v[64:79], v[100:103], v[60:63], v[64:79]
    s_cmp_eq_u32 s46, 0
    s_cbranch_scc0 K3_NOKV1
    s_add_u32 m0, s88, 90112
    s_mov_b32 s11, 90112
    buffer_load_dwordx4 v147, s[12:15], s11 offen lds
    s_add_u32 m0, s88, 32768
    s_mov_b32 s11, 32768
    buffer_load_dwordx4 v147, s[12:15], s11 offen lds
    s_add_u32 m0, s88, 98304
    s_mov_b32 s11, 98304
    buffer_load_dwordx4 v147, s[12:15], s11 offen lds
K3_NOKV1:
    s_cmp_eq_u32 s46, 0
    s_cbranch_scc0 K3_NOPRE1
    s_mov_b32 s11, 1024
    buffer_load_dwordx4 v[164:167], v107, s[56:59], s11 offen
    s_mov_b32 s11, 17408
    buffer_load_dwordx4 v[168:171], v107, s[56:59], s11 offen
    s_mov_b32 s11, 33792
    buffer_load_dwordx4 v[172:175], v107, s[56:59], s11 offen
    s_mov_b32 s11, 50176
    buffer_load_dwordx4 v[176:179], v107, s[56:59], s11 offen
K3_NOPRE1:
    s_cmp_eq_u64 s[48:49], 0
    s_cbranch_scc1 K3_RENORM_RET1
    s_getpc_b64 s[52:53]
    s_branch K3_RENORM
K3_RENORM_RET1:
    ds_read_b128 v[80:83], v2 offset:6144
    s_mov_b64 exec, s[44:45]
    ds_read_b128 v[96:99], v3 offset:5120
    ds_read_b128 v[100:103], v3 offset:5632
    s_mov_b64 exec, -1
    s_waitcnt lgkmcnt(3)
    v_mfma_f32_32x32x16_bf16 v[40:55], v[84:87], v[4:7], v[8:23]
    v_exp_f32 v24, v24
    v_exp_f32 v25, v25
    v_exp_f32 v26, v26
    v_exp_f32 v27, v27
    v_exp_f32 v28, v28
    v_exp_f32 v29, v29
    v_exp_f32 v30, v30
    v_exp_f32 v31, v31
    v_exp_f32 v32, v32
    v_cvt_pk_bf16_f32 v56, v24, v25
    v_exp_f32 v33, v33
    v_cvt_pk_bf16_f32 v57, v26, v27
    v_exp_f32 v34, v34
    v_cvt_pk_bf16_f32 v58, v28, v29
    v_exp_f32 v35, v35
    v_cvt_pk_bf16_f32 v59, v30, v31
    v_exp_f32 v36, v36
    v_exp_f32 v37, v37
    v_mfma_f32_32x32x16_bf16 v[64:79], v[88:91], v[56:59], v[64:79]
    v_exp_f32 v38, v38
    v_exp_f32 v39, v39
    v_cvt_pk_bf16_f32 v60, v32, v33
    v_cvt_pk_bf16_f32 v61, v34, v35
    v_cvt_pk_bf16_f32 v62, v36, v37
    v_cvt_pk_bf16_f32 v63, v38, v39
    s_nop 1
    v_mfma_f32_32x32x16_bf16 v[64:79], v[92:95], v[60:63], v[64:79]
    ds_read_b128 v[84:87], v2 offset:7168
    s_mov_b64 exec, s[44:45]
    ds_read_b128 v[88:91], v3 offset:6144
    ds_read_b128 v[92:95], v3 offset:6656
    s_mov_b64 exec, -1
    s_waitcnt lgkmcnt(3)
    v_mfma_f32_32x32x16_bf16 v[24:39], v[80:83], v[4:7], v[8:23]
    v_exp_f32 v40, v40
    v_exp_f32 v41, v41
    v_exp_f32 v42, v42
    v_exp_f32 v43, v43
    v_exp_f32 v44, v44
    v_exp_f32 v45, v45
    v_exp_f32 v46, v46
    v_exp_f32 v47, v47
    v_exp_f32 v48, v48
    v_cvt_pk_bf16_f32 v56, v40, v41
    v_exp_f32 v49, v49
    v_cvt_pk_bf16_f32 v57, v42, v43
    v_exp_f32 v50, v50
    v_cvt_pk_bf16_f32 v58, v44, v45
    v_exp_f32 v51, v51
    v_cvt_pk_bf16_f32 v59, v46, v47
    v_exp_f32 v52, v52
    v_exp_f32 v53, v53
    v_mfma_f32_32x32x16_bf16 v[64:79], v[96:99], v[56:59], v[64:79]
    v_exp_f32 v54, v54
    v_exp_f32 v55, v55
    v_cvt_pk_bf16_f32 v60, v48, v49
    v_cvt_pk_bf16_f32 v61, v50, v51
    v_cvt_pk_bf16_f32 v62, v52, v53
    v_cvt_pk_bf16_f32 v63, v54, v55
    s_nop 1
    v_mfma_f32_32x32x16_bf16 v[64:79], v[100:103], v[60:63], v[64:79]
    ds_read_b128 v[80:83], v2 offset:8192
    s_mov_b64 exec, s[44:45]
    ds_read_b128 v[96:99], v3 offset:7168
    ds_read_b128 v[100:103], v3 offset:7680
    s_mov_b64 exec, -1
    s_waitcnt lgkmcnt(3)
    v_mfma_f32_32x32x16_bf16 v[40:55], v[84:87], v[4:7], v[8:23]
    v_exp_f32 v24, v24
    v_exp_f32 v25, v25
    v_exp_f32 v26, v26
    v_exp_f32 v27, v27
    v_exp_f32 v28, v28
    v_exp_f32 v29, v29
    v_exp_f32 v30, v30
    v_exp_f32 v31, v31
    v_exp_f32 v32, v32
    v_cvt_pk_bf16_f32 v56, v24, v25
    v_exp_f32 v33, v33
    v_cvt_pk_bf16_f32 v57, v26, v27
    v_exp_f32 v34, v34
    v_cvt_pk_bf16_f32 v58, v28, v29
    v_exp_f32 v35, v35
    v_cvt_pk_bf16_f32 v59, v30, v31
    v_exp_f32 v36, v36
    v_exp_f32 v37, v37
    v_mfma_f32_32x32x16_bf16 v[64:79], v[88:91], v[56:59], v[64:79]
    v_exp_f32 v38, v38
    v_exp_f32 v39, v39
    v_cvt_pk_bf16_f32 v60, v32, v33
    v_cvt_pk_bf16_f32 v61, v34, v35
    v_cvt_pk_bf16_f32 v62, v36, v37
    v_cvt_pk_bf16_f32 v63, v38, v39
    s_nop 1
    v_mfma_f32_32x32x16_bf16 v[64:79], v[92:95], v[60:63], v[64:79]
    ds_read_b128 v[84:87], v2 offset:9216
    s_mov_b64 exec, s[44:45]
    ds_read_b128 v[88:91], v3 offset:8192
    ds_read_b128 v[92:95], v3 offset:8704
    s_mov_b64 exec, -1
    s_waitcnt lgkmcnt(3)
    v_mfma_f32_32x32x16_bf16 v[24:39], v[80:83], v[4:7], v[8:23]
    v_exp_f32 v40, v40
    v_exp_f32 v41, v41
    v_exp_f32 v42, v42
    v_exp_f32 v43, v43
    v_exp_f32 v44, v44
    v_exp_f32 v45, v45
    v_exp_f32 v46, v46
    v_exp_f32 v47, v47
    v_exp_f32 v48, v48
    v_cvt_pk_bf16_f32 v56, v40, v41
    v_exp_f32 v49, v49
    v_cvt_pk_bf16_f32 v57, v42, v43
    v_exp_f32 v50, v50
    v_cvt_pk_bf16_f32 v58, v44, v45
    v_exp_f32 v51, v51
    v_cvt_pk_bf16_f32 v59, v46, v47
    v_exp_f32 v52, v52
    v_exp_f32 v53, v53
    v_cmp_lt_f32 s[48:49], s89, v72
    v_mfma_f32_32x32x16_bf16 v[64:79], v[96:99], v[56:59], v[64:79]
    v_exp_f32 v54, v54
    v_exp_f32 v55, v55
    v_cvt_pk_bf16_f32 v60, v48, v49
    v_cvt_pk_bf16_f32 v61, v50, v51
    v_cvt_pk_bf16_f32 v62, v52, v53
    v_cvt_pk_bf16_f32 v63, v54, v55
    s_nop 1
    v_mfma_f32_32x32x16_bf16 v[64:79], v[100:103], v[60:63], v[64:79]
    s_cmp_eq_u32 s46, 0
    s_cbranch_scc0 K3_NOKV2
    s_add_u32 m0, s88, 40960
    s_mov_b32 s11, 40960
    buffer_load_dwordx4 v147, s[12:15], s11 offen lds
    s_add_u32 m0, s88, 106496
    s_mov_b32 s11, 106496
    buffer_load_dwordx4 v147, s[12:15], s11 offen lds
    s_add_u32 m0, s88, 49152
    s_mov_b32 s11, 49152
    buffer_load_dwordx4 v147, s[12:15], s11 offen lds
K3_NOKV2:
    s_cmp_eq_u32 s46, 0
    s_cbranch_scc0 K3_NOPRE2
    s_mov_b32 s11, 2048
    buffer_load_dwordx4 v[180:183], v107, s[56:59], s11 offen
    s_mov_b32 s11, 18432
    buffer_load_dwordx4 v[184:187], v107, s[56:59], s11 offen
    s_mov_b32 s11, 34816
    buffer_load_dwordx4 v[188:191], v107, s[56:59], s11 offen
    s_mov_b32 s11, 51200
    buffer_load_dwordx4 v[192:195], v107, s[56:59], s11 offen
K3_NOPRE2:
    s_cmp_eq_u64 s[48:49], 0
    s_cbranch_scc1 K3_RENORM_RET2
    s_getpc_b64 s[52:53]
    s_branch K3_RENORM
K3_RENORM_RET2:
    ds_read_b128 v[80:83], v2 offset:10240
    s_mov_b64 exec, s[44:45]
    ds_read_b128 v[96:99], v3 offset:9216
    ds_read_b128 v[100:103], v3 offset:9728
    s_mov_b64 exec, -1
    s_waitcnt lgkmcnt(3)
    v_mfma_f32_32x32x16_bf16 v[40:55], v[84:87], v[4:7], v[8:23]
    v_exp_f32 v24, v24
    v_exp_f32 v25, v25
    v_exp_f32 v26, v26
    v_exp_f32 v27, v27
    v_exp_f32 v28, v28
    v_exp_f32 v29, v29
    v_exp_f32 v30, v30
    v_exp_f32 v31, v31
    v_exp_f32 v32, v32
    v_cvt_pk_bf16_f32 v56, v24, v25
    v_exp_f32 v33, v33
    v_cvt_pk_bf16_f32 v57, v26, v27
    v_exp_f32 v34, v34
    v_cvt_pk_bf16_f32 v58, v28, v29
    v_exp_f32 v35, v35
    v_cvt_pk_bf16_f32 v59, v30, v31
    v_exp_f32 v36, v36
    v_exp_f32 v37, v37
    v_mfma_f32_32x32x16_bf16 v[64:79], v[88:91], v[56:59], v[64:79]
    v_exp_f32 v38, v38
    v_exp_f32 v39, v39
    v_cvt_pk_bf16_f32 v60, v32, v33
    v_cvt_pk_bf16_f32 v61, v34, v35
    v_cvt_pk_bf16_f32 v62, v36, v37
    v_cvt_pk_bf16_f32 v63, v38, v39
    s_nop 1
    v_mfma_f32_32x32x16_bf16 v[64:79], v[92:95], v[60:63], v[64:79]
    ds_read_b128 v[84:87], v2 offset:11264
    s_mov_b64 exec, s[44:45]
    ds_read_b128 v[88:91], v3 offset:10240
    ds_read_b128 v[92:95], v3 offset:10752
    s_mov_b64 exec, -1
    s_waitcnt lgkmcnt(3)
    v_mfma_f32_32x32x16_bf16 v[24:39], v[80:83], v[4:7], v[8:23]
    v_exp_f32 v40, v40
    v_exp_f32 v41, v41
    v_exp_f32 v42, v42
    v_exp_f32 v43, v43
    v_exp_f32 v44, v44
    v_exp_f32 v45, v45
    v_exp_f32 v46, v46
    v_exp_f32 v47, v47
    v_exp_f32 v48, v48
    v_cvt_pk_bf16_f32 v56, v40, v41
    v_exp_f32 v49, v49
    v_cvt_pk_bf16_f32 v57, v42, v43
    v_exp_f32 v50, v50
    v_cvt_pk_bf16_f32 v58, v44, v45
    v_exp_f32 v51, v51
    v_cvt_pk_bf16_f32 v59, v46, v47
    v_exp_f32 v52, v52
    v_exp_f32 v53, v53
    v_mfma_f32_32x32x16_bf16 v[64:79], v[96:99], v[56:59], v[64:79]
    v_exp_f32 v54, v54
    v_exp_f32 v55, v55
    v_cvt_pk_bf16_f32 v60, v48, v49
    v_cvt_pk_bf16_f32 v61, v50, v51
    v_cvt_pk_bf16_f32 v62, v52, v53
    v_cvt_pk_bf16_f32 v63, v54, v55
    s_nop 1
    v_mfma_f32_32x32x16_bf16 v[64:79], v[100:103], v[60:63], v[64:79]
    s_setprio 2
    ds_read_b128 v[80:83], v2 offset:12288
    s_mov_b64 exec, s[44:45]
    ds_read_b128 v[96:99], v3 offset:11264
    ds_read_b128 v[100:103], v3 offset:11776
    s_mov_b64 exec, -1
    s_waitcnt lgkmcnt(3)
    v_mfma_f32_32x32x16_bf16 v[40:55], v[84:87], v[4:7], v[8:23]
    v_exp_f32 v24, v24
    v_exp_f32 v25, v25
    v_exp_f32 v26, v26
    v_exp_f32 v27, v27
    v_exp_f32 v28, v28
    v_exp_f32 v29, v29
    v_exp_f32 v30, v30
    v_exp_f32 v31, v31
    v_exp_f32 v32, v32
    v_cvt_pk_bf16_f32 v56, v24, v25
    v_exp_f32 v33, v33
    v_cvt_pk_bf16_f32 v57, v26, v27
    v_exp_f32 v34, v34
    v_cvt_pk_bf16_f32 v58, v28, v29
    v_exp_f32 v35, v35
    v_cvt_pk_bf16_f32 v59, v30, v31
    v_exp_f32 v36, v36
    v_exp_f32 v37, v37
    v_mfma_f32_32x32x16_bf16 v[64:79], v[88:91], v[56:59], v[64:79]
    v_exp_f32 v38, v38
    v_exp_f32 v39, v39
    v_cvt_pk_bf16_f32 v60, v32, v33
    v_cvt_pk_bf16_f32 v61, v34, v35
    v_cvt_pk_bf16_f32 v62, v36, v37
    v_cvt_pk_bf16_f32 v63, v38, v39
    s_nop 1
    v_mfma_f32_32x32x16_bf16 v[64:79], v[92:95], v[60:63], v[64:79]
    ds_read_b128 v[84:87], v2 offset:13312
    s_mov_b64 exec, s[44:45]
    ds_read_b128 v[88:91], v3 offset:12288
    ds_read_b128 v[92:95], v3 offset:12800
    s_mov_b64 exec, -1
    s_waitcnt lgkmcnt(3)
    v_mfma_f32_32x32x16_bf16 v[24:39], v[80:83], v[4:7], v[8:23]
    v_exp_f32 v40, v40
    v_exp_f32 v41, v41
    v_exp_f32 v42, v42
    v_exp_f32 v43, v43
    v_exp_f32 v44, v44
    v_exp_f32 v45, v45
    v_exp_f32 v46, v46
    v_exp_f32 v47, v47
    v_exp_f32 v48, v48
    v_cvt_pk_bf16_f32 v56, v40, v41
    v_exp_f32 v49, v49
    v_cvt_pk_bf16_f32 v57, v42, v43
    v_exp_f32 v50, v50
    v_cvt_pk_bf16_f32 v58, v44, v45
    v_exp_f32 v51, v51
    v_cvt_pk_bf16_f32 v59, v46, v47
    v_exp_f32 v52, v52
    v_exp_f32 v53, v53
    v_cmp_lt_f32 s[48:49], s89, v72
    v_mfma_f32_32x32x16_bf16 v[64:79], v[96:99], v[56:59], v[64:79]
    v_exp_f32 v54, v54
    v_exp_f32 v55, v55
    v_cvt_pk_bf16_f32 v60, v48, v49
    v_cvt_pk_bf16_f32 v61, v50, v51
    v_cvt_pk_bf16_f32 v62, v52, v53
    v_cvt_pk_bf16_f32 v63, v54, v55
    s_nop 1
    v_mfma_f32_32x32x16_bf16 v[64:79], v[100:103], v[60:63], v[64:79]
    s_cmp_eq_u32 s46, 0
    s_cbranch_scc0 K3_NOKV3
    s_add_u32 m0, s88, 114688
    s_mov_b32 s11, 114688
    buffer_load_dwordx4 v147, s[12:15], s11 offen lds
    s_add_u32 m0, s88, 57344
    s_mov_b32 s11, 57344
    buffer_load_dwordx4 v147, s[12:15], s11 offen lds
    s_add_u32 m0, s88, 122880
    s_mov_b32 s11, 122880
    buffer_load_dwordx4 v147, s[12:15], s11 offen lds
K3_NOKV3:
    s_cmp_eq_u32 s46, 0
    s_cbranch_scc0 K3_NOPRE3
    s_mov_b32 s11, 3072
    buffer_load_dwordx4 v[196:199], v107, s[56:59], s11 offen
    s_mov_b32 s11, 19456
    buffer_load_dwordx4 v[200:203], v107, s[56:59], s11 offen
    s_mov_b32 s11, 35840
    buffer_load_dwordx4 v[204:207], v107, s[56:59], s11 offen
    s_mov_b32 s11, 52224
    buffer_load_dwordx4 v[208:211], v107, s[56:59], s11 offen
K3_NOPRE3:
    s_cmp_eq_u64 s[48:49], 0
    s_cbranch_scc1 K3_RENORM_RET3
    s_getpc_b64 s[52:53]
    s_branch K3_RENORM
K3_RENORM_RET3:
    ds_read_b128 v[80:83], v2 offset:14336
    s_mov_b64 exec, s[44:45]
    ds_read_b128 v[96:99], v3 offset:13312
    ds_read_b128 v[100:103], v3 offset:13824
    s_mov_b64 exec, -1
    s_waitcnt lgkmcnt(3)
    v_mfma_f32_32x32x16_bf16 v[40:55], v[84:87], v[4:7], v[8:23]
    v_exp_f32 v24, v24
    v_exp_f32 v25, v25
    v_exp_f32 v26, v26
    v_exp_f32 v27, v27
    v_exp_f32 v28, v28
    v_exp_f32 v29, v29
    v_exp_f32 v30, v30
    v_exp_f32 v31, v31
    v_exp_f32 v32, v32
    v_cvt_pk_bf16_f32 v56, v24, v25
    v_exp_f32 v33, v33
    v_cvt_pk_bf16_f32 v57, v26, v27
    v_exp_f32 v34, v34
    v_cvt_pk_bf16_f32 v58, v28, v29
    v_exp_f32 v35, v35
    v_cvt_pk_bf16_f32 v59, v30, v31
    v_exp_f32 v36, v36
    v_exp_f32 v37, v37
    v_mfma_f32_32x32x16_bf16 v[64:79], v[88:91], v[56:59], v[64:79]
    v_exp_f32 v38, v38
    v_exp_f32 v39, v39
    v_cvt_pk_bf16_f32 v60, v32, v33
    v_cvt_pk_bf16_f32 v61, v34, v35
    v_cvt_pk_bf16_f32 v62, v36, v37
    v_cvt_pk_bf16_f32 v63, v38, v39
    s_nop 1
    v_mfma_f32_32x32x16_bf16 v[64:79], v[92:95], v[60:63], v[64:79]
    ds_read_b128 v[84:87], v2 offset:15360
    s_mov_b64 exec, s[44:45]
    ds_read_b128 v[88:91], v3 offset:14336
    ds_read_b128 v[92:95], v3 offset:14848
    s_mov_b64 exec, -1
    s_waitcnt lgkmcnt(3)
    v_mfma_f32_32x32x16_bf16 v[24:39], v[80:83], v[4:7], v[8:23]
    v_exp_f32 v40, v40
    v_exp_f32 v41, v41
    v_exp_f32 v42, v42
    v_exp_f32 v43, v43
    v_exp_f32 v44, v44
    v_exp_f32 v45, v45
    v_exp_f32 v46, v46
    v_exp_f32 v47, v47
    v_exp_f32 v48, v48
    v_cvt_pk_bf16_f32 v56, v40, v41
    v_exp_f32 v49, v49
    v_cvt_pk_bf16_f32 v57, v42, v43
    v_exp_f32 v50, v50
    v_cvt_pk_bf16_f32 v58, v44, v45
    v_exp_f32 v51, v51
    v_cvt_pk_bf16_f32 v59, v46, v47
    v_exp_f32 v52, v52
    v_exp_f32 v53, v53
    v_mfma_f32_32x32x16_bf16 v[64:79], v[96:99], v[56:59], v[64:79]
    v_exp_f32 v54, v54
    v_exp_f32 v55, v55
    v_cvt_pk_bf16_f32 v60, v48, v49
    v_cvt_pk_bf16_f32 v61, v50, v51
    v_cvt_pk_bf16_f32 v62, v52, v53
    v_cvt_pk_bf16_f32 v63, v54, v55
    s_nop 1
    v_mfma_f32_32x32x16_bf16 v[64:79], v[100:103], v[60:63], v[64:79]
    s_setprio 1
    s_mov_b64 exec, s[44:45]
    ds_read_b128 v[96:99], v3 offset:15360
    ds_read_b128 v[100:103], v3 offset:15872
    s_mov_b64 exec, -1
    s_waitcnt lgkmcnt(2)
    v_mfma_f32_32x32x16_bf16 v[40:55], v[84:87], v[4:7], v[8:23]
    v_exp_f32 v24, v24
    v_exp_f32 v25, v25
    v_exp_f32 v26, v26
    v_exp_f32 v27, v27
    v_exp_f32 v28, v28
    v_exp_f32 v29, v29
    v_exp_f32 v30, v30
    v_exp_f32 v31, v31
    v_exp_f32 v32, v32
    v_cvt_pk_bf16_f32 v56, v24, v25
    v_exp_f32 v33, v33
    v_cvt_pk_bf16_f32 v57, v26, v27
    v_exp_f32 v34, v34
    v_cvt_pk_bf16_f32 v58, v28, v29
    v_exp_f32 v35, v35
    v_cvt_pk_bf16_f32 v59, v30, v31
    v_exp_f32 v36, v36
    v_exp_f32 v37, v37
    v_mfma_f32_32x32x16_bf16 v[64:79], v[88:91], v[56:59], v[64:79]
    v_exp_f32 v38, v38
    v_exp_f32 v39, v39
    v_cvt_pk_bf16_f32 v60, v32, v33
    v_cvt_pk_bf16_f32 v61, v34, v35
    v_cvt_pk_bf16_f32 v62, v36, v37
    v_cvt_pk_bf16_f32 v63, v38, v39
    s_nop 1
    v_mfma_f32_32x32x16_bf16 v[64:79], v[92:95], v[60:63], v[64:79]
    s_waitcnt lgkmcnt(0)
    v_exp_f32 v40, v40
    v_exp_f32 v41, v41
    v_exp_f32 v42, v42
    v_exp_f32 v43, v43
    v_exp_f32 v44, v44
    v_exp_f32 v45, v45
    v_exp_f32 v46, v46
    v_exp_f32 v47, v47
    v_exp_f32 v48, v48
    v_cvt_pk_bf16_f32 v56, v40, v41
    v_exp_f32 v49, v49
    v_cvt_pk_bf16_f32 v57, v42, v43
    v_exp_f32 v50, v50
    v_cvt_pk_bf16_f32 v58, v44, v45
    v_exp_f32 v51, v51
    v_cvt_pk_bf16_f32 v59, v46, v47
    v_exp_f32 v52, v52
    v_exp_f32 v53, v53
    v_cmp_lt_f32 s[48:49], s89, v72
    v_mfma_f32_32x32x16_bf16 v[64:79], v[96:99], v[56:59], v[64:79]
    v_exp_f32 v54, v54
    v_exp_f32 v55, v55
    v_cvt_pk_bf16_f32 v60, v48, v49
    v_cvt_pk_bf16_f32 v61, v50, v51
    v_cvt_pk_bf16_f32 v62, v52, v53
    v_cvt_pk_bf16_f32 v63, v54, v55
    s_nop 1
    v_mfma_f32_32x32x16_bf16 v[64:79], v[100:103], v[60:63], v[64:79]
    s_cmp_eq_u32 s46, 0
    s_cbranch_scc0 K3_NOBAR4
    s_waitcnt vmcnt(4)
    s_barrier
K3_NOBAR4:
    s_cmp_eq_u32 s46, 0
    s_cbranch_scc0 K3_NOPRE4
    s_mov_b32 s11, 4096
    buffer_load_dwordx4 v[212:215], v107, s[56:59], s11 offen
    s_mov_b32 s11, 20480
    buffer_load_dwordx4 v[216:219], v107, s[56:59], s11 offen
    s_mov_b32 s11, 36864
    buffer_load_dwordx4 v[220:223], v107, s[56:59], s11 offen
    s_mov_b32 s11, 53248
    buffer_load_dwordx4 v[224:227], v107, s[56:59], s11 offen
K3_NOPRE4:
    ds_read_b128 v[80:83], v2 offset:16384
    ds_read_b128 v[84:87], v2 offset:17408
    s_mov_b64 exec, s[44:45]
    ds_read_b128 v[88:91], v3 offset:16384
    ds_read_b128 v[92:95], v3 offset:16896
    s_mov_b64 exec, -1
    s_waitcnt lgkmcnt(3)
    v_mfma_f32_32x32x16_bf16 v[24:39], v[80:83], v[4:7], v[8:23]
    s_cmp_eq_u64 s[48:49], 0
    s_cbranch_scc1 K3_RENORM_RET4
    s_getpc_b64 s[52:53]
    s_branch K3_RENORM
K3_RENORM_RET4:
    s_setprio 3
    ds_read_b128 v[80:83], v2 offset:18432
    s_mov_b64 exec, s[44:45]
    ds_read_b128 v[96:99], v3 offset:17408
    ds_read_b128 v[100:103], v3 offset:17920
    s_mov_b64 exec, -1
    s_waitcnt lgkmcnt(3)
    v_mfma_f32_32x32x16_bf16 v[40:55], v[84:87], v[4:7], v[8:23]
    s_nop 9
    v_exp_f32 v24, v24
    v_exp_f32 v25, v25
    v_exp_f32 v26, v26
    v_exp_f32 v27, v27
    v_exp_f32 v28, v28
    v_exp_f32 v29, v29
    v_exp_f32 v30, v30
    v_exp_f32 v31, v31
    v_exp_f32 v32, v32
    v_cvt_pk_bf16_f32 v56, v24, v25
    v_exp_f32 v33, v33
    v_cvt_pk_bf16_f32 v57, v26, v27
    v_exp_f32 v34, v34
    v_cvt_pk_bf16_f32 v58, v28, v29
    v_exp_f32 v35, v35
    v_cvt_pk_bf16_f32 v59, v30, v31
    v_exp_f32 v36, v36
    v_exp_f32 v37, v37
    v_mfma_f32_32x32x16_bf16 v[64:79], v[88:91], v[56:59], v[64:79]
    v_exp_f32 v38, v38
    v_exp_f32 v39, v39
    v_cvt_pk_bf16_f32 v60, v32, v33
    v_cvt_pk_bf16_f32 v61, v34, v35
    v_cvt_pk_bf16_f32 v62, v36, v37
    v_cvt_pk_bf16_f32 v63, v38, v39
    s_nop 1
    v_mfma_f32_32x32x16_bf16 v[64:79], v[92:95], v[60:63], v[64:79]
    ds_read_b128 v[84:87], v2 offset:19456
    s_mov_b64 exec, s[44:45]
    ds_read_b128 v[88:91], v3 offset:18432
    ds_read_b128 v[92:95], v3 offset:18944
    s_mov_b64 exec, -1
    s_waitcnt lgkmcnt(3)
    v_mfma_f32_32x32x16_bf16 v[24:39], v[80:83], v[4:7], v[8:23]
    v_exp_f32 v40, v40
    v_exp_f32 v41, v41
    v_exp_f32 v42, v42
    v_exp_f32 v43, v43
    v_exp_f32 v44, v44
    v_exp_f32 v45, v45
    v_exp_f32 v46, v46
    v_exp_f32 v47, v47
    v_exp_f32 v48, v48
    v_cvt_pk_bf16_f32 v56, v40, v41
    v_exp_f32 v49, v49
    v_cvt_pk_bf16_f32 v57, v42, v43
    v_exp_f32 v50, v50
    v_cvt_pk_bf16_f32 v58, v44, v45
    v_exp_f32 v51, v51
    v_cvt_pk_bf16_f32 v59, v46, v47
    v_exp_f32 v52, v52
    v_exp_f32 v53, v53
    v_mfma_f32_32x32x16_bf16 v[64:79], v[96:99], v[56:59], v[64:79]
    v_exp_f32 v54, v54
    v_exp_f32 v55, v55
    v_cvt_pk_bf16_f32 v60, v48, v49
    v_cvt_pk_bf16_f32 v61, v50, v51
    v_cvt_pk_bf16_f32 v62, v52, v53
    v_cvt_pk_bf16_f32 v63, v54, v55
    s_nop 1
    v_mfma_f32_32x32x16_bf16 v[64:79], v[100:103], v[60:63], v[64:79]
    ds_read_b128 v[80:83], v2 offset:20480
    s_mov_b64 exec, s[44:45]
    ds_read_b128 v[96:99], v3 offset:19456
    ds_read_b128 v[100:103], v3 offset:19968
    s_mov_b64 exec, -1
    s_waitcnt lgkmcnt(3)
    v_mfma_f32_32x32x16_bf16 v[40:55], v[84:87], v[4:7], v[8:23]
    v_exp_f32 v24, v24
    v_exp_f32 v25, v25
    v_exp_f32 v26, v26
    v_exp_f32 v27, v27
    v_exp_f32 v28, v28
    v_exp_f32 v29, v29
    v_exp_f32 v30, v30
    v_exp_f32 v31, v31
    v_exp_f32 v32, v32
    v_cvt_pk_bf16_f32 v56, v24, v25
    v_exp_f32 v33, v33
    v_cvt_pk_bf16_f32 v57, v26, v27
    v_exp_f32 v34, v34
    v_cvt_pk_bf16_f32 v58, v28, v29
    v_exp_f32 v35, v35
    v_cvt_pk_bf16_f32 v59, v30, v31
    v_exp_f32 v36, v36
    v_exp_f32 v37, v37
    v_mfma_f32_32x32x16_bf16 v[64:79], v[88:91], v[56:59], v[64:79]
    v_exp_f32 v38, v38
    v_exp_f32 v39, v39
    v_cvt_pk_bf16_f32 v60, v32, v33
    v_cvt_pk_bf16_f32 v61, v34, v35
    v_cvt_pk_bf16_f32 v62, v36, v37
    v_cvt_pk_bf16_f32 v63, v38, v39
    s_nop 1
    v_mfma_f32_32x32x16_bf16 v[64:79], v[92:95], v[60:63], v[64:79]
    ds_read_b128 v[84:87], v2 offset:21504
    s_mov_b64 exec, s[44:45]
    ds_read_b128 v[88:91], v3 offset:20480
    ds_read_b128 v[92:95], v3 offset:20992
    s_mov_b64 exec, -1
    s_waitcnt lgkmcnt(3)
    v_mfma_f32_32x32x16_bf16 v[24:39], v[80:83], v[4:7], v[8:23]
    v_exp_f32 v40, v40
    v_exp_f32 v41, v41
    v_exp_f32 v42, v42
    v_exp_f32 v43, v43
    v_exp_f32 v44, v44
    v_exp_f32 v45, v45
    v_exp_f32 v46, v46
    v_exp_f32 v47, v47
    v_exp_f32 v48, v48
    v_cvt_pk_bf16_f32 v56, v40, v41
    v_exp_f32 v49, v49
    v_cvt_pk_bf16_f32 v57, v42, v43
    v_exp_f32 v50, v50
    v_cvt_pk_bf16_f32 v58, v44, v45
    v_exp_f32 v51, v51
    v_cvt_pk_bf16_f32 v59, v46, v47
    v_exp_f32 v52, v52
    v_exp_f32 v53, v53
    v_cmp_lt_f32 s[48:49], s89, v72
    v_mfma_f32_32x32x16_bf16 v[64:79], v[96:99], v[56:59], v[64:79]
    v_exp_f32 v54, v54
    v_exp_f32 v55, v55
    v_cvt_pk_bf16_f32 v60, v48, v49
    v_cvt_pk_bf16_f32 v61, v50, v51
    v_cvt_pk_bf16_f32 v62, v52, v53
    v_cvt_pk_bf16_f32 v63, v54, v55
    s_nop 1
    v_mfma_f32_32x32x16_bf16 v[64:79], v[100:103], v[60:63], v[64:79]
    s_cmp_eq_u32 s46, 0
    s_cbranch_scc0 K3_NOOPS
    v_and_b32 v104, 15, v1
    v_bfe_u32 v105, v1, 4, 1
    s_lshl_b32 s7, s3, 8
    v_lshlrev_b32 v106, 2, v104
    v_add_u32 v106, s7, v106
    s_add_u32 s8, s42, 53248
    s_addc_u32 s9, s43, 0
    global_load_dword v110, v106, s[8:9] offset:0
    global_load_dword v111, v106, s[8:9] offset:64
    global_load_dword v112, v106, s[8:9] offset:128
    global_load_dword v113, v106, s[8:9] offset:192
    s_lshl_b32 s7, s84, 10
    s_lshl_b32 s8, s3, 7
    s_add_u32 s7, s7, s8
    v_lshlrev_b32 v109, 1, v104
    v_lshl_add_u32 v109, v105, 12, v109
    v_add_u32 v109, s7, v109
    global_load_ushort v114, v109, s[16:17] offset:0
    global_load_ushort v115, v109, s[16:17] offset:1024
    global_load_ushort v116, v109, s[16:17] offset:2048
    global_load_ushort v117, v109, s[16:17] offset:3072
    global_load_ushort v118, v109, s[16:17] offset:32
    global_load_ushort v119, v109, s[16:17] offset:1056
    global_load_ushort v120, v109, s[16:17] offset:2080
    global_load_ushort v121, v109, s[16:17] offset:3104
    global_load_ushort v122, v109, s[16:17] offset:64
    global_load_ushort v123, v109, s[16:17] offset:1088
    global_load_ushort v124, v109, s[16:17] offset:2112
    global_load_ushort v125, v109, s[16:17] offset:3136
    global_load_ushort v126, v109, s[16:17] offset:96
    global_load_ushort v127, v109, s[16:17] offset:1120
    global_load_ushort v128, v109, s[16:17] offset:2144
    global_load_ushort v129, v109, s[16:17] offset:3168
    v_lshlrev_b32 v108, 5, v1
    s_add_u32 s8, s42, 57344
    s_addc_u32 s9, s43, 0
    global_load_dwordx4 v[130:133], v108, s[8:9]
    global_load_dwordx4 v[134:137], v108, s[8:9] offset:16
    s_add_u32 s8, s42, 55296
    s_addc_u32 s9, s43, 0
    global_load_dwordx4 v[138:141], v108, s[8:9]
    global_load_dwordx4 v[142:145], v108, s[8:9] offset:16
K3_NOOPS:
    s_cmp_eq_u32 s46, 0
    s_cbranch_scc0 K3_NOPRE5
    s_mov_b32 s11, 5120
    buffer_load_dwordx4 v[228:231], v107, s[56:59], s11 offen
    s_mov_b32 s11, 21504
    buffer_load_dwordx4 v[232:235], v107, s[56:59], s11 offen
    s_mov_b32 s11, 37888
    buffer_load_dwordx4 v[236:239], v107, s[56:59], s11 offen
    s_mov_b32 s11, 54272
    buffer_load_dwordx4 v[240:243], v107, s[56:59], s11 offen
K3_NOPRE5:
    s_cmp_eq_u64 s[48:49], 0
    s_cbranch_scc1 K3_RENORM_RET5
    s_getpc_b64 s[52:53]
    s_branch K3_RENORM
K3_RENORM_RET5:
    ds_read_b128 v[80:83], v2 offset:22528
    s_mov_b64 exec, s[44:45]
    ds_read_b128 v[96:99], v3 offset:21504
    ds_read_b128 v[100:103], v3 offset:22016
    s_mov_b64 exec, -1
    s_waitcnt lgkmcnt(3)
    v_mfma_f32_32x32x16_bf16 v[40:55], v[84:87], v[4:7], v[8:23]
    v_exp_f32 v24, v24
    v_exp_f32 v25, v25
    v_exp_f32 v26, v26
    v_exp_f32 v27, v27
    v_exp_f32 v28, v28
    v_exp_f32 v29, v29
    v_exp_f32 v30, v30
    v_exp_f32 v31, v31
    v_exp_f32 v32, v32
    v_cvt_pk_bf16_f32 v56, v24, v25
    v_exp_f32 v33, v33
    v_cvt_pk_bf16_f32 v57, v26, v27
    v_exp_f32 v34, v34
    v_cvt_pk_bf16_f32 v58, v28, v29
    v_exp_f32 v35, v35
    v_cvt_pk_bf16_f32 v59, v30, v31
    v_exp_f32 v36, v36
    v_exp_f32 v37, v37
    v_mfma_f32_32x32x16_bf16 v[64:79], v[88:91], v[56:59], v[64:79]
    v_exp_f32 v38, v38
    v_exp_f32 v39, v39
    v_cvt_pk_bf16_f32 v60, v32, v33
    v_cvt_pk_bf16_f32 v61, v34, v35
    v_cvt_pk_bf16_f32 v62, v36, v37
    v_cvt_pk_bf16_f32 v63, v38, v39
    s_nop 1
    v_mfma_f32_32x32x16_bf16 v[64:79], v[92:95], v[60:63], v[64:79]
    ds_read_b128 v[84:87], v2 offset:23552
    s_mov_b64 exec, s[44:45]
    ds_read_b128 v[88:91], v3 offset:22528
    ds_read_b128 v[92:95], v3 offset:23040
    s_mov_b64 exec, -1
    s_waitcnt lgkmcnt(3)
    v_mfma_f32_32x32x16_bf16 v[24:39], v[80:83], v[4:7], v[8:23]
    v_exp_f32 v40, v40
    v_exp_f32 v41, v41
    v_exp_f32 v42, v42
    v_exp_f32 v43, v43
    v_exp_f32 v44, v44
    v_exp_f32 v45, v45
    v_exp_f32 v46, v46
    v_exp_f32 v47, v47
    v_exp_f32 v48, v48
    v_cvt_pk_bf16_f32 v56, v40, v41
    v_exp_f32 v49, v49
    v_cvt_pk_bf16_f32 v57, v42, v43
    v_exp_f32 v50, v50
    v_cvt_pk_bf16_f32 v58, v44, v45
    v_exp_f32 v51, v51
    v_cvt_pk_bf16_f32 v59, v46, v47
    v_exp_f32 v52, v52
    v_exp_f32 v53, v53
    v_mfma_f32_32x32x16_bf16 v[64:79], v[96:99], v[56:59], v[64:79]
    v_exp_f32 v54, v54
    v_exp_f32 v55, v55
    v_cvt_pk_bf16_f32 v60, v48, v49
    v_cvt_pk_bf16_f32 v61, v50, v51
    v_cvt_pk_bf16_f32 v62, v52, v53
    v_cvt_pk_bf16_f32 v63, v54, v55
    s_nop 1
    v_mfma_f32_32x32x16_bf16 v[64:79], v[100:103], v[60:63], v[64:79]
    ds_read_b128 v[80:83], v2 offset:24576
    s_mov_b64 exec, s[44:45]
    ds_read_b128 v[96:99], v3 offset:23552
    ds_read_b128 v[100:103], v3 offset:24064
    s_mov_b64 exec, -1
    s_waitcnt lgkmcnt(3)
    v_mfma_f32_32x32x16_bf16 v[40:55], v[84:87], v[4:7], v[8:23]
    v_exp_f32 v24, v24
    v_exp_f32 v25, v25
    v_exp_f32 v26, v26
    v_exp_f32 v27, v27
    v_exp_f32 v28, v28
    v_exp_f32 v29, v29
    v_exp_f32 v30, v30
    v_exp_f32 v31, v31
    v_exp_f32 v32, v32
    v_cvt_pk_bf16_f32 v56, v24, v25
    v_exp_f32 v33, v33
    v_cvt_pk_bf16_f32 v57, v26, v27
    v_exp_f32 v34, v34
    v_cvt_pk_bf16_f32 v58, v28, v29
    v_exp_f32 v35, v35
    v_cvt_pk_bf16_f32 v59, v30, v31
    v_exp_f32 v36, v36
    v_exp_f32 v37, v37
    v_mfma_f32_32x32x16_bf16 v[64:79], v[88:91], v[56:59], v[64:79]
    v_exp_f32 v38, v38
    v_exp_f32 v39, v39
    v_cvt_pk_bf16_f32 v60, v32, v33
    v_cvt_pk_bf16_f32 v61, v34, v35
    v_cvt_pk_bf16_f32 v62, v36, v37
    v_cvt_pk_bf16_f32 v63, v38, v39
    s_nop 1
    v_mfma_f32_32x32x16_bf16 v[64:79], v[92:95], v[60:63], v[64:79]
    ds_read_b128 v[84:87], v2 offset:25600
    s_mov_b64 exec, s[44:45]
    ds_read_b128 v[88:91], v3 offset:24576
    ds_read_b128 v[92:95], v3 offset:25088
    s_mov_b64 exec, -1
    s_waitcnt lgkmcnt(3)
    v_mfma_f32_32x32x16_bf16 v[24:39], v[80:83], v[4:7], v[8:23]
    v_exp_f32 v40, v40
    v_exp_f32 v41, v41
    v_exp_f32 v42, v42
    v_exp_f32 v43, v43
    v_exp_f32 v44, v44
    v_exp_f32 v45, v45
    v_exp_f32 v46, v46
    v_exp_f32 v47, v47
    v_exp_f32 v48, v48
    v_cvt_pk_bf16_f32 v56, v40, v41
    v_exp_f32 v49, v49
    v_cvt_pk_bf16_f32 v57, v42, v43
    v_exp_f32 v50, v50
    v_cvt_pk_bf16_f32 v58, v44, v45
    v_exp_f32 v51, v51
    v_cvt_pk_bf16_f32 v59, v46, v47
    v_exp_f32 v52, v52
    v_exp_f32 v53, v53
    v_cmp_lt_f32 s[48:49], s89, v72
    v_mfma_f32_32x32x16_bf16 v[64:79], v[96:99], v[56:59], v[64:79]
    v_exp_f32 v54, v54
    v_exp_f32 v55, v55
    v_cvt_pk_bf16_f32 v60, v48, v49
    v_cvt_pk_bf16_f32 v61, v50, v51
    v_cvt_pk_bf16_f32 v62, v52, v53
    v_cvt_pk_bf16_f32 v63, v54, v55
    s_nop 1
    v_mfma_f32_32x32x16_bf16 v[64:79], v[100:103], v[60:63], v[64:79]
    s_cmp_eq_u32 s46, 0
    s_cbranch_scc0 K3_NOPRE6
    s_mov_b32 s11, 6144
    buffer_load_dwordx4 v[244:247], v107, s[56:59], s11 offen
    s_mov_b32 s11, 22528
    buffer_load_dwordx4 v[248:251], v107, s[56:59], s11 offen
    s_mov_b32 s11, 38912
    buffer_load_dwordx4 v[252:255], v107, s[56:59], s11 offen
K3_NOPRE6:
    s_cmp_eq_u64 s[48:49], 0
    s_cbranch_scc1 K3_RENORM_RET6
    s_getpc_b64 s[52:53]
    s_branch K3_RENORM
K3_RENORM_RET6:
    ds_read_b128 v[80:83], v2 offset:26624
    s_mov_b64 exec, s[44:45]
    ds_read_b128 v[96:99], v3 offset:25600
    ds_read_b128 v[100:103], v3 offset:26112
    s_mov_b64 exec, -1
    s_waitcnt lgkmcnt(3)
    v_mfma_f32_32x32x16_bf16 v[40:55], v[84:87], v[4:7], v[8:23]
    v_exp_f32 v24, v24
    v_exp_f32 v25, v25
    v_exp_f32 v26, v26
    v_exp_f32 v27, v27
    v_exp_f32 v28, v28
    v_exp_f32 v29, v29
    v_exp_f32 v30, v30
    v_exp_f32 v31, v31
    v_exp_f32 v32, v32
    v_cvt_pk_bf16_f32 v56, v24, v25
    v_exp_f32 v33, v33
    v_cvt_pk_bf16_f32 v57, v26, v27
    v_exp_f32 v34, v34
    v_cvt_pk_bf16_f32 v58, v28, v29
    v_exp_f32 v35, v35
    v_cvt_pk_bf16_f32 v59, v30, v31
    v_exp_f32 v36, v36
    v_exp_f32 v37, v37
    v_mfma_f32_32x32x16_bf16 v[64:79], v[88:91], v[56:59], v[64:79]
    v_exp_f32 v38, v38
    v_exp_f32 v39, v39
    v_cvt_pk_bf16_f32 v60, v32, v33
    v_cvt_pk_bf16_f32 v61, v34, v35
    v_cvt_pk_bf16_f32 v62, v36, v37
    v_cvt_pk_bf16_f32 v63, v38, v39
    s_nop 1
    v_mfma_f32_32x32x16_bf16 v[64:79], v[92:95], v[60:63], v[64:79]
    ds_read_b128 v[84:87], v2 offset:27648
    s_mov_b64 exec, s[44:45]
    ds_read_b128 v[88:91], v3 offset:26624
    ds_read_b128 v[92:95], v3 offset:27136
    s_mov_b64 exec, -1
    s_waitcnt lgkmcnt(3)
    v_mfma_f32_32x32x16_bf16 v[24:39], v[80:83], v[4:7], v[8:23]
    v_exp_f32 v40, v40
    v_exp_f32 v41, v41
    v_exp_f32 v42, v42
    v_exp_f32 v43, v43
    v_exp_f32 v44, v44
    v_exp_f32 v45, v45
    v_exp_f32 v46, v46
    v_exp_f32 v47, v47
    v_exp_f32 v48, v48
    v_cvt_pk_bf16_f32 v56, v40, v41
    v_exp_f32 v49, v49
    v_cvt_pk_bf16_f32 v57, v42, v43
    v_exp_f32 v50, v50
    v_cvt_pk_bf16_f32 v58, v44, v45
    v_exp_f32 v51, v51
    v_cvt_pk_bf16_f32 v59, v46, v47
    v_exp_f32 v52, v52
    v_exp_f32 v53, v53
    v_mfma_f32_32x32x16_bf16 v[64:79], v[96:99], v[56:59], v[64:79]
    v_exp_f32 v54, v54
    v_exp_f32 v55, v55
    v_cvt_pk_bf16_f32 v60, v48, v49
    v_cvt_pk_bf16_f32 v61, v50, v51
    v_cvt_pk_bf16_f32 v62, v52, v53
    v_cvt_pk_bf16_f32 v63, v54, v55
    s_nop 1
    v_mfma_f32_32x32x16_bf16 v[64:79], v[100:103], v[60:63], v[64:79]
    s_setprio 2
    ds_read_b128 v[80:83], v2 offset:28672
    s_mov_b64 exec, s[44:45]
    ds_read_b128 v[96:99], v3 offset:27648
    ds_read_b128 v[100:103], v3 offset:28160
    s_mov_b64 exec, -1
    s_waitcnt lgkmcnt(3)
    v_mfma_f32_32x32x16_bf16 v[40:55], v[84:87], v[4:7], v[8:23]
    v_exp_f32 v24, v24
    v_exp_f32 v25, v25
    v_exp_f32 v26, v26
    v_exp_f32 v27, v27
    v_exp_f32 v28, v28
    v_exp_f32 v29, v29
    v_exp_f32 v30, v30
    v_exp_f32 v31, v31
    v_exp_f32 v32, v32
    v_cvt_pk_bf16_f32 v56, v24, v25
    v_exp_f32 v33, v33
    v_cvt_pk_bf16_f32 v57, v26, v27
    v_exp_f32 v34, v34
    v_cvt_pk_bf16_f32 v58, v28, v29
    v_exp_f32 v35, v35
    v_cvt_pk_bf16_f32 v59, v30, v31
    v_exp_f32 v36, v36
    v_exp_f32 v37, v37
    v_mfma_f32_32x32x16_bf16 v[64:79], v[88:91], v[56:59], v[64:79]
    v_exp_f32 v38, v38
    v_exp_f32 v39, v39
    v_cvt_pk_bf16_f32 v60, v32, v33
    v_cvt_pk_bf16_f32 v61, v34, v35
    v_cvt_pk_bf16_f32 v62, v36, v37
    v_cvt_pk_bf16_f32 v63, v38, v39
    s_nop 1
    v_mfma_f32_32x32x16_bf16 v[64:79], v[92:95], v[60:63], v[64:79]
    ds_read_b128 v[84:87], v2 offset:29696
    s_mov_b64 exec, s[44:45]
    ds_read_b128 v[88:91], v3 offset:28672
    ds_read_b128 v[92:95], v3 offset:29184
    s_mov_b64 exec, -1
    s_waitcnt lgkmcnt(3)
    v_mfma_f32_32x32x16_bf16 v[24:39], v[80:83], v[4:7], v[8:23]
    v_exp_f32 v40, v40
    v_exp_f32 v41, v41
    v_exp_f32 v42, v42
    v_exp_f32 v43, v43
    v_exp_f32 v44, v44
    v_exp_f32 v45, v45
    v_exp_f32 v46, v46
    v_exp_f32 v47, v47
    v_exp_f32 v48, v48
    v_cvt_pk_bf16_f32 v56, v40, v41
    v_exp_f32 v49, v49
    v_cvt_pk_bf16_f32 v57, v42, v43
    v_exp_f32 v50, v50
    v_cvt_pk_bf16_f32 v58, v44, v45
    v_exp_f32 v51, v51
    v_cvt_pk_bf16_f32 v59, v46, v47
    v_exp_f32 v52, v52
    v_exp_f32 v53, v53
    v_cmp_lt_f32 s[48:49], s89, v72
    v_mfma_f32_32x32x16_bf16 v[64:79], v[96:99], v[56:59], v[64:79]
    v_exp_f32 v54, v54
    v_exp_f32 v55, v55
    v_cvt_pk_bf16_f32 v60, v48, v49
    v_cvt_pk_bf16_f32 v61, v50, v51
    v_cvt_pk_bf16_f32 v62, v52, v53
    v_cvt_pk_bf16_f32 v63, v54, v55
    s_nop 1
    v_mfma_f32_32x32x16_bf16 v[64:79], v[100:103], v[60:63], v[64:79]
    s_cmp_eq_u64 s[48:49], 0
    s_cbranch_scc1 K3_RENORM_RET7
    s_getpc_b64 s[52:53]
    s_branch K3_RENORM
K3_RENORM_RET7:
    ds_read_b128 v[80:83], v2 offset:30720
    s_mov_b64 exec, s[44:45]
    ds_read_b128 v[96:99], v3 offset:29696
    ds_read_b128 v[100:103], v3 offset:30208
    s_mov_b64 exec, -1
    s_waitcnt lgkmcnt(3)
    v_mfma_f32_32x32x16_bf16 v[40:55], v[84:87], v[4:7], v[8:23]
    v_exp_f32 v24, v24
    v_exp_f32 v25, v25
    v_exp_f32 v26, v26
    v_exp_f32 v27, v27
    v_exp_f32 v28, v28
    v_exp_f32 v29, v29
    v_exp_f32 v30, v30
    v_exp_f32 v31, v31
    v_exp_f32 v32, v32
    v_cvt_pk_bf16_f32 v56, v24, v25
    v_exp_f32 v33, v33
    v_cvt_pk_bf16_f32 v57, v26, v27
    v_exp_f32 v34, v34
    v_cvt_pk_bf16_f32 v58, v28, v29
    v_exp_f32 v35, v35
    v_cvt_pk_bf16_f32 v59, v30, v31
    v_exp_f32 v36, v36
    v_exp_f32 v37, v37
    v_mfma_f32_32x32x16_bf16 v[64:79], v[88:91], v[56:59], v[64:79]
    v_exp_f32 v38, v38
    v_exp_f32 v39, v39
    v_cvt_pk_bf16_f32 v60, v32, v33
    v_cvt_pk_bf16_f32 v61, v34, v35
    v_cvt_pk_bf16_f32 v62, v36, v37
    v_cvt_pk_bf16_f32 v63, v38, v39
    s_nop 1
    v_mfma_f32_32x32x16_bf16 v[64:79], v[92:95], v[60:63], v[64:79]
    ds_read_b128 v[84:87], v2 offset:31744
    s_mov_b64 exec, s[44:45]
    ds_read_b128 v[88:91], v3 offset:30720
    ds_read_b128 v[92:95], v3 offset:31232
    s_mov_b64 exec, -1
    s_waitcnt lgkmcnt(3)
    v_mfma_f32_32x32x16_bf16 v[24:39], v[80:83], v[4:7], v[8:23]
    v_exp_f32 v40, v40
    v_exp_f32 v41, v41
    v_exp_f32 v42, v42
    v_exp_f32 v43, v43
    v_exp_f32 v44, v44
    v_exp_f32 v45, v45
    v_exp_f32 v46, v46
    v_exp_f32 v47, v47
    v_exp_f32 v48, v48
    v_cvt_pk_bf16_f32 v56, v40, v41
    v_exp_f32 v49, v49
    v_cvt_pk_bf16_f32 v57, v42, v43
    v_exp_f32 v50, v50
    v_cvt_pk_bf16_f32 v58, v44, v45
    v_exp_f32 v51, v51
    v_cvt_pk_bf16_f32 v59, v46, v47
    v_exp_f32 v52, v52
    v_exp_f32 v53, v53
    v_mfma_f32_32x32x16_bf16 v[64:79], v[96:99], v[56:59], v[64:79]
    v_exp_f32 v54, v54
    v_exp_f32 v55, v55
    v_cvt_pk_bf16_f32 v60, v48, v49
    v_cvt_pk_bf16_f32 v61, v50, v51
    v_cvt_pk_bf16_f32 v62, v52, v53
    v_cvt_pk_bf16_f32 v63, v54, v55
    s_nop 1
    v_mfma_f32_32x32x16_bf16 v[64:79], v[100:103], v[60:63], v[64:79]
    s_setprio 1
    ds_read_b128 v[80:83], v2 offset:32768
    s_mov_b64 exec, s[44:45]
    ds_read_b128 v[96:99], v3 offset:31744
    ds_read_b128 v[100:103], v3 offset:32256
    s_mov_b64 exec, -1
    s_waitcnt lgkmcnt(3)
    v_mfma_f32_32x32x16_bf16 v[40:55], v[84:87], v[4:7], v[8:23]
    v_exp_f32 v24, v24
    v_exp_f32 v25, v25
    v_exp_f32 v26, v26
    v_exp_f32 v27, v27
    v_exp_f32 v28, v28
    v_exp_f32 v29, v29
    v_exp_f32 v30, v30
    v_exp_f32 v31, v31
    v_exp_f32 v32, v32
    v_cvt_pk_bf16_f32 v56, v24, v25
    v_exp_f32 v33, v33
    v_cvt_pk_bf16_f32 v57, v26, v27
    v_exp_f32 v34, v34
    v_cvt_pk_bf16_f32 v58, v28, v29
    v_exp_f32 v35, v35
    v_cvt_pk_bf16_f32 v59, v30, v31
    v_exp_f32 v36, v36
    v_exp_f32 v37, v37
    v_mfma_f32_32x32x16_bf16 v[64:79], v[88:91], v[56:59], v[64:79]
    v_exp_f32 v38, v38
    v_exp_f32 v39, v39
    v_cvt_pk_bf16_f32 v60, v32, v33
    v_cvt_pk_bf16_f32 v61, v34, v35
    v_cvt_pk_bf16_f32 v62, v36, v37
    v_cvt_pk_bf16_f32 v63, v38, v39
    s_nop 1
    v_mfma_f32_32x32x16_bf16 v[64:79], v[92:95], v[60:63], v[64:79]
    ds_read_b128 v[84:87], v2 offset:33792
    s_mov_b64 exec, s[44:45]
    ds_read_b128 v[88:91], v3 offset:32768
    ds_read_b128 v[92:95], v3 offset:33280
    s_mov_b64 exec, -1
    s_waitcnt lgkmcnt(3)
    v_mfma_f32_32x32x16_bf16 v[24:39], v[80:83], v[4:7], v[8:23]
    v_exp_f32 v40, v40
    v_exp_f32 v41, v41
    v_exp_f32 v42, v42
    v_exp_f32 v43, v43
    v_exp_f32 v44, v44
    v_exp_f32 v45, v45
    v_exp_f32 v46, v46
    v_exp_f32 v47, v47
    v_exp_f32 v48, v48
    v_cvt_pk_bf16_f32 v56, v40, v41
    v_exp_f32 v49, v49
    v_cvt_pk_bf16_f32 v57, v42, v43
    v_exp_f32 v50, v50
    v_cvt_pk_bf16_f32 v58, v44, v45
    v_exp_f32 v51, v51
    v_cvt_pk_bf16_f32 v59, v46, v47
    v_exp_f32 v52, v52
    v_exp_f32 v53, v53
    v_cmp_lt_f32 s[48:49], s89, v72
    v_mfma_f32_32x32x16_bf16 v[64:79], v[96:99], v[56:59], v[64:79]
    v_exp_f32 v54, v54
    v_exp_f32 v55, v55
    v_cvt_pk_bf16_f32 v60, v48, v49
    v_cvt_pk_bf16_f32 v61, v50, v51
    v_cvt_pk_bf16_f32 v62, v52, v53
    v_cvt_pk_bf16_f32 v63, v54, v55
    s_nop 1
    v_mfma_f32_32x32x16_bf16 v[64:79], v[100:103], v[60:63], v[64:79]
    s_cmp_eq_u32 s46, 0
    s_cbranch_scc0 K3_NOBAR8
    s_barrier
    s_mul_i32 s11, s3, 4096
    s_add_u32 m0, s11, 0
    s_mov_b32 s11, 55296
    buffer_load_dwordx4 v107, s[56:59], s11 offen lds
    s_mul_i32 s11, s3, 4096
    s_add_u32 m0, s11, 1024
    s_mov_b32 s11, 7168
    buffer_load_dwordx4 v107, s[56:59], s11 offen lds
    s_mul_i32 s11, s3, 4096
    s_add_u32 m0, s11, 2048
    s_mov_b32 s11, 23552
    buffer_load_dwordx4 v107, s[56:59], s11 offen lds
    s_mul_i32 s11, s3, 4096
    s_add_u32 m0, s11, 3072
    s_mov_b32 s11, 39936
    buffer_load_dwordx4 v107, s[56:59], s11 offen lds
    s_mul_i32 s11, s3, 4096
    s_add_u32 m0, s11, 65536
    s_mov_b32 s11, 56320
    buffer_load_dwordx4 v107, s[56:59], s11 offen lds
    s_mul_i32 s11, s3, 4096
    s_add_u32 m0, s11, 66560
    s_mov_b32 s11, 8192
    buffer_load_dwordx4 v107, s[56:59], s11 offen lds
    s_mul_i32 s11, s3, 4096
    s_add_u32 m0, s11, 67584
    s_mov_b32 s11, 24576
    buffer_load_dwordx4 v107, s[56:59], s11 offen lds
    s_mul_i32 s11, s3, 4096
    s_add_u32 m0, s11, 68608
    s_mov_b32 s11, 40960
    buffer_load_dwordx4 v107, s[56:59], s11 offen lds
K3_NOBAR8:
    s_cmp_eq_u64 s[48:49], 0
    s_cbranch_scc1 K3_RENORM_RET8
    s_getpc_b64 s[52:53]
    s_branch K3_RENORM
K3_RENORM_RET8:
    s_setprio 3
    ds_read_b128 v[80:83], v2 offset:34816
    s_mov_b64 exec, s[44:45]
    ds_read_b128 v[96:99], v3 offset:33792
    ds_read_b128 v[100:103], v3 offset:34304
    s_mov_b64 exec, -1
    s_waitcnt lgkmcnt(3)
    v_mfma_f32_32x32x16_bf16 v[40:55], v[84:87], v[4:7], v[8:23]
    v_exp_f32 v24, v24
    v_exp_f32 v25, v25
    v_exp_f32 v26, v26
    v_exp_f32 v27, v27
    v_exp_f32 v28, v28
    v_exp_f32 v29, v29
    v_exp_f32 v30, v30
    v_exp_f32 v31, v31
    v_exp_f32 v32, v32
    v_cvt_pk_bf16_f32 v56, v24, v25
    v_exp_f32 v33, v33
    v_cvt_pk_bf16_f32 v57, v26, v27
    v_exp_f32 v34, v34
    v_cvt_pk_bf16_f32 v58, v28, v29
    v_exp_f32 v35, v35
    v_cvt_pk_bf16_f32 v59, v30, v31
    v_exp_f32 v36, v36
    v_exp_f32 v37, v37
    v_mfma_f32_32x32x16_bf16 v[64:79], v[88:91], v[56:59], v[64:79]
    v_exp_f32 v38, v38
    v_exp_f32 v39, v39
    v_cvt_pk_bf16_f32 v60, v32, v33
    v_cvt_pk_bf16_f32 v61, v34, v35
    v_cvt_pk_bf16_f32 v62, v36, v37
    v_cvt_pk_bf16_f32 v63, v38, v39
    s_nop 1
    v_mfma_f32_32x32x16_bf16 v[64:79], v[92:95], v[60:63], v[64:79]
    ds_read_b128 v[84:87], v2 offset:35840
    s_mov_b64 exec, s[44:45]
    ds_read_b128 v[88:91], v3 offset:34816
    ds_read_b128 v[92:95], v3 offset:35328
    s_mov_b64 exec, -1
    s_waitcnt lgkmcnt(3)
    v_mfma_f32_32x32x16_bf16 v[24:39], v[80:83], v[4:7], v[8:23]
    v_exp_f32 v40, v40
    v_exp_f32 v41, v41
    v_exp_f32 v42, v42
    v_exp_f32 v43, v43
    v_exp_f32 v44, v44
    v_exp_f32 v45, v45
    v_exp_f32 v46, v46
    v_exp_f32 v47, v47
    v_exp_f32 v48, v48
    v_cvt_pk_bf16_f32 v56, v40, v41
    v_exp_f32 v49, v49
    v_cvt_pk_bf16_f32 v57, v42, v43
    v_exp_f32 v50, v50
    v_cvt_pk_bf16_f32 v58, v44, v45
    v_exp_f32 v51, v51
    v_cvt_pk_bf16_f32 v59, v46, v47
    v_exp_f32 v52, v52
    v_exp_f32 v53, v53
    v_mfma_f32_32x32x16_bf16 v[64:79], v[96:99], v[56:59], v[64:79]
    v_exp_f32 v54, v54
    v_exp_f32 v55, v55
    v_cvt_pk_bf16_f32 v60, v48, v49
    v_cvt_pk_bf16_f32 v61, v50, v51
    v_cvt_pk_bf16_f32 v62, v52, v53
    v_cvt_pk_bf16_f32 v63, v54, v55
    s_nop 1
    v_mfma_f32_32x32x16_bf16 v[64:79], v[100:103], v[60:63], v[64:79]
    ds_read_b128 v[80:83], v2 offset:36864
    s_mov_b64 exec, s[44:45]
    ds_read_b128 v[96:99], v3 offset:35840
    ds_read_b128 v[100:103], v3 offset:36352
    s_mov_b64 exec, -1
    s_waitcnt lgkmcnt(3)
    v_mfma_f32_32x32x16_bf16 v[40:55], v[84:87], v[4:7], v[8:23]
    v_exp_f32 v24, v24
    v_exp_f32 v25, v25
    v_exp_f32 v26, v26
    v_exp_f32 v27, v27
    v_exp_f32 v28, v28
    v_exp_f32 v29, v29
    v_exp_f32 v30, v30
    v_exp_f32 v31, v31
    v_exp_f32 v32, v32
    v_cvt_pk_bf16_f32 v56, v24, v25
    v_exp_f32 v33, v33
    v_cvt_pk_bf16_f32 v57, v26, v27
    v_exp_f32 v34, v34
    v_cvt_pk_bf16_f32 v58, v28, v29
    v_exp_f32 v35, v35
    v_cvt_pk_bf16_f32 v59, v30, v31
    v_exp_f32 v36, v36
    v_exp_f32 v37, v37
    v_mfma_f32_32x32x16_bf16 v[64:79], v[88:91], v[56:59], v[64:79]
    v_exp_f32 v38, v38
    v_exp_f32 v39, v39
    v_cvt_pk_bf16_f32 v60, v32, v33
    v_cvt_pk_bf16_f32 v61, v34, v35
    v_cvt_pk_bf16_f32 v62, v36, v37
    v_cvt_pk_bf16_f32 v63, v38, v39
    s_nop 1
    v_mfma_f32_32x32x16_bf16 v[64:79], v[92:95], v[60:63], v[64:79]
    ds_read_b128 v[84:87], v2 offset:37888
    s_mov_b64 exec, s[44:45]
    ds_read_b128 v[88:91], v3 offset:36864
    ds_read_b128 v[92:95], v3 offset:37376
    s_mov_b64 exec, -1
    s_waitcnt lgkmcnt(3)
    v_mfma_f32_32x32x16_bf16 v[24:39], v[80:83], v[4:7], v[8:23]
    v_exp_f32 v40, v40
    v_exp_f32 v41, v41
    v_exp_f32 v42, v42
    v_exp_f32 v43, v43
    v_exp_f32 v44, v44
    v_exp_f32 v45, v45
    v_exp_f32 v46, v46
    v_exp_f32 v47, v47
    v_exp_f32 v48, v48
    v_cvt_pk_bf16_f32 v56, v40, v41
    v_exp_f32 v49, v49
    v_cvt_pk_bf16_f32 v57, v42, v43
    v_exp_f32 v50, v50
    v_cvt_pk_bf16_f32 v58, v44, v45
    v_exp_f32 v51, v51
    v_cvt_pk_bf16_f32 v59, v46, v47
    v_exp_f32 v52, v52
    v_exp_f32 v53, v53
    v_cmp_lt_f32 s[48:49], s89, v72
    v_mfma_f32_32x32x16_bf16 v[64:79], v[96:99], v[56:59], v[64:79]
    v_exp_f32 v54, v54
    v_exp_f32 v55, v55
    v_cvt_pk_bf16_f32 v60, v48, v49
    v_cvt_pk_bf16_f32 v61, v50, v51
    v_cvt_pk_bf16_f32 v62, v52, v53
    v_cvt_pk_bf16_f32 v63, v54, v55
    s_nop 1
    v_mfma_f32_32x32x16_bf16 v[64:79], v[100:103], v[60:63], v[64:79]
    s_cmp_eq_u32 s46, 0
    s_cbranch_scc0 K3_NOPF
    s_and_b32 s7, s4, 1
    s_lshl_b32 s8, s5, 3
    s_add_u32 s8, s8, s3
    v_min_u32 v106, 55, v1
    v_mul_u32_u24 v108, 2341, v106
    v_lshrrev_b32 v108, 16, v108
    v_mul_u32_u24 v109, 28, v108
    v_sub_u32 v109, v106, v109
    v_lshlrev_b32 v109, 6, v109
    s_lshl_b32 s9, s8, 1
    v_add_u32 v108, s9, v108
    v_mul_u32_u24 v108, 3584, v108
    v_add_u32 v108, v108, v109
    s_mul_i32 s9, s7, 1792
    v_add_u32 v108, s9, v108
    global_load_dword v146, v108, s[28:29]
    global_load_dword v146, v108, s[30:31]
    v_lshrrev_b32 v108, 3, v106
    s_mul_i32 s9, s8, 7
    v_add_u32 v108, s9, v108
    v_lshlrev_b32 v108, 10, v108
    v_and_b32 v109, 7, v106
    v_lshl_add_u32 v108, v109, 6, v108
    s_lshl_b32 s9, s7, 9
    v_add_u32 v108, s9, v108
    global_load_dword v146, v108, s[32:33]
K3_NOPF:
    s_cmp_eq_u64 s[48:49], 0
    s_cbranch_scc1 K3_RENORM_RET9
    s_getpc_b64 s[52:53]
    s_branch K3_RENORM
K3_RENORM_RET9:
    ds_read_b128 v[80:83], v2 offset:38912
    s_mov_b64 exec, s[44:45]
    ds_read_b128 v[96:99], v3 offset:37888
    ds_read_b128 v[100:103], v3 offset:38400
    s_mov_b64 exec, -1
    s_waitcnt lgkmcnt(3)
    v_mfma_f32_32x32x16_bf16 v[40:55], v[84:87], v[4:7], v[8:23]
    v_exp_f32 v24, v24
    v_exp_f32 v25, v25
    v_exp_f32 v26, v26
    v_exp_f32 v27, v27
    v_exp_f32 v28, v28
    v_exp_f32 v29, v29
    v_exp_f32 v30, v30
    v_exp_f32 v31, v31
    v_exp_f32 v32, v32
    v_cvt_pk_bf16_f32 v56, v24, v25
    v_exp_f32 v33, v33
    v_cvt_pk_bf16_f32 v57, v26, v27
    v_exp_f32 v34, v34
    v_cvt_pk_bf16_f32 v58, v28, v29
    v_exp_f32 v35, v35
    v_cvt_pk_bf16_f32 v59, v30, v31
    v_exp_f32 v36, v36
    v_exp_f32 v37, v37
    v_mfma_f32_32x32x16_bf16 v[64:79], v[88:91], v[56:59], v[64:79]
    v_exp_f32 v38, v38
    v_exp_f32 v39, v39
    v_cvt_pk_bf16_f32 v60, v32, v33
    v_cvt_pk_bf16_f32 v61, v34, v35
    v_cvt_pk_bf16_f32 v62, v36, v37
    v_cvt_pk_bf16_f32 v63, v38, v39
    s_nop 1
    v_mfma_f32_32x32x16_bf16 v[64:79], v[92:95], v[60:63], v[64:79]
    ds_read_b128 v[84:87], v2 offset:39936
    s_mov_b64 exec, s[44:45]
    ds_read_b128 v[88:91], v3 offset:38912
    ds_read_b128 v[92:95], v3 offset:39424
    s_mov_b64 exec, -1
    s_waitcnt lgkmcnt(3)
    v_mfma_f32_32x32x16_bf16 v[24:39], v[80:83], v[4:7], v[8:23]
    v_exp_f32 v40, v40
    v_exp_f32 v41, v41
    v_exp_f32 v42, v42
    v_exp_f32 v43, v43
    v_exp_f32 v44, v44
    v_exp_f32 v45, v45
    v_exp_f32 v46, v46
    v_exp_f32 v47, v47
    v_exp_f32 v48, v48
    v_cvt_pk_bf16_f32 v56, v40, v41
    v_exp_f32 v49, v49
    v_cvt_pk_bf16_f32 v57, v42, v43
    v_exp_f32 v50, v50
    v_cvt_pk_bf16_f32 v58, v44, v45
    v_exp_f32 v51, v51
    v_cvt_pk_bf16_f32 v59, v46, v47
    v_exp_f32 v52, v52
    v_exp_f32 v53, v53
    v_mfma_f32_32x32x16_bf16 v[64:79], v[96:99], v[56:59], v[64:79]
    v_exp_f32 v54, v54
    v_exp_f32 v55, v55
    v_cvt_pk_bf16_f32 v60, v48, v49
    v_cvt_pk_bf16_f32 v61, v50, v51
    v_cvt_pk_bf16_f32 v62, v52, v53
    v_cvt_pk_bf16_f32 v63, v54, v55
    s_nop 1
    v_mfma_f32_32x32x16_bf16 v[64:79], v[100:103], v[60:63], v[64:79]
    ds_read_b128 v[80:83], v2 offset:40960
    s_mov_b64 exec, s[44:45]
    ds_read_b128 v[96:99], v3 offset:39936
    ds_read_b128 v[100:103], v3 offset:40448
    s_mov_b64 exec, -1
    s_waitcnt lgkmcnt(3)
    v_mfma_f32_32x32x16_bf16 v[40:55], v[84:87], v[4:7], v[8:23]
    v_exp_f32 v24, v24
    v_exp_f32 v25, v25
    v_exp_f32 v26, v26
    v_exp_f32 v27, v27
    v_exp_f32 v28, v28
    v_exp_f32 v29, v29
    v_exp_f32 v30, v30
    v_exp_f32 v31, v31
    v_exp_f32 v32, v32
    v_cvt_pk_bf16_f32 v56, v24, v25
    v_exp_f32 v33, v33
    v_cvt_pk_bf16_f32 v57, v26, v27
    v_exp_f32 v34, v34
    v_cvt_pk_bf16_f32 v58, v28, v29
    v_exp_f32 v35, v35
    v_cvt_pk_bf16_f32 v59, v30, v31
    v_exp_f32 v36, v36
    v_exp_f32 v37, v37
    v_mfma_f32_32x32x16_bf16 v[64:79], v[88:91], v[56:59], v[64:79]
    v_exp_f32 v38, v38
    v_exp_f32 v39, v39
    v_cvt_pk_bf16_f32 v60, v32, v33
    v_cvt_pk_bf16_f32 v61, v34, v35
    v_cvt_pk_bf16_f32 v62, v36, v37
    v_cvt_pk_bf16_f32 v63, v38, v39
    s_nop 1
    v_mfma_f32_32x32x16_bf16 v[64:79], v[92:95], v[60:63], v[64:79]
    ds_read_b128 v[84:87], v2 offset:41984
    s_mov_b64 exec, s[44:45]
    ds_read_b128 v[88:91], v3 offset:40960
    ds_read_b128 v[92:95], v3 offset:41472
    s_mov_b64 exec, -1
    s_waitcnt lgkmcnt(3)
    v_mfma_f32_32x32x16_bf16 v[24:39], v[80:83], v[4:7], v[8:23]
    v_exp_f32 v40, v40
    v_exp_f32 v41, v41
    v_exp_f32 v42, v42
    v_exp_f32 v43, v43
    v_exp_f32 v44, v44
    v_exp_f32 v45, v45
    v_exp_f32 v46, v46
    v_exp_f32 v47, v47
    v_exp_f32 v48, v48
    v_cvt_pk_bf16_f32 v56, v40, v41
    v_exp_f32 v49, v49
    v_cvt_pk_bf16_f32 v57, v42, v43
    v_exp_f32 v50, v50
    v_cvt_pk_bf16_f32 v58, v44, v45
    v_exp_f32 v51, v51
    v_cvt_pk_bf16_f32 v59, v46, v47
    v_exp_f32 v52, v52
    v_exp_f32 v53, v53
    v_cmp_lt_f32 s[48:49], s89, v72
    v_mfma_f32_32x32x16_bf16 v[64:79], v[96:99], v[56:59], v[64:79]
    v_exp_f32 v54, v54
    v_exp_f32 v55, v55
    v_cvt_pk_bf16_f32 v60, v48, v49
    v_cvt_pk_bf16_f32 v61, v50, v51
    v_cvt_pk_bf16_f32 v62, v52, v53
    v_cvt_pk_bf16_f32 v63, v54, v55
    s_nop 1
    v_mfma_f32_32x32x16_bf16 v[64:79], v[100:103], v[60:63], v[64:79]
    s_cmp_eq_u64 s[48:49], 0
    s_cbranch_scc1 K3_RENORM_RET10
    s_getpc_b64 s[52:53]
    s_branch K3_RENORM
K3_RENORM_RET10:
    ds_read_b128 v[80:83], v2 offset:43008
    s_mov_b64 exec, s[44:45]
    ds_read_b128 v[96:99], v3 offset:41984
    ds_read_b128 v[100:103], v3 offset:42496
    s_mov_b64 exec, -1
    s_waitcnt lgkmcnt(3)
    v_mfma_f32_32x32x16_bf16 v[40:55], v[84:87], v[4:7], v[8:23]
    v_exp_f32 v24, v24
    v_exp_f32 v25, v25
    v_exp_f32 v26, v26
    v_exp_f32 v27, v27
    v_exp_f32 v28, v28
    v_exp_f32 v29, v29
    v_exp_f32 v30, v30
    v_exp_f32 v31, v31
    v_exp_f32 v32, v32
    v_cvt_pk_bf16_f32 v56, v24, v25
    v_exp_f32 v33, v33
    v_cvt_pk_bf16_f32 v57, v26, v27
    v_exp_f32 v34, v34
    v_cvt_pk_bf16_f32 v58, v28, v29
    v_exp_f32 v35, v35
    v_cvt_pk_bf16_f32 v59, v30, v31
    v_exp_f32 v36, v36
    v_exp_f32 v37, v37
    v_mfma_f32_32x32x16_bf16 v[64:79], v[88:91], v[56:59], v[64:79]
    v_exp_f32 v38, v38
    v_exp_f32 v39, v39
    v_cvt_pk_bf16_f32 v60, v32, v33
    v_cvt_pk_bf16_f32 v61, v34, v35
    v_cvt_pk_bf16_f32 v62, v36, v37
    v_cvt_pk_bf16_f32 v63, v38, v39
    s_nop 1
    v_mfma_f32_32x32x16_bf16 v[64:79], v[92:95], v[60:63], v[64:79]
    ds_read_b128 v[84:87], v2 offset:44032
    s_mov_b64 exec, s[44:45]
    ds_read_b128 v[88:91], v3 offset:43008
    ds_read_b128 v[92:95], v3 offset:43520
    s_mov_b64 exec, -1
    s_waitcnt lgkmcnt(3)
    v_mfma_f32_32x32x16_bf16 v[24:39], v[80:83], v[4:7], v[8:23]
    v_exp_f32 v40, v40
    v_exp_f32 v41, v41
    v_exp_f32 v42, v42
    v_exp_f32 v43, v43
    v_exp_f32 v44, v44
    v_exp_f32 v45, v45
    v_exp_f32 v46, v46
    v_exp_f32 v47, v47
    v_exp_f32 v48, v48
    v_cvt_pk_bf16_f32 v56, v40, v41
    v_exp_f32 v49, v49
    v_cvt_pk_bf16_f32 v57, v42, v43
    v_exp_f32 v50, v50
    v_cvt_pk_bf16_f32 v58, v44, v45
    v_exp_f32 v51, v51
    v_cvt_pk_bf16_f32 v59, v46, v47
    v_exp_f32 v52, v52
    v_exp_f32 v53, v53
    v_mfma_f32_32x32x16_bf16 v[64:79], v[96:99], v[56:59], v[64:79]
    v_exp_f32 v54, v54
    v_exp_f32 v55, v55
    v_cvt_pk_bf16_f32 v60, v48, v49
    v_cvt_pk_bf16_f32 v61, v50, v51
    v_cvt_pk_bf16_f32 v62, v52, v53
    v_cvt_pk_bf16_f32 v63, v54, v55
    s_nop 1
    v_mfma_f32_32x32x16_bf16 v[64:79], v[100:103], v[60:63], v[64:79]
    s_setprio 2
    ds_read_b128 v[80:83], v2 offset:45056
    s_mov_b64 exec, s[44:45]
    ds_read_b128 v[96:99], v3 offset:44032
    ds_read_b128 v[100:103], v3 offset:44544
    s_mov_b64 exec, -1
    s_waitcnt lgkmcnt(3)
    v_mfma_f32_32x32x16_bf16 v[40:55], v[84:87], v[4:7], v[8:23]
    v_exp_f32 v24, v24
    v_exp_f32 v25, v25
    v_exp_f32 v26, v26
    v_exp_f32 v27, v27
    v_exp_f32 v28, v28
    v_exp_f32 v29, v29
    v_exp_f32 v30, v30
    v_exp_f32 v31, v31
    v_exp_f32 v32, v32
    v_cvt_pk_bf16_f32 v56, v24, v25
    v_exp_f32 v33, v33
    v_cvt_pk_bf16_f32 v57, v26, v27
    v_exp_f32 v34, v34
    v_cvt_pk_bf16_f32 v58, v28, v29
    v_exp_f32 v35, v35
    v_cvt_pk_bf16_f32 v59, v30, v31
    v_exp_f32 v36, v36
    v_exp_f32 v37, v37
    v_mfma_f32_32x32x16_bf16 v[64:79], v[88:91], v[56:59], v[64:79]
    v_exp_f32 v38, v38
    v_exp_f32 v39, v39
    v_cvt_pk_bf16_f32 v60, v32, v33
    v_cvt_pk_bf16_f32 v61, v34, v35
    v_cvt_pk_bf16_f32 v62, v36, v37
    v_cvt_pk_bf16_f32 v63, v38, v39
    s_nop 1
    v_mfma_f32_32x32x16_bf16 v[64:79], v[92:95], v[60:63], v[64:79]
    ds_read_b128 v[84:87], v2 offset:46080
    s_mov_b64 exec, s[44:45]
    ds_read_b128 v[88:91], v3 offset:45056
    ds_read_b128 v[92:95], v3 offset:45568
    s_mov_b64 exec, -1
    s_waitcnt lgkmcnt(3)
    v_mfma_f32_32x32x16_bf16 v[24:39], v[80:83], v[4:7], v[8:23]
    v_exp_f32 v40, v40
    v_exp_f32 v41, v41
    v_exp_f32 v42, v42
    v_exp_f32 v43, v43
    v_exp_f32 v44, v44
    v_exp_f32 v45, v45
    v_exp_f32 v46, v46
    v_exp_f32 v47, v47
    v_exp_f32 v48, v48
    v_cvt_pk_bf16_f32 v56, v40, v41
    v_exp_f32 v49, v49
    v_cvt_pk_bf16_f32 v57, v42, v43
    v_exp_f32 v50, v50
    v_cvt_pk_bf16_f32 v58, v44, v45
    v_exp_f32 v51, v51
    v_cvt_pk_bf16_f32 v59, v46, v47
    v_exp_f32 v52, v52
    v_exp_f32 v53, v53
    v_cmp_lt_f32 s[48:49], s89, v72
    v_mfma_f32_32x32x16_bf16 v[64:79], v[96:99], v[56:59], v[64:79]
    v_exp_f32 v54, v54
    v_exp_f32 v55, v55
    v_cvt_pk_bf16_f32 v60, v48, v49
    v_cvt_pk_bf16_f32 v61, v50, v51
    v_cvt_pk_bf16_f32 v62, v52, v53
    v_cvt_pk_bf16_f32 v63, v54, v55
    s_nop 1
    v_mfma_f32_32x32x16_bf16 v[64:79], v[100:103], v[60:63], v[64:79]
    s_cmp_eq_u64 s[48:49], 0
    s_cbranch_scc1 K3_RENORM_RET11
    s_getpc_b64 s[52:53]
    s_branch K3_RENORM
K3_RENORM_RET11:
    ds_read_b128 v[80:83], v2 offset:47104
    s_mov_b64 exec, s[44:45]
    ds_read_b128 v[96:99], v3 offset:46080
    ds_read_b128 v[100:103], v3 offset:46592
    s_mov_b64 exec, -1
    s_waitcnt lgkmcnt(3)
    v_mfma_f32_32x32x16_bf16 v[40:55], v[84:87], v[4:7], v[8:23]
    v_exp_f32 v24, v24
    v_exp_f32 v25, v25
    v_exp_f32 v26, v26
    v_exp_f32 v27, v27
    v_exp_f32 v28, v28
    v_exp_f32 v29, v29
    v_exp_f32 v30, v30
    v_exp_f32 v31, v31
    v_exp_f32 v32, v32
    v_cvt_pk_bf16_f32 v56, v24, v25
    v_exp_f32 v33, v33
    v_cvt_pk_bf16_f32 v57, v26, v27
    v_exp_f32 v34, v34
    v_cvt_pk_bf16_f32 v58, v28, v29
    v_exp_f32 v35, v35
    v_cvt_pk_bf16_f32 v59, v30, v31
    v_exp_f32 v36, v36
    v_exp_f32 v37, v37
    v_mfma_f32_32x32x16_bf16 v[64:79], v[88:91], v[56:59], v[64:79]
    v_exp_f32 v38, v38
    v_exp_f32 v39, v39
    v_cvt_pk_bf16_f32 v60, v32, v33
    v_cvt_pk_bf16_f32 v61, v34, v35
    v_cvt_pk_bf16_f32 v62, v36, v37
    v_cvt_pk_bf16_f32 v63, v38, v39
    s_nop 1
    v_mfma_f32_32x32x16_bf16 v[64:79], v[92:95], v[60:63], v[64:79]
    ds_read_b128 v[84:87], v2 offset:48128
    s_mov_b64 exec, s[44:45]
    ds_read_b128 v[88:91], v3 offset:47104
    ds_read_b128 v[92:95], v3 offset:47616
    s_mov_b64 exec, -1
    s_waitcnt lgkmcnt(3)
    v_mfma_f32_32x32x16_bf16 v[24:39], v[80:83], v[4:7], v[8:23]
    v_exp_f32 v40, v40
    v_exp_f32 v41, v41
    v_exp_f32 v42, v42
    v_exp_f32 v43, v43
    v_exp_f32 v44, v44
    v_exp_f32 v45, v45
    v_exp_f32 v46, v46
    v_exp_f32 v47, v47
    v_exp_f32 v48, v48
    v_cvt_pk_bf16_f32 v56, v40, v41
    v_exp_f32 v49, v49
    v_cvt_pk_bf16_f32 v57, v42, v43
    v_exp_f32 v50, v50
    v_cvt_pk_bf16_f32 v58, v44, v45
    v_exp_f32 v51, v51
    v_cvt_pk_bf16_f32 v59, v46, v47
    v_exp_f32 v52, v52
    v_exp_f32 v53, v53
    v_mfma_f32_32x32x16_bf16 v[64:79], v[96:99], v[56:59], v[64:79]
    v_exp_f32 v54, v54
    v_exp_f32 v55, v55
    v_cvt_pk_bf16_f32 v60, v48, v49
    v_cvt_pk_bf16_f32 v61, v50, v51
    v_cvt_pk_bf16_f32 v62, v52, v53
    v_cvt_pk_bf16_f32 v63, v54, v55
    s_nop 1
    v_mfma_f32_32x32x16_bf16 v[64:79], v[100:103], v[60:63], v[64:79]
    s_setprio 1
    ds_read_b128 v[80:83], v2 offset:49152
    s_mov_b64 exec, s[44:45]
    ds_read_b128 v[96:99], v3 offset:48128
    ds_read_b128 v[100:103], v3 offset:48640
    s_mov_b64 exec, -1
    s_waitcnt lgkmcnt(3)
    v_mfma_f32_32x32x16_bf16 v[40:55], v[84:87], v[4:7], v[8:23]
    v_exp_f32 v24, v24
    v_exp_f32 v25, v25
    v_exp_f32 v26, v26
    v_exp_f32 v27, v27
    v_exp_f32 v28, v28
    v_exp_f32 v29, v29
    v_exp_f32 v30, v30
    v_exp_f32 v31, v31
    v_exp_f32 v32, v32
    v_cvt_pk_bf16_f32 v56, v24, v25
    v_exp_f32 v33, v33
    v_cvt_pk_bf16_f32 v57, v26, v27
    v_exp_f32 v34, v34
    v_cvt_pk_bf16_f32 v58, v28, v29
    v_exp_f32 v35, v35
    v_cvt_pk_bf16_f32 v59, v30, v31
    v_exp_f32 v36, v36
    v_exp_f32 v37, v37
    v_mfma_f32_32x32x16_bf16 v[64:79], v[88:91], v[56:59], v[64:79]
    v_exp_f32 v38, v38
    v_exp_f32 v39, v39
    v_cvt_pk_bf16_f32 v60, v32, v33
    v_cvt_pk_bf16_f32 v61, v34, v35
    v_cvt_pk_bf16_f32 v62, v36, v37
    v_cvt_pk_bf16_f32 v63, v38, v39
    s_nop 1
    v_mfma_f32_32x32x16_bf16 v[64:79], v[92:95], v[60:63], v[64:79]
    ds_read_b128 v[84:87], v2 offset:50176
    s_mov_b64 exec, s[44:45]
    ds_read_b128 v[88:91], v3 offset:49152
    ds_read_b128 v[92:95], v3 offset:49664
    s_mov_b64 exec, -1
    s_waitcnt lgkmcnt(3)
    v_mfma_f32_32x32x16_bf16 v[24:39], v[80:83], v[4:7], v[8:23]
    v_exp_f32 v40, v40
    v_exp_f32 v41, v41
    v_exp_f32 v42, v42
    v_exp_f32 v43, v43
    v_exp_f32 v44, v44
    v_exp_f32 v45, v45
    v_exp_f32 v46, v46
    v_exp_f32 v47, v47
    v_exp_f32 v48, v48
    v_cvt_pk_bf16_f32 v56, v40, v41
    v_exp_f32 v49, v49
    v_cvt_pk_bf16_f32 v57, v42, v43
    v_exp_f32 v50, v50
    v_cvt_pk_bf16_f32 v58, v44, v45
    v_exp_f32 v51, v51
    v_cvt_pk_bf16_f32 v59, v46, v47
    v_exp_f32 v52, v52
    v_exp_f32 v53, v53
    v_cmp_lt_f32 s[48:49], s89, v72
    v_mfma_f32_32x32x16_bf16 v[64:79], v[96:99], v[56:59], v[64:79]
    v_exp_f32 v54, v54
    v_exp_f32 v55, v55
    v_cvt_pk_bf16_f32 v60, v48, v49
    v_cvt_pk_bf16_f32 v61, v50, v51
    v_cvt_pk_bf16_f32 v62, v52, v53
    v_cvt_pk_bf16_f32 v63, v54, v55
    s_nop 1
    v_mfma_f32_32x32x16_bf16 v[64:79], v[100:103], v[60:63], v[64:79]
    s_cmp_eq_u32 s46, 0
    s_cbranch_scc0 K3_NOBAR12
    s_barrier
    s_mul_i32 s11, s3, 2048
    s_add_u32 m0, s11, 32768
    s_mov_b32 s11, 57344
    buffer_load_dwordx4 v107, s[56:59], s11 offen lds
    s_mul_i32 s11, s3, 2048
    s_add_u32 m0, s11, 33792
    s_mov_b32 s11, 9216
    buffer_load_dwordx4 v107, s[56:59], s11 offen lds
    s_mul_i32 s11, s3, 2048
    s_add_u32 m0, s11, 98304
    s_mov_b32 s11, 25600
    buffer_load_dwordx4 v107, s[56:59], s11 offen lds
    s_mul_i32 s11, s3, 2048
    s_add_u32 m0, s11, 99328
    s_mov_b32 s11, 41984
    buffer_load_dwordx4 v107, s[56:59], s11 offen lds
K3_NOBAR12:
    s_cmp_eq_u64 s[48:49], 0
    s_cbranch_scc1 K3_RENORM_RET12
    s_getpc_b64 s[52:53]
    s_branch K3_RENORM
K3_RENORM_RET12:
    s_setprio 3
    ds_read_b128 v[80:83], v2 offset:51200
    s_mov_b64 exec, s[44:45]
    ds_read_b128 v[96:99], v3 offset:50176
    ds_read_b128 v[100:103], v3 offset:50688
    s_mov_b64 exec, -1
    s_waitcnt lgkmcnt(3)
    v_mfma_f32_32x32x16_bf16 v[40:55], v[84:87], v[4:7], v[8:23]
    v_exp_f32 v24, v24
    v_exp_f32 v25, v25
    v_exp_f32 v26, v26
    v_exp_f32 v27, v27
    v_exp_f32 v28, v28
    v_exp_f32 v29, v29
    v_exp_f32 v30, v30
    v_exp_f32 v31, v31
    v_exp_f32 v32, v32
    v_cvt_pk_bf16_f32 v56, v24, v25
    v_exp_f32 v33, v33
    v_cvt_pk_bf16_f32 v57, v26, v27
    v_exp_f32 v34, v34
    v_cvt_pk_bf16_f32 v58, v28, v29
    v_exp_f32 v35, v35
    v_cvt_pk_bf16_f32 v59, v30, v31
    v_exp_f32 v36, v36
    v_exp_f32 v37, v37
    v_mfma_f32_32x32x16_bf16 v[64:79], v[88:91], v[56:59], v[64:79]
    v_exp_f32 v38, v38
    v_exp_f32 v39, v39
    v_cvt_pk_bf16_f32 v60, v32, v33
    v_cvt_pk_bf16_f32 v61, v34, v35
    v_cvt_pk_bf16_f32 v62, v36, v37
    v_cvt_pk_bf16_f32 v63, v38, v39
    s_nop 1
    v_mfma_f32_32x32x16_bf16 v[64:79], v[92:95], v[60:63], v[64:79]
    ds_read_b128 v[84:87], v2 offset:52224
    s_mov_b64 exec, s[44:45]
    ds_read_b128 v[88:91], v3 offset:51200
    ds_read_b128 v[92:95], v3 offset:51712
    s_mov_b64 exec, -1
    s_waitcnt lgkmcnt(3)
    v_mfma_f32_32x32x16_bf16 v[24:39], v[80:83], v[4:7], v[8:23]
    v_exp_f32 v40, v40
    v_exp_f32 v41, v41
    v_exp_f32 v42, v42
    v_exp_f32 v43, v43
    v_exp_f32 v44, v44
    v_exp_f32 v45, v45
    v_exp_f32 v46, v46
    v_exp_f32 v47, v47
    v_exp_f32 v48, v48
    v_cvt_pk_bf16_f32 v56, v40, v41
    v_exp_f32 v49, v49
    v_cvt_pk_bf16_f32 v57, v42, v43
    v_exp_f32 v50, v50
    v_cvt_pk_bf16_f32 v58, v44, v45
    v_exp_f32 v51, v51
    v_cvt_pk_bf16_f32 v59, v46, v47
    v_exp_f32 v52, v52
    v_exp_f32 v53, v53
    v_mfma_f32_32x32x16_bf16 v[64:79], v[96:99], v[56:59], v[64:79]
    v_exp_f32 v54, v54
    v_exp_f32 v55, v55
    v_cvt_pk_bf16_f32 v60, v48, v49
    v_cvt_pk_bf16_f32 v61, v50, v51
    v_cvt_pk_bf16_f32 v62, v52, v53
    v_cvt_pk_bf16_f32 v63, v54, v55
    s_nop 1
    v_mfma_f32_32x32x16_bf16 v[64:79], v[100:103], v[60:63], v[64:79]
    ds_read_b128 v[80:83], v2 offset:53248
    s_mov_b64 exec, s[44:45]
    ds_read_b128 v[96:99], v3 offset:52224
    ds_read_b128 v[100:103], v3 offset:52736
    s_mov_b64 exec, -1
    s_waitcnt lgkmcnt(3)
    v_mfma_f32_32x32x16_bf16 v[40:55], v[84:87], v[4:7], v[8:23]
    v_exp_f32 v24, v24
    v_exp_f32 v25, v25
    v_exp_f32 v26, v26
    v_exp_f32 v27, v27
    v_exp_f32 v28, v28
    v_exp_f32 v29, v29
    v_exp_f32 v30, v30
    v_exp_f32 v31, v31
    v_exp_f32 v32, v32
    v_cvt_pk_bf16_f32 v56, v24, v25
    v_exp_f32 v33, v33
    v_cvt_pk_bf16_f32 v57, v26, v27
    v_exp_f32 v34, v34
    v_cvt_pk_bf16_f32 v58, v28, v29
    v_exp_f32 v35, v35
    v_cvt_pk_bf16_f32 v59, v30, v31
    v_exp_f32 v36, v36
    v_exp_f32 v37, v37
    v_mfma_f32_32x32x16_bf16 v[64:79], v[88:91], v[56:59], v[64:79]
    v_exp_f32 v38, v38
    v_exp_f32 v39, v39
    v_cvt_pk_bf16_f32 v60, v32, v33
    v_cvt_pk_bf16_f32 v61, v34, v35
    v_cvt_pk_bf16_f32 v62, v36, v37
    v_cvt_pk_bf16_f32 v63, v38, v39
    s_nop 1
    v_mfma_f32_32x32x16_bf16 v[64:79], v[92:95], v[60:63], v[64:79]
    ds_read_b128 v[84:87], v2 offset:54272
    s_mov_b64 exec, s[44:45]
    ds_read_b128 v[88:91], v3 offset:53248
    ds_read_b128 v[92:95], v3 offset:53760
    s_mov_b64 exec, -1
    s_waitcnt lgkmcnt(3)
    v_mfma_f32_32x32x16_bf16 v[24:39], v[80:83], v[4:7], v[8:23]
    v_exp_f32 v40, v40
    v_exp_f32 v41, v41
    v_exp_f32 v42, v42
    v_exp_f32 v43, v43
    v_exp_f32 v44, v44
    v_exp_f32 v45, v45
    v_exp_f32 v46, v46
    v_exp_f32 v47, v47
    v_exp_f32 v48, v48
    v_cvt_pk_bf16_f32 v56, v40, v41
    v_exp_f32 v49, v49
    v_cvt_pk_bf16_f32 v57, v42, v43
    v_exp_f32 v50, v50
    v_cvt_pk_bf16_f32 v58, v44, v45
    v_exp_f32 v51, v51
    v_cvt_pk_bf16_f32 v59, v46, v47
    v_exp_f32 v52, v52
    v_exp_f32 v53, v53
    v_cmp_lt_f32 s[48:49], s89, v72
    v_mfma_f32_32x32x16_bf16 v[64:79], v[96:99], v[56:59], v[64:79]
    v_exp_f32 v54, v54
    v_exp_f32 v55, v55
    v_cvt_pk_bf16_f32 v60, v48, v49
    v_cvt_pk_bf16_f32 v61, v50, v51
    v_cvt_pk_bf16_f32 v62, v52, v53
    v_cvt_pk_bf16_f32 v63, v54, v55
    s_nop 1
    v_mfma_f32_32x32x16_bf16 v[64:79], v[100:103], v[60:63], v[64:79]
    s_cmp_eq_u64 s[48:49], 0
    s_cbranch_scc1 K3_RENORM_RET13
    s_getpc_b64 s[52:53]
    s_branch K3_RENORM
K3_RENORM_RET13:
    ds_read_b128 v[80:83], v2 offset:55296
    s_mov_b64 exec, s[44:45]
    ds_read_b128 v[96:99], v3 offset:54272
    ds_read_b128 v[100:103], v3 offset:54784
    s_mov_b64 exec, -1
    s_waitcnt lgkmcnt(3)
    v_mfma_f32_32x32x16_bf16 v[40:55], v[84:87], v[4:7], v[8:23]
    v_exp_f32 v24, v24
    v_exp_f32 v25, v25
    v_exp_f32 v26, v26
    v_exp_f32 v27, v27
    v_exp_f32 v28, v28
    v_exp_f32 v29, v29
    v_exp_f32 v30, v30
    v_exp_f32 v31, v31
    v_exp_f32 v32, v32
    v_cvt_pk_bf16_f32 v56, v24, v25
    v_exp_f32 v33, v33
    v_cvt_pk_bf16_f32 v57, v26, v27
    v_exp_f32 v34, v34
    v_cvt_pk_bf16_f32 v58, v28, v29
    v_exp_f32 v35, v35
    v_cvt_pk_bf16_f32 v59, v30, v31
    v_exp_f32 v36, v36
    v_exp_f32 v37, v37
    v_mfma_f32_32x32x16_bf16 v[64:79], v[88:91], v[56:59], v[64:79]
    v_exp_f32 v38, v38
    v_exp_f32 v39, v39
    v_cvt_pk_bf16_f32 v60, v32, v33
    v_cvt_pk_bf16_f32 v61, v34, v35
    v_cvt_pk_bf16_f32 v62, v36, v37
    v_cvt_pk_bf16_f32 v63, v38, v39
    s_nop 1
    v_mfma_f32_32x32x16_bf16 v[64:79], v[92:95], v[60:63], v[64:79]
    ds_read_b128 v[84:87], v2 offset:56320
    s_mov_b64 exec, s[44:45]
    ds_read_b128 v[88:91], v3 offset:55296
    ds_read_b128 v[92:95], v3 offset:55808
    s_mov_b64 exec, -1
    s_waitcnt lgkmcnt(3)
    v_mfma_f32_32x32x16_bf16 v[24:39], v[80:83], v[4:7], v[8:23]
    v_exp_f32 v40, v40
    v_exp_f32 v41, v41
    v_exp_f32 v42, v42
    v_exp_f32 v43, v43
    v_exp_f32 v44, v44
    v_exp_f32 v45, v45
    v_exp_f32 v46, v46
    v_exp_f32 v47, v47
    v_exp_f32 v48, v48
    v_cvt_pk_bf16_f32 v56, v40, v41
    v_exp_f32 v49, v49
    v_cvt_pk_bf16_f32 v57, v42, v43
    v_exp_f32 v50, v50
    v_cvt_pk_bf16_f32 v58, v44, v45
    v_exp_f32 v51, v51
    v_cvt_pk_bf16_f32 v59, v46, v47
    v_exp_f32 v52, v52
    v_exp_f32 v53, v53
    v_mfma_f32_32x32x16_bf16 v[64:79], v[96:99], v[56:59], v[64:79]
    v_exp_f32 v54, v54
    v_exp_f32 v55, v55
    v_cvt_pk_bf16_f32 v60, v48, v49
    v_cvt_pk_bf16_f32 v61, v50, v51
    v_cvt_pk_bf16_f32 v62, v52, v53
    v_cvt_pk_bf16_f32 v63, v54, v55
    s_nop 1
    v_mfma_f32_32x32x16_bf16 v[64:79], v[100:103], v[60:63], v[64:79]
    ds_read_b128 v[80:83], v2 offset:57344
    s_mov_b64 exec, s[44:45]
    ds_read_b128 v[96:99], v3 offset:56320
    ds_read_b128 v[100:103], v3 offset:56832
    s_mov_b64 exec, -1
    s_waitcnt lgkmcnt(3)
    v_mfma_f32_32x32x16_bf16 v[40:55], v[84:87], v[4:7], v[8:23]
    v_exp_f32 v24, v24
    v_exp_f32 v25, v25
    v_exp_f32 v26, v26
    v_exp_f32 v27, v27
    v_exp_f32 v28, v28
    v_exp_f32 v29, v29
    v_exp_f32 v30, v30
    v_exp_f32 v31, v31
    v_exp_f32 v32, v32
    v_cvt_pk_bf16_f32 v56, v24, v25
    v_exp_f32 v33, v33
    v_cvt_pk_bf16_f32 v57, v26, v27
    v_exp_f32 v34, v34
    v_cvt_pk_bf16_f32 v58, v28, v29
    v_exp_f32 v35, v35
    v_cvt_pk_bf16_f32 v59, v30, v31
    v_exp_f32 v36, v36
    v_exp_f32 v37, v37
    v_mfma_f32_32x32x16_bf16 v[64:79], v[88:91], v[56:59], v[64:79]
    v_exp_f32 v38, v38
    v_exp_f32 v39, v39
    v_cvt_pk_bf16_f32 v60, v32, v33
    v_cvt_pk_bf16_f32 v61, v34, v35
    v_cvt_pk_bf16_f32 v62, v36, v37
    v_cvt_pk_bf16_f32 v63, v38, v39
    s_nop 1
    v_mfma_f32_32x32x16_bf16 v[64:79], v[92:95], v[60:63], v[64:79]
    ds_read_b128 v[84:87], v2 offset:58368
    s_mov_b64 exec, s[44:45]
    ds_read_b128 v[88:91], v3 offset:57344
    ds_read_b128 v[92:95], v3 offset:57856
    s_mov_b64 exec, -1
    s_waitcnt lgkmcnt(3)
    v_mfma_f32_32x32x16_bf16 v[24:39], v[80:83], v[4:7], v[8:23]
    v_exp_f32 v40, v40
    v_exp_f32 v41, v41
    v_exp_f32 v42, v42
    v_exp_f32 v43, v43
    v_exp_f32 v44, v44
    v_exp_f32 v45, v45
    v_exp_f32 v46, v46
    v_exp_f32 v47, v47
    v_exp_f32 v48, v48
    v_cvt_pk_bf16_f32 v56, v40, v41
    v_exp_f32 v49, v49
    v_cvt_pk_bf16_f32 v57, v42, v43
    v_exp_f32 v50, v50
    v_cvt_pk_bf16_f32 v58, v44, v45
    v_exp_f32 v51, v51
    v_cvt_pk_bf16_f32 v59, v46, v47
    v_exp_f32 v52, v52
    v_exp_f32 v53, v53
    v_cmp_lt_f32 s[48:49], s89, v72
    v_mfma_f32_32x32x16_bf16 v[64:79], v[96:99], v[56:59], v[64:79]
    v_exp_f32 v54, v54
    v_exp_f32 v55, v55
    v_cvt_pk_bf16_f32 v60, v48, v49
    v_cvt_pk_bf16_f32 v61, v50, v51
    v_cvt_pk_bf16_f32 v62, v52, v53
    v_cvt_pk_bf16_f32 v63, v54, v55
    s_nop 1
    v_mfma_f32_32x32x16_bf16 v[64:79], v[100:103], v[60:63], v[64:79]
    s_cmp_eq_u64 s[48:49], 0
    s_cbranch_scc1 K3_RENORM_RET14
    s_getpc_b64 s[52:53]
    s_branch K3_RENORM
K3_RENORM_RET14:
    s_setprio 2
    ds_read_b128 v[80:83], v2 offset:59392
    s_mov_b64 exec, s[44:45]
    ds_read_b128 v[96:99], v3 offset:58368
    ds_read_b128 v[100:103], v3 offset:58880
    s_mov_b64 exec, -1
    s_waitcnt lgkmcnt(3)
    v_mfma_f32_32x32x16_bf16 v[40:55], v[84:87], v[4:7], v[8:23]
    v_exp_f32 v24, v24
    v_exp_f32 v25, v25
    v_exp_f32 v26, v26
    v_exp_f32 v27, v27
    v_exp_f32 v28, v28
    v_exp_f32 v29, v29
    v_exp_f32 v30, v30
    v_exp_f32 v31, v31
    v_exp_f32 v32, v32
    v_cvt_pk_bf16_f32 v56, v24, v25
    v_exp_f32 v33, v33
    v_cvt_pk_bf16_f32 v57, v26, v27
    v_exp_f32 v34, v34
    v_cvt_pk_bf16_f32 v58, v28, v29
    v_exp_f32 v35, v35
    v_cvt_pk_bf16_f32 v59, v30, v31
    v_exp_f32 v36, v36
    v_exp_f32 v37, v37
    v_mfma_f32_32x32x16_bf16 v[64:79], v[88:91], v[56:59], v[64:79]
    v_exp_f32 v38, v38
    v_exp_f32 v39, v39
    v_cvt_pk_bf16_f32 v60, v32, v33
    v_cvt_pk_bf16_f32 v61, v34, v35
    v_cvt_pk_bf16_f32 v62, v36, v37
    v_cvt_pk_bf16_f32 v63, v38, v39
    s_nop 1
    v_mfma_f32_32x32x16_bf16 v[64:79], v[92:95], v[60:63], v[64:79]
    ds_read_b128 v[84:87], v2 offset:60416
    s_mov_b64 exec, s[44:45]
    ds_read_b128 v[88:91], v3 offset:59392
    ds_read_b128 v[92:95], v3 offset:59904
    s_mov_b64 exec, -1
    s_waitcnt lgkmcnt(3)
    v_mfma_f32_32x32x16_bf16 v[24:39], v[80:83], v[4:7], v[8:23]
    v_exp_f32 v40, v40
    v_exp_f32 v41, v41
    v_exp_f32 v42, v42
    v_exp_f32 v43, v43
    v_exp_f32 v44, v44
    v_exp_f32 v45, v45
    v_exp_f32 v46, v46
    v_exp_f32 v47, v47
    v_exp_f32 v48, v48
    v_cvt_pk_bf16_f32 v56, v40, v41
    v_exp_f32 v49, v49
    v_cvt_pk_bf16_f32 v57, v42, v43
    v_exp_f32 v50, v50
    v_cvt_pk_bf16_f32 v58, v44, v45
    v_exp_f32 v51, v51
    v_cvt_pk_bf16_f32 v59, v46, v47
    v_exp_f32 v52, v52
    v_exp_f32 v53, v53
    v_mfma_f32_32x32x16_bf16 v[64:79], v[96:99], v[56:59], v[64:79]
    v_exp_f32 v54, v54
    v_exp_f32 v55, v55
    v_cvt_pk_bf16_f32 v60, v48, v49
    v_cvt_pk_bf16_f32 v61, v50, v51
    v_cvt_pk_bf16_f32 v62, v52, v53
    v_cvt_pk_bf16_f32 v63, v54, v55
    s_nop 1
    v_mfma_f32_32x32x16_bf16 v[64:79], v[100:103], v[60:63], v[64:79]
    ds_read_b128 v[80:83], v2 offset:61440
    s_mov_b64 exec, s[44:45]
    ds_read_b128 v[96:99], v3 offset:60416
    ds_read_b128 v[100:103], v3 offset:60928
    s_mov_b64 exec, -1
    s_waitcnt lgkmcnt(3)
    v_mfma_f32_32x32x16_bf16 v[40:55], v[84:87], v[4:7], v[8:23]
    v_exp_f32 v24, v24
    v_exp_f32 v25, v25
    v_exp_f32 v26, v26
    v_exp_f32 v27, v27
    v_exp_f32 v28, v28
    v_exp_f32 v29, v29
    v_exp_f32 v30, v30
    v_exp_f32 v31, v31
    v_exp_f32 v32, v32
    v_cvt_pk_bf16_f32 v56, v24, v25
    v_exp_f32 v33, v33
    v_cvt_pk_bf16_f32 v57, v26, v27
    v_exp_f32 v34, v34
    v_cvt_pk_bf16_f32 v58, v28, v29
    v_exp_f32 v35, v35
    v_cvt_pk_bf16_f32 v59, v30, v31
    v_exp_f32 v36, v36
    v_exp_f32 v37, v37
    v_mfma_f32_32x32x16_bf16 v[64:79], v[88:91], v[56:59], v[64:79]
    v_exp_f32 v38, v38
    v_exp_f32 v39, v39
    v_cvt_pk_bf16_f32 v60, v32, v33
    v_cvt_pk_bf16_f32 v61, v34, v35
    v_cvt_pk_bf16_f32 v62, v36, v37
    v_cvt_pk_bf16_f32 v63, v38, v39
    s_nop 1
    v_mfma_f32_32x32x16_bf16 v[64:79], v[92:95], v[60:63], v[64:79]
    ds_read_b128 v[84:87], v2 offset:62464
    s_mov_b64 exec, s[44:45]
    ds_read_b128 v[88:91], v3 offset:61440
    ds_read_b128 v[92:95], v3 offset:61952
    s_mov_b64 exec, -1
    s_waitcnt lgkmcnt(3)
    v_mfma_f32_32x32x16_bf16 v[24:39], v[80:83], v[4:7], v[8:23]
    v_exp_f32 v40, v40
    v_exp_f32 v41, v41
    v_exp_f32 v42, v42
    v_exp_f32 v43, v43
    v_exp_f32 v44, v44
    v_exp_f32 v45, v45
    v_exp_f32 v46, v46
    v_exp_f32 v47, v47
    v_exp_f32 v48, v48
    v_cvt_pk_bf16_f32 v56, v40, v41
    v_exp_f32 v49, v49
    v_cvt_pk_bf16_f32 v57, v42, v43
    v_exp_f32 v50, v50
    v_cvt_pk_bf16_f32 v58, v44, v45
    v_exp_f32 v51, v51
    v_cvt_pk_bf16_f32 v59, v46, v47
    v_exp_f32 v52, v52
    v_exp_f32 v53, v53
    v_cmp_lt_f32 s[48:49], s89, v72
    v_mfma_f32_32x32x16_bf16 v[64:79], v[96:99], v[56:59], v[64:79]
    v_exp_f32 v54, v54
    v_exp_f32 v55, v55
    v_cvt_pk_bf16_f32 v60, v48, v49
    v_cvt_pk_bf16_f32 v61, v50, v51
    v_cvt_pk_bf16_f32 v62, v52, v53
    v_cvt_pk_bf16_f32 v63, v54, v55
    s_nop 1
    v_mfma_f32_32x32x16_bf16 v[64:79], v[100:103], v[60:63], v[64:79]
    s_cmp_eq_u64 s[48:49], 0
    s_cbranch_scc1 K3_RENORM_RET15
    s_getpc_b64 s[52:53]
    s_branch K3_RENORM
K3_RENORM_RET15:
    s_setprio 1
    ds_read_b128 v[80:83], v2 offset:63488
    s_mov_b64 exec, s[44:45]
    ds_read_b128 v[96:99], v3 offset:62464
    ds_read_b128 v[100:103], v3 offset:62976
    s_mov_b64 exec, -1
    s_waitcnt lgkmcnt(3)
    v_mfma_f32_32x32x16_bf16 v[40:55], v[84:87], v[4:7], v[8:23]
    v_exp_f32 v24, v24
    v_exp_f32 v25, v25
    v_exp_f32 v26, v26
    v_exp_f32 v27, v27
    v_exp_f32 v28, v28
    v_exp_f32 v29, v29
    v_exp_f32 v30, v30
    v_exp_f32 v31, v31
    v_exp_f32 v32, v32
    v_cvt_pk_bf16_f32 v56, v24, v25
    v_exp_f32 v33, v33
    v_cvt_pk_bf16_f32 v57, v26, v27
    v_exp_f32 v34, v34
    v_cvt_pk_bf16_f32 v58, v28, v29
    v_exp_f32 v35, v35
    v_cvt_pk_bf16_f32 v59, v30, v31
    v_exp_f32 v36, v36
    v_exp_f32 v37, v37
    v_mfma_f32_32x32x16_bf16 v[64:79], v[88:91], v[56:59], v[64:79]
    v_exp_f32 v38, v38
    v_exp_f32 v39, v39
    v_cvt_pk_bf16_f32 v60, v32, v33
    v_cvt_pk_bf16_f32 v61, v34, v35
    v_cvt_pk_bf16_f32 v62, v36, v37
    v_cvt_pk_bf16_f32 v63, v38, v39
    s_nop 1
    v_mfma_f32_32x32x16_bf16 v[64:79], v[92:95], v[60:63], v[64:79]
    ds_read_b128 v[84:87], v2 offset:64512
    s_mov_b64 exec, s[44:45]
    ds_read_b128 v[88:91], v3 offset:63488
    ds_read_b128 v[92:95], v3 offset:64000
    s_mov_b64 exec, -1
    s_waitcnt lgkmcnt(3)
    v_mfma_f32_32x32x16_bf16 v[24:39], v[80:83], v[4:7], v[8:23]
    v_exp_f32 v40, v40
    v_exp_f32 v41, v41
    v_exp_f32 v42, v42
    v_exp_f32 v43, v43
    v_exp_f32 v44, v44
    v_exp_f32 v45, v45
    v_exp_f32 v46, v46
    v_exp_f32 v47, v47
    v_exp_f32 v48, v48
    v_cvt_pk_bf16_f32 v56, v40, v41
    v_exp_f32 v49, v49
    v_cvt_pk_bf16_f32 v57, v42, v43
    v_exp_f32 v50, v50
    v_cvt_pk_bf16_f32 v58, v44, v45
    v_exp_f32 v51, v51
    v_cvt_pk_bf16_f32 v59, v46, v47
    v_exp_f32 v52, v52
    v_exp_f32 v53, v53
    v_mfma_f32_32x32x16_bf16 v[64:79], v[96:99], v[56:59], v[64:79]
    v_exp_f32 v54, v54
    v_exp_f32 v55, v55
    v_cvt_pk_bf16_f32 v60, v48, v49
    v_cvt_pk_bf16_f32 v61, v50, v51
    v_cvt_pk_bf16_f32 v62, v52, v53
    v_cvt_pk_bf16_f32 v63, v54, v55
    s_nop 1
    v_mfma_f32_32x32x16_bf16 v[64:79], v[100:103], v[60:63], v[64:79]
    s_setprio 0
    s_mov_b64 exec, s[44:45]
    ds_read_b128 v[96:99], v3 offset:64512
    ds_read_b128 v[100:103], v3 offset:65024
    s_mov_b64 exec, -1
    s_waitcnt lgkmcnt(2)
    v_mfma_f32_32x32x16_bf16 v[40:55], v[84:87], v[4:7], v[8:23]
    v_exp_f32 v24, v24
    v_exp_f32 v25, v25
    v_exp_f32 v26, v26
    v_exp_f32 v27, v27
    v_exp_f32 v28, v28
    v_exp_f32 v29, v29
    v_exp_f32 v30, v30
    v_exp_f32 v31, v31
    v_exp_f32 v32, v32
    v_cvt_pk_bf16_f32 v56, v24, v25
    v_exp_f32 v33, v33
    v_cvt_pk_bf16_f32 v57, v26, v27
    v_exp_f32 v34, v34
    v_cvt_pk_bf16_f32 v58, v28, v29
    v_exp_f32 v35, v35
    v_cvt_pk_bf16_f32 v59, v30, v31
    v_exp_f32 v36, v36
    v_exp_f32 v37, v37
    v_mfma_f32_32x32x16_bf16 v[64:79], v[88:91], v[56:59], v[64:79]
    v_exp_f32 v38, v38
    v_exp_f32 v39, v39
    v_cvt_pk_bf16_f32 v60, v32, v33
    v_cvt_pk_bf16_f32 v61, v34, v35
    v_cvt_pk_bf16_f32 v62, v36, v37
    v_cvt_pk_bf16_f32 v63, v38, v39
    s_nop 1
    v_mfma_f32_32x32x16_bf16 v[64:79], v[92:95], v[60:63], v[64:79]
    s_waitcnt lgkmcnt(0)
    v_exp_f32 v40, v40
    v_exp_f32 v41, v41
    v_exp_f32 v42, v42
    v_exp_f32 v43, v43
    v_exp_f32 v44, v44
    v_exp_f32 v45, v45
    v_exp_f32 v46, v46
    v_exp_f32 v47, v47
    v_exp_f32 v48, v48
    v_cvt_pk_bf16_f32 v56, v40, v41
    v_exp_f32 v49, v49
    v_cvt_pk_bf16_f32 v57, v42, v43
    v_exp_f32 v50, v50
    v_cvt_pk_bf16_f32 v58, v44, v45
    v_exp_f32 v51, v51
    v_cvt_pk_bf16_f32 v59, v46, v47
    v_exp_f32 v52, v52
    v_exp_f32 v53, v53
    v_mfma_f32_32x32x16_bf16 v[64:79], v[96:99], v[56:59], v[64:79]
    v_exp_f32 v54, v54
    v_exp_f32 v55, v55
    v_cvt_pk_bf16_f32 v60, v48, v49
    v_cvt_pk_bf16_f32 v61, v50, v51
    v_cvt_pk_bf16_f32 v62, v52, v53
    v_cvt_pk_bf16_f32 v63, v54, v55
    s_nop 1
    v_mfma_f32_32x32x16_bf16 v[64:79], v[100:103], v[60:63], v[64:79]
    s_nop 15
    s_cmp_eq_u32 s46, 0
    s_cbranch_scc0 K3_DONE
    v_mov_b32 v104, 0x207
    s_mov_b64 s[48:49], 0
    v_cmp_class_f32 vcc, v64, v104
    s_or_b64 s[48:49], s[48:49], vcc
    v_cmp_class_f32 vcc, v65, v104
    s_or_b64 s[48:49], s[48:49], vcc
    v_cmp_class_f32 vcc, v66, v104
    s_or_b64 s[48:49], s[48:49], vcc
    v_cmp_class_f32 vcc, v67, v104
    s_or_b64 s[48:49], s[48:49], vcc
    v_cmp_class_f32 vcc, v68, v104
    s_or_b64 s[48:49], s[48:49], vcc
    v_cmp_class_f32 vcc, v69, v104
    s_or_b64 s[48:49], s[48:49], vcc
    v_cmp_class_f32 vcc, v70, v104
    s_or_b64 s[48:49], s[48:49], vcc
    v_cmp_class_f32 vcc, v71, v104
    s_or_b64 s[48:49], s[48:49], vcc
    v_cmp_class_f32 vcc, v72, v104
    s_or_b64 s[48:49], s[48:49], vcc
    s_cmp_eq_u64 s[48:49], 0
    s_cbranch_scc1 K3_DONE
    s_branch K3_FALLBACK
K3_RENORM:
    s_nop 15
    s_nop 3
    s_mov_b64 vcc, s[48:49]
    v_frexp_exp_i32_f32 v104, v72
    v_add_u32 v104, 90, v104
    v_cndmask_b32 v104, 0, v104, vcc
    v_sub_u32 v105, 0, v104
    v_ldexp_f32 v64, v64, v105
    v_ldexp_f32 v65, v65, v105
    v_ldexp_f32 v66, v66, v105
    v_ldexp_f32 v67, v67, v105
    v_ldexp_f32 v68, v68, v105
    v_ldexp_f32 v69, v69, v105
    v_ldexp_f32 v70, v70, v105
    v_ldexp_f32 v71, v71, v105
    v_ldexp_f32 v72, v72, v105
    v_ldexp_f32 v73, v73, v105
    v_ldexp_f32 v74, v74, v105
    v_ldexp_f32 v75, v75, v105
    v_ldexp_f32 v76, v76, v105
    v_ldexp_f32 v77, v77, v105
    v_ldexp_f32 v78, v78, v105
    v_ldexp_f32 v79, v79, v105
    v_cvt_f32_i32 v104, v104
    v_sub_f32 v8, v8, v104
    v_mov_b32 v9, v8
    v_mov_b32 v10, v8
    v_mov_b32 v11, v8
    v_mov_b32 v12, v8
    v_mov_b32 v13, v8
    v_mov_b32 v14, v8
    v_mov_b32 v15, v8
    v_mov_b32 v16, v8
    v_mov_b32 v17, v8
    v_mov_b32 v18, v8
    v_mov_b32 v19, v8
    v_mov_b32 v20, v8
    v_mov_b32 v21, v8
    v_mov_b32 v22, v8
    v_mov_b32 v23, v8
    v_sub_f32 v24, v24, v104
    v_sub_f32 v25, v25, v104
    v_sub_f32 v26, v26, v104
    v_sub_f32 v27, v27, v104
    v_sub_f32 v28, v28, v104
    v_sub_f32 v29, v29, v104
    v_sub_f32 v30, v30, v104
    v_sub_f32 v31, v31, v104
    v_sub_f32 v32, v32, v104
    v_sub_f32 v33, v33, v104
    v_sub_f32 v34, v34, v104
    v_sub_f32 v35, v35, v104
    v_sub_f32 v36, v36, v104
    v_sub_f32 v37, v37, v104
    v_sub_f32 v38, v38, v104
    v_sub_f32 v39, v39, v104
    s_mov_b64 s[48:49], 0
    s_nop 1
    s_add_u32 s52, s52, 4
    s_addc_u32 s53, s53, 0
    s_setpc_b64 s[52:53]
K3_FALLBACK:
    s_add_u32 s48, s42, 10878976
    s_addc_u32 s49, s43, 0
    s_add_u32 s50, s42, 10944512
    s_addc_u32 s51, s43, 0
    v_mov_b32 v8, 0
    v_mov_b32 v64, 0
    v_mov_b32 v9, 0
    v_mov_b32 v65, 0
    v_mov_b32 v10, 0
    v_mov_b32 v66, 0
    v_mov_b32 v11, 0
    v_mov_b32 v67, 0
    v_mov_b32 v12, 0
    v_mov_b32 v68, 0
    v_mov_b32 v13, 0
    v_mov_b32 v69, 0
    v_mov_b32 v14, 0
    v_mov_b32 v70, 0
    v_mov_b32 v15, 0
    v_mov_b32 v71, 0
    v_mov_b32 v16, 0
    v_mov_b32 v72, 0
    v_mov_b32 v17, 0
    v_mov_b32 v73, 0
    v_mov_b32 v18, 0
    v_mov_b32 v74, 0
    v_mov_b32 v19, 0
    v_mov_b32 v75, 0
    v_mov_b32 v20, 0
    v_mov_b32 v76, 0
    v_mov_b32 v21, 0
    v_mov_b32 v77, 0
    v_mov_b32 v22, 0
    v_mov_b32 v78, 0
    v_mov_b32 v23, 0
    v_mov_b32 v79, 0
    v_mov_b32 v104, 0xff800000
    v_lshlrev_b32 v106, 4, v1
    s_mov_b32 s47, 0
K3_FB_LOOP:
    global_load_dwordx4 v[80:83], v106, s[48:49]
    s_waitcnt vmcnt(0)
    v_mfma_f32_32x32x16_bf16 v[24:39], v[80:83], v[4:7], v[8:23]
    s_nop 15
    s_nop 3
    v_max3_f32 v104, v104, v24, v25
    v_max3_f32 v104, v104, v26, v27
    v_max3_f32 v104, v104, v28, v29
    v_max3_f32 v104, v104, v30, v31
    v_max3_f32 v104, v104, v32, v33
    v_max3_f32 v104, v104, v34, v35
    v_max3_f32 v104, v104, v36, v37
    v_max3_f32 v104, v104, v38, v39
    v_add_u32 v106, 1024, v106
    s_add_u32 s47, s47, 1
    s_cmp_lt_u32 s47, 64
    s_cbranch_scc1 K3_FB_LOOP
    v_mov_b32 v105, v104
    s_nop 1
    v_permlane32_swap_b32 v104, v105
    s_nop 0
    v_max_f32 v104, v104, v105
    v_sub_f32 v104, 0, v104
    v_mov_b32 v8, v104
    v_mov_b32 v9, v104
    v_mov_b32 v10, v104
    v_mov_b32 v11, v104
    v_mov_b32 v12, v104
    v_mov_b32 v13, v104
    v_mov_b32 v14, v104
    v_mov_b32 v15, v104
    v_mov_b32 v16, v104
    v_mov_b32 v17, v104
    v_mov_b32 v18, v104
    v_mov_b32 v19, v104
    v_mov_b32 v20, v104
    v_mov_b32 v21, v104
    v_mov_b32 v22, v104
    v_mov_b32 v23, v104
    v_lshlrev_b32 v106, 4, v1
    v_subrev_u32 v108, 65536, v3
    s_mov_b32 s47, 0
K3_FB_LOOP2:
    global_load_dwordx4 v[80:83], v106, s[48:49]
    s_mov_b64 exec, s[44:45]
    global_load_dwordx4 v[88:91], v108, s[50:51]
    global_load_dwordx4 v[92:95], v108, s[50:51] offset:512
    s_mov_b64 exec, -1
    s_waitcnt vmcnt(0)
    v_mfma_f32_32x32x16_bf16 v[24:39], v[80:83], v[4:7], v[8:23]
    s_nop 15
    s_nop 3
    v_exp_f32 v24, v24
    v_exp_f32 v25, v25
    v_exp_f32 v26, v26
    v_exp_f32 v27, v27
    v_exp_f32 v28, v28
    v_exp_f32 v29, v29
    v_exp_f32 v30, v30
    v_exp_f32 v31, v31
    v_exp_f32 v32, v32
    v_exp_f32 v33, v33
    v_exp_f32 v34, v34
    v_exp_f32 v35, v35
    v_exp_f32 v36, v36
    v_exp_f32 v37, v37
    v_exp_f32 v38, v38
    v_exp_f32 v39, v39
    s_nop 0
    v_cvt_pk_bf16_f32 v56, v24, v25
    v_cvt_pk_bf16_f32 v57, v26, v27
    v_cvt_pk_bf16_f32 v58, v28, v29
    v_cvt_pk_bf16_f32 v59, v30, v31
    v_cvt_pk_bf16_f32 v60, v32, v33
    v_cvt_pk_bf16_f32 v61, v34, v35
    v_cvt_pk_bf16_f32 v62, v36, v37
    v_cvt_pk_bf16_f32 v63, v38, v39
    s_nop 1
    v_mfma_f32_32x32x16_bf16 v[64:79], v[88:91], v[56:59], v[64:79]
    v_mfma_f32_32x32x16_bf16 v[64:79], v[92:95], v[60:63], v[64:79]
    v_add_u32 v106, 1024, v106
    v_add_u32 v108, 1024, v108
    s_add_u32 s47, s47, 1
    s_cmp_lt_u32 s47, 64
    s_cbranch_scc1 K3_FB_LOOP2
    s_nop 15
    s_nop 3
K3_DONE:
    s_setprio 0
    s_waitcnt vmcnt(4)
    s_mov_b32 s11, 58368
    buffer_load_dwordx4 v[24:27], v107, s[56:59], s11 offen
    s_mov_b32 s11, 10240
    buffer_load_dwordx4 v[28:31], v107, s[56:59], s11 offen
    s_mov_b32 s11, 26624
    buffer_load_dwordx4 v[32:35], v107, s[56:59], s11 offen
    s_mov_b32 s11, 43008
    buffer_load_dwordx4 v[36:39], v107, s[56:59], s11 offen
    s_mov_b32 s11, 59392
    buffer_load_dwordx4 v[40:43], v107, s[56:59], s11 offen
    s_mov_b32 s11, 11264
    buffer_load_dwordx4 v[44:47], v107, s[56:59], s11 offen
    s_mov_b32 s11, 27648
    buffer_load_dwordx4 v[48:51], v107, s[56:59], s11 offen
    s_mov_b32 s11, 44032
    buffer_load_dwordx4 v[52:55], v107, s[56:59], s11 offen
    s_mov_b32 s11, 60416
    buffer_load_dwordx4 v[56:59], v107, s[56:59], s11 offen
    s_mov_b32 s11, 12288
    buffer_load_dwordx4 v[60:63], v107, s[56:59], s11 offen
    s_mov_b32 s11, 28672
    buffer_load_dwordx4 v[80:83], v107, s[56:59], s11 offen
    s_mov_b32 s11, 45056
    buffer_load_dwordx4 v[84:87], v107, s[56:59], s11 offen
    s_mov_b32 s11, 61440
    buffer_load_dwordx4 v[88:91], v107, s[56:59], s11 offen
    s_mov_b32 s11, 13312
    buffer_load_dwordx4 v[92:95], v107, s[56:59], s11 offen
    v_and_b32 v104, 31, v1
    v_lshrrev_b32 v105, 5, v1
    v_frexp_exp_i32_f32 v106, v72
    v_sub_u32 v106, 0, v106
    v_ldexp_f32 v64, v64, v106
    v_ldexp_f32 v65, v65, v106
    v_ldexp_f32 v66, v66, v106
    v_ldexp_f32 v67, v67, v106
    v_ldexp_f32 v68, v68, v106
    v_ldexp_f32 v69, v69, v106
    v_ldexp_f32 v70, v70, v106
    v_ldexp_f32 v71, v71, v106
    v_ldexp_f32 v72, v72, v106
    v_rcp_f32 v106, v72
    s_nop 0
    v_mul_f32 v64, v64, v106
    v_mul_f32 v65, v65, v106
    v_mul_f32 v66, v66, v106
    v_mul_f32 v67, v67, v106
    v_mul_f32 v68, v68, v106
    v_mul_f32 v69, v69, v106
    v_mul_f32 v70, v70, v106
    v_mul_f32 v71, v71, v106
    v_cvt_pk_bf16_f32 v74, v64, v65
    v_cvt_pk_bf16_f32 v75, v66, v67
    v_cvt_pk_bf16_f32 v76, v68, v69
    v_cvt_pk_bf16_f32 v77, v70, v71
    s_mul_i32 s7, s3, 1040
    s_add_u32 s7, s7, 131072
    v_lshlrev_b32 v108, 5, v104
    v_lshl_add_u32 v108, v105, 3, v108
    v_add_u32 v108, s7, v108
    ds_write_b64 v108, v[74:75]
    ds_write_b64 v108, v[76:77] offset:16
    s_waitcnt lgkmcnt(0)
    s_barrier
    v_and_b32 v108, 7, v1
    s_movk_i32 s7, 1040
    v_mul_lo_u32 v108, v108, s7
    v_lshrrev_b32 v105, 4, v1
    v_lshl_add_u32 v108, v105, 4, v108
    v_add_u32 v108, 131072, v108
    v_mov_b32 v64, 0
    v_mov_b32 v65, 0
    v_mov_b32 v66, 0
    v_mov_b32 v67, 0
    v_mov_b32 v68, 0
    v_mov_b32 v69, 0
    v_mov_b32 v70, 0
    v_mov_b32 v71, 0
    v_mov_b32 v72, 0
    v_mov_b32 v73, 0
    v_mov_b32 v74, 0
    v_mov_b32 v75, 0
    v_mov_b32 v76, 0
    v_mov_b32 v77, 0
    v_mov_b32 v78, 0
    v_mov_b32 v79, 0
    ds_read_b128 v[8:11], v108 offset:0
    ds_read_b128 v[12:15], v108 offset:64
    ds_read_b128 v[16:19], v108 offset:128
    ds_read_b128 v[20:23], v108 offset:192
    s_lshl_b32 s7, s3, 12
    v_add_u32 v106, s7, v107
    s_lshl_b32 s7, s3, 11
    v_add_u32 v109, s7, v107
    v_add_u32 v2, 65536, v106
    v_add_u32 v3, 65536, v109
    s_waitcnt vmcnt(63) lgkmcnt(3)
    v_mfma_f32_16x16x32_bf16 v[64:67], v[8:11], v[148:151], v[64:67]
    s_mov_b32 s11, 29696
    buffer_load_dwordx4 v[148:151], v107, s[56:59], s11 offen
    s_waitcnt vmcnt(63)
    v_mfma_f32_16x16x32_bf16 v[68:71], v[8:11], v[152:155], v[68:71]
    s_mov_b32 s11, 46080
    buffer_load_dwordx4 v[152:155], v107, s[56:59], s11 offen
    s_waitcnt vmcnt(63)
    v_mfma_f32_16x16x32_bf16 v[72:75], v[8:11], v[156:159], v[72:75]
    s_mov_b32 s11, 62464
    buffer_load_dwordx4 v[156:159], v107, s[56:59], s11 offen
    s_waitcnt vmcnt(63)
    v_mfma_f32_16x16x32_bf16 v[76:79], v[8:11], v[160:163], v[76:79]
    s_mov_b32 s11, 14336
    buffer_load_dwordx4 v[160:163], v107, s[56:59], s11 offen
    ds_read_b128 v[8:11], v108 offset:256
    s_waitcnt vmcnt(63) lgkmcnt(3)
    v_mfma_f32_16x16x32_bf16 v[64:67], v[12:15], v[164:167], v[64:67]
    s_mov_b32 s11, 30720
    buffer_load_dwordx4 v[164:167], v107, s[56:59], s11 offen
    s_waitcnt vmcnt(63)
    v_mfma_f32_16x16x32_bf16 v[68:71], v[12:15], v[168:171], v[68:71]
    s_mov_b32 s11, 47104
    buffer_load_dwordx4 v[168:171], v107, s[56:59], s11 offen
    s_waitcnt vmcnt(63)
    v_mfma_f32_16x16x32_bf16 v[72:75], v[12:15], v[172:175], v[72:75]
    s_mov_b32 s11, 63488
    buffer_load_dwordx4 v[172:175], v107, s[56:59], s11 offen
    s_waitcnt vmcnt(63)
    v_mfma_f32_16x16x32_bf16 v[76:79], v[12:15], v[176:179], v[76:79]
    s_mov_b32 s11, 15360
    buffer_load_dwordx4 v[176:179], v107, s[56:59], s11 offen
    ds_read_b128 v[12:15], v108 offset:320
    s_waitcnt vmcnt(63) lgkmcnt(3)
    v_mfma_f32_16x16x32_bf16 v[64:67], v[16:19], v[180:183], v[64:67]
    s_mov_b32 s11, 31744
    buffer_load_dwordx4 v[180:183], v107, s[56:59], s11 offen
    s_waitcnt vmcnt(63)
    v_mfma_f32_16x16x32_bf16 v[68:71], v[16:19], v[184:187], v[68:71]
    s_mov_b32 s11, 48128
    buffer_load_dwordx4 v[184:187], v107, s[56:59], s11 offen
    s_waitcnt vmcnt(63)
    v_mfma_f32_16x16x32_bf16 v[72:75], v[16:19], v[188:191], v[72:75]
    s_mov_b32 s11, 64512
    buffer_load_dwordx4 v[188:191], v107, s[56:59], s11 offen
    s_waitcnt vmcnt(63)
    v_mfma_f32_16x16x32_bf16 v[76:79], v[16:19], v[192:195], v[76:79]
    ds_read_b128 v[16:19], v108 offset:384
    s_waitcnt vmcnt(63) lgkmcnt(3)
    v_mfma_f32_16x16x32_bf16 v[64:67], v[20:23], v[196:199], v[64:67]
    s_waitcnt vmcnt(63)
    v_mfma_f32_16x16x32_bf16 v[68:71], v[20:23], v[200:203], v[68:71]
    s_waitcnt vmcnt(63)
    v_mfma_f32_16x16x32_bf16 v[72:75], v[20:23], v[204:207], v[72:75]
    s_waitcnt vmcnt(63)
    v_mfma_f32_16x16x32_bf16 v[76:79], v[20:23], v[208:211], v[76:79]
    ds_read_b128 v[20:23], v108 offset:448
    s_waitcnt vmcnt(63) lgkmcnt(3)
    v_mfma_f32_16x16x32_bf16 v[64:67], v[8:11], v[212:215], v[64:67]
    s_waitcnt vmcnt(63)
    v_mfma_f32_16x16x32_bf16 v[68:71], v[8:11], v[216:219], v[68:71]
    s_waitcnt vmcnt(63)
    v_mfma_f32_16x16x32_bf16 v[72:75], v[8:11], v[220:223], v[72:75]
    s_waitcnt vmcnt(63)
    v_mfma_f32_16x16x32_bf16 v[76:79], v[8:11], v[224:227], v[76:79]
    ds_read_b128 v[8:11], v108 offset:512
    s_waitcnt vmcnt(46) lgkmcnt(3)
    v_mfma_f32_16x16x32_bf16 v[64:67], v[12:15], v[228:231], v[64:67]
    s_waitcnt vmcnt(45)
    v_mfma_f32_16x16x32_bf16 v[68:71], v[12:15], v[232:235], v[68:71]
    s_waitcnt vmcnt(44)
    v_mfma_f32_16x16x32_bf16 v[72:75], v[12:15], v[236:239], v[72:75]
    s_waitcnt vmcnt(25)
    ds_read_b128 v[192:195], v106 offset:0
    ds_read_b128 v[196:199], v106 offset:1024
    ds_read_b128 v[200:203], v106 offset:2048
    ds_read_b128 v[204:207], v106 offset:3072
    ds_read_b128 v[208:211], v2 offset:0
    ds_read_b128 v[212:215], v2 offset:1024
    ds_read_b128 v[216:219], v2 offset:2048
    ds_read_b128 v[220:223], v2 offset:3072
    ds_read_b128 v[224:227], v109 offset:32768
    ds_read_b128 v[228:231], v109 offset:33792
    ds_read_b128 v[232:235], v3 offset:32768
    ds_read_b128 v[236:239], v3 offset:33792
    s_waitcnt lgkmcnt(0)
    s_waitcnt vmcnt(43)
    v_mfma_f32_16x16x32_bf16 v[76:79], v[12:15], v[240:243], v[76:79]
    ds_read_b128 v[12:15], v108 offset:576
    s_waitcnt vmcnt(42) lgkmcnt(3)
    v_mfma_f32_16x16x32_bf16 v[64:67], v[16:19], v[244:247], v[64:67]
    s_waitcnt vmcnt(41)
    v_mfma_f32_16x16x32_bf16 v[68:71], v[16:19], v[248:251], v[68:71]
    s_waitcnt vmcnt(40)
    v_mfma_f32_16x16x32_bf16 v[72:75], v[16:19], v[252:255], v[72:75]
    v_mfma_f32_16x16x32_bf16 v[76:79], v[16:19], v[192:195], v[76:79]
    ds_read_b128 v[16:19], v108 offset:640
    s_waitcnt  lgkmcnt(3)
    v_mfma_f32_16x16x32_bf16 v[64:67], v[20:23], v[196:199], v[64:67]
    v_mfma_f32_16x16x32_bf16 v[68:71], v[20:23], v[200:203], v[68:71]
    v_mfma_f32_16x16x32_bf16 v[72:75], v[20:23], v[204:207], v[72:75]
    v_mfma_f32_16x16x32_bf16 v[76:79], v[20:23], v[208:211], v[76:79]
    ds_read_b128 v[20:23], v108 offset:704
    s_waitcnt  lgkmcnt(3)
    v_mfma_f32_16x16x32_bf16 v[64:67], v[8:11], v[212:215], v[64:67]
    v_mfma_f32_16x16x32_bf16 v[68:71], v[8:11], v[216:219], v[68:71]
    v_mfma_f32_16x16x32_bf16 v[72:75], v[8:11], v[220:223], v[72:75]
    v_mfma_f32_16x16x32_bf16 v[76:79], v[8:11], v[224:227], v[76:79]
    ds_read_b128 v[8:11], v108 offset:768
    s_waitcnt  lgkmcnt(3)
    v_mfma_f32_16x16x32_bf16 v[64:67], v[12:15], v[228:231], v[64:67]
    v_mfma_f32_16x16x32_bf16 v[68:71], v[12:15], v[232:235], v[68:71]
    v_mfma_f32_16x16x32_bf16 v[72:75], v[12:15], v[236:239], v[72:75]
    s_waitcnt vmcnt(24)
    v_mfma_f32_16x16x32_bf16 v[76:79], v[12:15], v[24:27], v[76:79]
    ds_read_b128 v[12:15], v108 offset:832
    s_waitcnt vmcnt(23) lgkmcnt(3)
    v_mfma_f32_16x16x32_bf16 v[64:67], v[16:19], v[28:31], v[64:67]
    s_waitcnt vmcnt(22)
    v_mfma_f32_16x16x32_bf16 v[68:71], v[16:19], v[32:35], v[68:71]
    s_waitcnt vmcnt(21)
    v_mfma_f32_16x16x32_bf16 v[72:75], v[16:19], v[36:39], v[72:75]
    s_waitcnt vmcnt(20)
    v_mfma_f32_16x16x32_bf16 v[76:79], v[16:19], v[40:43], v[76:79]
    ds_read_b128 v[16:19], v108 offset:896
    s_waitcnt vmcnt(19) lgkmcnt(3)
    v_mfma_f32_16x16x32_bf16 v[64:67], v[20:23], v[44:47], v[64:67]
    s_waitcnt vmcnt(18)
    v_mfma_f32_16x16x32_bf16 v[68:71], v[20:23], v[48:51], v[68:71]
    s_waitcnt vmcnt(17)
    v_mfma_f32_16x16x32_bf16 v[72:75], v[20:23], v[52:55], v[72:75]
    s_waitcnt vmcnt(16)
    v_mfma_f32_16x16x32_bf16 v[76:79], v[20:23], v[56:59], v[76:79]
    ds_read_b128 v[20:23], v108 offset:960
    s_waitcnt vmcnt(15) lgkmcnt(3)
    v_mfma_f32_16x16x32_bf16 v[64:67], v[8:11], v[60:63], v[64:67]
    s_waitcnt vmcnt(14)
    v_mfma_f32_16x16x32_bf16 v[68:71], v[8:11], v[80:83], v[68:71]
    s_waitcnt vmcnt(13)
    v_mfma_f32_16x16x32_bf16 v[72:75], v[8:11], v[84:87], v[72:75]
    s_waitcnt vmcnt(12)
    v_mfma_f32_16x16x32_bf16 v[76:79], v[8:11], v[88:91], v[76:79]
    s_waitcnt vmcnt(11) lgkmcnt(2)
    v_mfma_f32_16x16x32_bf16 v[64:67], v[12:15], v[92:95], v[64:67]
    s_waitcnt vmcnt(10)
    v_mfma_f32_16x16x32_bf16 v[68:71], v[12:15], v[148:151], v[68:71]
    s_waitcnt vmcnt(9)
    v_mfma_f32_16x16x32_bf16 v[72:75], v[12:15], v[152:155], v[72:75]
    s_waitcnt vmcnt(8)
    v_mfma_f32_16x16x32_bf16 v[76:79], v[12:15], v[156:159], v[76:79]
    s_waitcnt vmcnt(7) lgkmcnt(1)
    v_mfma_f32_16x16x32_bf16 v[64:67], v[16:19], v[160:163], v[64:67]
    s_waitcnt vmcnt(6)
    v_mfma_f32_16x16x32_bf16 v[68:71], v[16:19], v[164:167], v[68:71]
    s_waitcnt vmcnt(5)
    v_mfma_f32_16x16x32_bf16 v[72:75], v[16:19], v[168:171], v[72:75]
    s_waitcnt vmcnt(4)
    v_mfma_f32_16x16x32_bf16 v[76:79], v[16:19], v[172:175], v[76:79]
    s_waitcnt vmcnt(3) lgkmcnt(0)
    v_mfma_f32_16x16x32_bf16 v[64:67], v[20:23], v[176:179], v[64:67]
    s_waitcnt vmcnt(2)
    v_mfma_f32_16x16x32_bf16 v[68:71], v[20:23], v[180:183], v[68:71]
    s_waitcnt vmcnt(1)
    v_mfma_f32_16x16x32_bf16 v[72:75], v[20:23], v[184:187], v[72:75]
    s_waitcnt vmcnt(0)
    v_mfma_f32_16x16x32_bf16 v[76:79], v[20:23], v[188:191], v[76:79]
    s_nop 7
    v_cvt_pk_bf16_f32 v64, v64, v64
    v_lshlrev_b32 v64, 16, v64
    v_mul_f32 v64, v64, v110
    v_cvt_pk_bf16_f32 v64, v64, v64
    v_lshlrev_b32 v64, 16, v64
    v_lshlrev_b32 v114, 16, v114
    v_add_f32 v64, v64, v114
    v_cvt_pk_bf16_f32 v64, v64, v64
    v_lshlrev_b32 v64, 16, v64
    v_cvt_pk_bf16_f32 v65, v65, v65
    v_lshlrev_b32 v65, 16, v65
    v_mul_f32 v65, v65, v110
    v_cvt_pk_bf16_f32 v65, v65, v65
    v_lshlrev_b32 v65, 16, v65
    v_lshlrev_b32 v115, 16, v115
    v_add_f32 v65, v65, v115
    v_cvt_pk_bf16_f32 v65, v65, v65
    v_lshlrev_b32 v65, 16, v65
    v_cvt_pk_bf16_f32 v66, v66, v66
    v_lshlrev_b32 v66, 16, v66
    v_mul_f32 v66, v66, v110
    v_cvt_pk_bf16_f32 v66, v66, v66
    v_lshlrev_b32 v66, 16, v66
    v_lshlrev_b32 v116, 16, v116
    v_add_f32 v66, v66, v116
    v_cvt_pk_bf16_f32 v66, v66, v66
    v_lshlrev_b32 v66, 16, v66
    v_cvt_pk_bf16_f32 v67, v67, v67
    v_lshlrev_b32 v67, 16, v67
    v_mul_f32 v67, v67, v110
    v_cvt_pk_bf16_f32 v67, v67, v67
    v_lshlrev_b32 v67, 16, v67
    v_lshlrev_b32 v117, 16, v117
    v_add_f32 v67, v67, v117
    v_cvt_pk_bf16_f32 v67, v67, v67
    v_lshlrev_b32 v67, 16, v67
    v_cvt_pk_bf16_f32 v68, v68, v68
    v_lshlrev_b32 v68, 16, v68
    v_mul_f32 v68, v68, v111
    v_cvt_pk_bf16_f32 v68, v68, v68
    v_lshlrev_b32 v68, 16, v68
    v_lshlrev_b32 v118, 16, v118
    v_add_f32 v68, v68, v118
    v_cvt_pk_bf16_f32 v68, v68, v68
    v_lshlrev_b32 v68, 16, v68
    v_cvt_pk_bf16_f32 v69, v69, v69
    v_lshlrev_b32 v69, 16, v69
    v_mul_f32 v69, v69, v111
    v_cvt_pk_bf16_f32 v69, v69, v69
    v_lshlrev_b32 v69, 16, v69
    v_lshlrev_b32 v119, 16, v119
    v_add_f32 v69, v69, v119
    v_cvt_pk_bf16_f32 v69, v69, v69
    v_lshlrev_b32 v69, 16, v69
    v_cvt_pk_bf16_f32 v70, v70, v70
    v_lshlrev_b32 v70, 16, v70
    v_mul_f32 v70, v70, v111
    v_cvt_pk_bf16_f32 v70, v70, v70
    v_lshlrev_b32 v70, 16, v70
    v_lshlrev_b32 v120, 16, v120
    v_add_f32 v70, v70, v120
    v_cvt_pk_bf16_f32 v70, v70, v70
    v_lshlrev_b32 v70, 16, v70
    v_cvt_pk_bf16_f32 v71, v71, v71
    v_lshlrev_b32 v71, 16, v71
    v_mul_f32 v71, v71, v111
    v_cvt_pk_bf16_f32 v71, v71, v71
    v_lshlrev_b32 v71, 16, v71
    v_lshlrev_b32 v121, 16, v121
    v_add_f32 v71, v71, v121
    v_cvt_pk_bf16_f32 v71, v71, v71
    v_lshlrev_b32 v71, 16, v71
    v_cvt_pk_bf16_f32 v72, v72, v72
    v_lshlrev_b32 v72, 16, v72
    v_mul_f32 v72, v72, v112
    v_cvt_pk_bf16_f32 v72, v72, v72
    v_lshlrev_b32 v72, 16, v72
    v_lshlrev_b32 v122, 16, v122
    v_add_f32 v72, v72, v122
    v_cvt_pk_bf16_f32 v72, v72, v72
    v_lshlrev_b32 v72, 16, v72
    v_cvt_pk_bf16_f32 v73, v73, v73
    v_lshlrev_b32 v73, 16, v73
    v_mul_f32 v73, v73, v112
    v_cvt_pk_bf16_f32 v73, v73, v73
    v_lshlrev_b32 v73, 16, v73
    v_lshlrev_b32 v123, 16, v123
    v_add_f32 v73, v73, v123
    v_cvt_pk_bf16_f32 v73, v73, v73
    v_lshlrev_b32 v73, 16, v73
    v_cvt_pk_bf16_f32 v74, v74, v74
    v_lshlrev_b32 v74, 16, v74
    v_mul_f32 v74, v74, v112
    v_cvt_pk_bf16_f32 v74, v74, v74
    v_lshlrev_b32 v74, 16, v74
    v_lshlrev_b32 v124, 16, v124
    v_add_f32 v74, v74, v124
    v_cvt_pk_bf16_f32 v74, v74, v74
    v_lshlrev_b32 v74, 16, v74
    v_cvt_pk_bf16_f32 v75, v75, v75
    v_lshlrev_b32 v75, 16, v75
    v_mul_f32 v75, v75, v112
    v_cvt_pk_bf16_f32 v75, v75, v75
    v_lshlrev_b32 v75, 16, v75
    v_lshlrev_b32 v125, 16, v125
    v_add_f32 v75, v75, v125
    v_cvt_pk_bf16_f32 v75, v75, v75
    v_lshlrev_b32 v75, 16, v75
    v_cvt_pk_bf16_f32 v76, v76, v76
    v_lshlrev_b32 v76, 16, v76
    v_mul_f32 v76, v76, v113
    v_cvt_pk_bf16_f32 v76, v76, v76
    v_lshlrev_b32 v76, 16, v76
    v_lshlrev_b32 v126, 16, v126
    v_add_f32 v76, v76, v126
    v_cvt_pk_bf16_f32 v76, v76, v76
    v_lshlrev_b32 v76, 16, v76
    v_cvt_pk_bf16_f32 v77, v77, v77
    v_lshlrev_b32 v77, 16, v77
    v_mul_f32 v77, v77, v113
    v_cvt_pk_bf16_f32 v77, v77, v77
    v_lshlrev_b32 v77, 16, v77
    v_lshlrev_b32 v127, 16, v127
    v_add_f32 v77, v77, v127
    v_cvt_pk_bf16_f32 v77, v77, v77
    v_lshlrev_b32 v77, 16, v77
    v_cvt_pk_bf16_f32 v78, v78, v78
    v_lshlrev_b32 v78, 16, v78
    v_mul_f32 v78, v78, v113
    v_cvt_pk_bf16_f32 v78, v78, v78
    v_lshlrev_b32 v78, 16, v78
    v_lshlrev_b32 v128, 16, v128
    v_add_f32 v78, v78, v128
    v_cvt_pk_bf16_f32 v78, v78, v78
    v_lshlrev_b32 v78, 16, v78
    v_cvt_pk_bf16_f32 v79, v79, v79
    v_lshlrev_b32 v79, 16, v79
    v_mul_f32 v79, v79, v113
    v_cvt_pk_bf16_f32 v79, v79, v79
    v_lshlrev_b32 v79, 16, v79
    v_lshlrev_b32 v129, 16, v129
    v_add_f32 v79, v79, v129
    v_cvt_pk_bf16_f32 v79, v79, v79
    v_lshlrev_b32 v79, 16, v79
    s_lshl_b32 s7, s3, 8
    v_and_b32 v104, 15, v1
    v_lshlrev_b32 v108, 2, v104
    v_lshl_add_u32 v108, v105, 13, v108
    v_add_u32 v108, s7, v108
    v_add_u32 v108, 139520, v108
    s_mov_b32 exec_hi, 0
    ds_write_b32 v108, v64 offset:0
    ds_write_b32 v108, v65 offset:2048
    ds_write_b32 v108, v66 offset:4096
    ds_write_b32 v108, v67 offset:6144
    ds_write_b32 v108, v68 offset:64
    ds_write_b32 v108, v69 offset:2112
    ds_write_b32 v108, v70 offset:4160
    ds_write_b32 v108, v71 offset:6208
    ds_write_b32 v108, v72 offset:128
    ds_write_b32 v108, v73 offset:2176
    ds_write_b32 v108, v74 offset:4224
    ds_write_b32 v108, v75 offset:6272
    ds_write_b32 v108, v76 offset:192
    ds_write_b32 v108, v77 offset:2240
    ds_write_b32 v108, v78 offset:4288
    ds_write_b32 v108, v79 offset:6336
    s_mov_b64 exec, -1
    s_waitcnt lgkmcnt(0)
    s_barrier
    s_lshl_b32 s7, s3, 11
    v_lshlrev_b32 v108, 5, v1
    v_add_u32 v108, s7, v108
    v_add_u32 v108, 139520, v108
    ds_read_b128 v[8:11], v108
    ds_read_b128 v[12:15], v108 offset:16
    s_waitcnt lgkmcnt(0)
    v_cvt_pk_bf16_f32 v16, v8, v9
    v_cvt_pk_bf16_f32 v17, v10, v11
    v_cvt_pk_bf16_f32 v18, v12, v13
    v_cvt_pk_bf16_f32 v19, v14, v15
    v_add_f32 v20, v8, v9
    v_add_f32 v20, v20, v10
    v_add_f32 v20, v20, v11
    v_add_f32 v20, v20, v12
    v_add_f32 v20, v20, v13
    v_add_f32 v20, v20, v14
    v_add_f32 v20, v20, v15
    s_nop 1
    v_add_f32_dpp v20, v20, v20 quad_perm:[1,0,3,2] row_mask:0xf bank_mask:0xf
    s_nop 1
    v_add_f32_dpp v20, v20, v20 quad_perm:[2,3,0,1] row_mask:0xf bank_mask:0xf
    s_nop 1
    v_add_f32_dpp v20, v20, v20 row_half_mirror row_mask:0xf bank_mask:0xf
    s_nop 1
    v_add_f32_dpp v20, v20, v20 row_mirror row_mask:0xf bank_mask:0xf
    s_nop 1
    v_readlane_b32 s8, v20, 0
    v_readlane_b32 s9, v20, 16
    v_readlane_b32 s10, v20, 32
    v_readlane_b32 s11, v20, 48
    s_nop 1
    v_mov_b32 v20, s8
    v_add_f32 v20, s9, v20
    v_add_f32 v20, s10, v20
    v_add_f32 v20, s11, v20
    v_mul_f32 v20, 0x3b000000, v20
    v_sub_f32 v8, v8, v20
    v_sub_f32 v9, v9, v20
    v_sub_f32 v10, v10, v20
    v_sub_f32 v11, v11, v20
    v_sub_f32 v12, v12, v20
    v_sub_f32 v13, v13, v20
    v_sub_f32 v14, v14, v20
    v_sub_f32 v15, v15, v20
    v_mul_f32 v21, v8, v8
    v_fmac_f32 v21, v9, v9
    v_fmac_f32 v21, v10, v10
    v_fmac_f32 v21, v11, v11
    v_fmac_f32 v21, v12, v12
    v_fmac_f32 v21, v13, v13
    v_fmac_f32 v21, v14, v14
    v_fmac_f32 v21, v15, v15
    s_nop 1
    v_add_f32_dpp v21, v21, v21 quad_perm:[1,0,3,2] row_mask:0xf bank_mask:0xf
    s_nop 1
    v_add_f32_dpp v21, v21, v21 quad_perm:[2,3,0,1] row_mask:0xf bank_mask:0xf
    s_nop 1
    v_add_f32_dpp v21, v21, v21 row_half_mirror row_mask:0xf bank_mask:0xf
    s_nop 1
    v_add_f32_dpp v21, v21, v21 row_mirror row_mask:0xf bank_mask:0xf
    s_nop 1
    v_readlane_b32 s8, v21, 0
    v_readlane_b32 s9, v21, 16
    v_readlane_b32 s10, v21, 32
    v_readlane_b32 s11, v21, 48
    s_nop 1
    v_mov_b32 v21, s8
    v_add_f32 v21, s9, v21
    v_add_f32 v21, s10, v21
    v_add_f32 v21, s11, v21
    v_mov_b32 v22, 0x3727c5ac
    v_fmac_f32 v22, 0x3b000000, v21
    v_rsq_f32 v22, v22
    s_nop 0
    v_mul_f32 v8, v8, v22
    v_mul_f32 v9, v9, v22
    v_mul_f32 v10, v10, v22
    v_mul_f32 v11, v11, v22
    v_mul_f32 v12, v12, v22
    v_mul_f32 v13, v13, v22
    v_mul_f32 v14, v14, v22
    v_mul_f32 v15, v15, v22
    v_cvt_pk_bf16_f32 v8, v8, v8
    v_lshlrev_b32 v8, 16, v8
    v_cvt_pk_bf16_f32 v9, v9, v9
    v_lshlrev_b32 v9, 16, v9
    v_cvt_pk_bf16_f32 v10, v10, v10
    v_lshlrev_b32 v10, 16, v10
    v_cvt_pk_bf16_f32 v11, v11, v11
    v_lshlrev_b32 v11, 16, v11
    v_cvt_pk_bf16_f32 v12, v12, v12
    v_lshlrev_b32 v12, 16, v12
    v_cvt_pk_bf16_f32 v13, v13, v13
    v_lshlrev_b32 v13, 16, v13
    v_cvt_pk_bf16_f32 v14, v14, v14
    v_lshlrev_b32 v14, 16, v14
    v_cvt_pk_bf16_f32 v15, v15, v15
    v_lshlrev_b32 v15, 16, v15
    v_fma_f32 v8, v8, v130, v138
    v_fma_f32 v9, v9, v131, v139
    v_fma_f32 v10, v10, v132, v140
    v_fma_f32 v11, v11, v133, v141
    v_fma_f32 v12, v12, v134, v142
    v_fma_f32 v13, v13, v135, v143
    v_fma_f32 v14, v14, v136, v144
    v_fma_f32 v15, v15, v137, v145
    v_cvt_pk_bf16_f32 v24, v8, v9
    v_cvt_pk_bf16_f32 v25, v10, v11
    v_cvt_pk_bf16_f32 v26, v12, v13
    v_cvt_pk_bf16_f32 v27, v14, v15
    s_lshl_b32 s7, s6, 10
    v_lshlrev_b32 v108, 4, v1
    v_add_u32 v108, s7, v108
    s_add_u32 s8, s42, 11010048
    s_addc_u32 s9, s43, 0
    global_store_dwordx4 v108, v[16:19], s[8:9]
    s_lshr_b32 s7, s6, 5
    s_lshl_b32 s7, s7, 15
    s_and_b32 s8, s6, 31
    s_lshl_b32 s8, s8, 4
    s_add_u32 s7, s7, s8
    v_lshrrev_b32 v108, 1, v1
    v_lshlrev_b32 v108, 10, v108
    v_and_b32 v109, 1, v1
    v_lshl_add_u32 v108, v109, 9, v108
    v_add_u32 v108, s7, v108
    s_add_u32 s10, s42, 13107200
    s_addc_u32 s11, s43, 0
    global_store_dwordx4 v108, v[24:27], s[10:11]
K3_END:
    s_endpgm
.globl ffn1_kernel
.p2align 8
.type ffn1_kernel,@function
ffn1_kernel:
    s_load_dwordx16 s[16:31], s[0:1], 0
    s_load_dwordx8 s[32:39], s[0:1], 64
    s_load_dwordx4 s[40:43], s[0:1], 96
    s_cmp_ge_u32 s2, 256
    s_cbranch_scc1 K5_END
    v_and_b32 v1, 63, v0
    v_lshrrev_b32 v2, 6, v0
    s_nop 0
    v_readfirstlane_b32 s3, v2
    s_and_b32 s4, s2, 7
    s_lshr_b32 s5, s2, 3
    s_lshr_b32 s6, s4, 1
    s_lshl_b32 s6, s6, 2
    s_and_b32 s7, s5, 3
    s_add_u32 s6, s6, s7
    s_and_b32 s7, s4, 1
    s_lshl_b32 s7, s7, 3
    s_lshr_b32 s8, s5, 2
    s_add_u32 s7, s7, s8
    v_lshlrev_b32 v6, 4, v1
    s_and_b32 s8, s3, 3
    s_lshr_b32 s9, s3, 2
    s_lshl_b32 s10, s6, 2
    s_add_u32 s10, s10, s8
    v_bfe_u32 v2, v1, 4, 1
    s_movk_i32 s11, 7296
    v_mul_lo_u32 v7, v2, s11
    v_lshrrev_b32 v2, 5, v1
    v_lshlrev_b32 v2, 3, v2
    v_bfe_u32 v3, v1, 2, 2
    v_add_u32 v2, v2, v3
    s_movk_i32 s11, 224
    v_mul_lo_u32 v2, v2, s11
    v_add_u32 v7, v7, v2
    v_and_b32 v2, 3, v1
    v_lshl_add_u32 v7, v2, 3, v7
    s_lshl_b32 s11, s9, 7
    v_add_u32 v7, s11, v7
    v_add_u32 v144, 0, v7
    v_add_u32 v145, 22784, v7
    v_add_u32 v146, 45568, v7
    v_add_u32 v147, 68352, v7
    v_add_u32 v148, 91136, v7
    v_add_u32 v149, 113920, v7
    v_add_u32 v150, 136704, v7
    s_lshl_b32 s11, s8, 11
    s_add_u32 s11, s11, 14592
    v_add_u32 v152, 0, v6
    v_add_u32 v152, s11, v152
    v_add_u32 v153, 22784, v6
    v_add_u32 v153, s11, v153
    v_add_u32 v154, 45568, v6
    v_add_u32 v154, s11, v154
    v_add_u32 v155, 68352, v6
    v_add_u32 v155, s11, v155
    v_add_u32 v156, 91136, v6
    v_add_u32 v156, s11, v156
    v_add_u32 v157, 113920, v6
    v_add_u32 v157, s11, v157
    v_add_u32 v158, 136704, v6
    v_add_u32 v158, s11, v158
    s_waitcnt lgkmcnt(0)
    s_add_u32 s44, s3, 0
    s_cmp_ge_u32 s44, 7
    s_cselect_b32 s45, 7, 0
    s_sub_u32 s46, s44, s45
    s_lshl_b32 s46, s46, 10
    s_cmp_ge_u32 s44, 7
    s_cselect_b32 s47, 7296, 0
    s_add_u32 s52, s46, s47
    v_add_u32 v2, s46, v6
    v_mul_u32_u24 v3, 18725, v2
    v_lshrrev_b32 v3, 22, v3
    v_mul_u32_u24 v4, 224, v3
    v_sub_u32 v4, v2, v4
    v_mul_u32_u24 v3, 3584, v3
    v_add_u32 v13, v3, v4
    s_cmp_ge_u32 s44, 7
    s_cselect_b32 s68, s30, s28
    s_cselect_b32 s69, s31, s29
    s_mul_i32 s47, s7, 224
    s_add_u32 s68, s68, s47
    s_addc_u32 s69, s69, 0
    s_sub_u32 s70, 1835008, s47
    s_mov_b32 s71, 0x00020000
    s_mov_b32 s56, 114688
    s_cmp_lt_u32 s44, 14
    s_cbranch_scc1 K5_PC0
    s_sub_u32 s45, s44, 14
    s_lshl_b32 s46, s45, 10
    s_add_u32 s52, s46, 14592
    s_lshr_b32 s46, s45, 1
    s_lshl_b32 s46, s46, 15
    s_and_b32 s47, s45, 1
    s_lshl_b32 s47, s47, 10
    s_add_u32 s46, s46, s47
    s_lshl_b32 s47, s6, 17
    s_add_u32 s46, s46, s47
    s_add_u32 s46, s46, 13107200
    s_add_u32 s68, s42, s46
    s_addc_u32 s69, s43, 0
    s_mov_b32 s70, 32768
    s_mov_b32 s56, 2048
    v_mov_b32 v13, v6
K5_PC0:
    s_add_u32 s44, s3, 8
    s_cmp_ge_u32 s44, 7
    s_cselect_b32 s45, 7, 0
    s_sub_u32 s46, s44, s45
    s_lshl_b32 s46, s46, 10
    s_cmp_ge_u32 s44, 7
    s_cselect_b32 s47, 7296, 0
    s_add_u32 s53, s46, s47
    v_add_u32 v2, s46, v6
    v_mul_u32_u24 v3, 18725, v2
    v_lshrrev_b32 v3, 22, v3
    v_mul_u32_u24 v4, 224, v3
    v_sub_u32 v4, v2, v4
    v_mul_u32_u24 v3, 3584, v3
    v_add_u32 v14, v3, v4
    s_cmp_ge_u32 s44, 7
    s_cselect_b32 s72, s30, s28
    s_cselect_b32 s73, s31, s29
    s_mul_i32 s47, s7, 224
    s_add_u32 s72, s72, s47
    s_addc_u32 s73, s73, 0
    s_sub_u32 s74, 1835008, s47
    s_mov_b32 s75, 0x00020000
    s_mov_b32 s57, 114688
    s_cmp_lt_u32 s44, 14
    s_cbranch_scc1 K5_PC1
    s_sub_u32 s45, s44, 14
    s_lshl_b32 s46, s45, 10
    s_add_u32 s53, s46, 14592
    s_lshr_b32 s46, s45, 1
    s_lshl_b32 s46, s46, 15
    s_and_b32 s47, s45, 1
    s_lshl_b32 s47, s47, 10
    s_add_u32 s46, s46, s47
    s_lshl_b32 s47, s6, 17
    s_add_u32 s46, s46, s47
    s_add_u32 s46, s46, 13107200
    s_add_u32 s72, s42, s46
    s_addc_u32 s73, s43, 0
    s_mov_b32 s74, 32768
    s_mov_b32 s57, 2048
    v_mov_b32 v14, v6
K5_PC1:
    s_add_u32 s44, s3, 16
    s_cmp_ge_u32 s44, 7
    s_cselect_b32 s45, 7, 0
    s_sub_u32 s46, s44, s45
    s_lshl_b32 s46, s46, 10
    s_cmp_ge_u32 s44, 7
    s_cselect_b32 s47, 7296, 0
    s_add_u32 s54, s46, s47
    v_add_u32 v2, s46, v6
    v_mul_u32_u24 v3, 18725, v2
    v_lshrrev_b32 v3, 22, v3
    v_mul_u32_u24 v4, 224, v3
    v_sub_u32 v4, v2, v4
    v_mul_u32_u24 v3, 3584, v3
    v_add_u32 v15, v3, v4
    s_cmp_ge_u32 s44, 7
    s_cselect_b32 s76, s30, s28
    s_cselect_b32 s77, s31, s29
    s_mul_i32 s47, s7, 224
    s_add_u32 s76, s76, s47
    s_addc_u32 s77, s77, 0
    s_sub_u32 s78, 1835008, s47
    s_mov_b32 s79, 0x00020000
    s_mov_b32 s58, 114688
    s_cmp_lt_u32 s44, 14
    s_cbranch_scc1 K5_PC2
    s_sub_u32 s45, s44, 14
    s_lshl_b32 s46, s45, 10
    s_add_u32 s54, s46, 14592
    s_lshr_b32 s46, s45, 1
    s_lshl_b32 s46, s46, 15
    s_and_b32 s47, s45, 1
    s_lshl_b32 s47, s47, 10
    s_add_u32 s46, s46, s47
    s_lshl_b32 s47, s6, 17
    s_add_u32 s46, s46, s47
    s_add_u32 s46, s46, 13107200
    s_add_u32 s76, s42, s46
    s_addc_u32 s77, s43, 0
    s_mov_b32 s78, 32768
    s_mov_b32 s58, 2048
    v_mov_b32 v15, v6
K5_PC2:
    s_add_u32 m0, s52, 0
    s_mul_i32 s46, s56, 0
    buffer_load_dwordx4 v13, s[68:71], s46 offen lds
    s_add_u32 m0, s53, 0
    s_mul_i32 s46, s57, 0
    buffer_load_dwordx4 v14, s[72:75], s46 offen lds
    s_cmp_lt_u32 s3, 6
    s_cbranch_scc0 K5_SKp0
    s_add_u32 m0, s54, 0
    s_mul_i32 s46, s58, 0
    buffer_load_dwordx4 v15, s[76:79], s46 offen lds
K5_SKp0:
    v_mov_b32 v64, 0
    v_mov_b32 v65, 0
    v_mov_b32 v66, 0
    v_mov_b32 v67, 0
    v_mov_b32 v68, 0
    v_mov_b32 v69, 0
    v_mov_b32 v70, 0
    v_mov_b32 v71, 0
    v_mov_b32 v72, 0
    v_mov_b32 v73, 0
    v_mov_b32 v74, 0
    v_mov_b32 v75, 0
    v_mov_b32 v76, 0
    v_mov_b32 v77, 0
    v_mov_b32 v78, 0
    v_mov_b32 v79, 0
    v_mov_b32 v80, 0
    v_mov_b32 v81, 0
    v_mov_b32 v82, 0
    v_mov_b32 v83, 0
    v_mov_b32 v84, 0
    v_mov_b32 v85, 0
    v_mov_b32 v86, 0
    v_mov_b32 v87, 0
    v_mov_b32 v88, 0
    v_mov_b32 v89, 0
    v_mov_b32 v90, 0
    v_mov_b32 v91, 0
    v_mov_b32 v92, 0
    v_mov_b32 v93, 0
    v_mov_b32 v94, 0
    v_mov_b32 v95, 0
    v_mov_b32 v96, 0
    v_mov_b32 v97, 0
    v_mov_b32 v98, 0
    v_mov_b32 v99, 0
    v_mov_b32 v100, 0
    v_mov_b32 v101, 0
    v_mov_b32 v102, 0
    v_mov_b32 v103, 0
    v_mov_b32 v104, 0
    v_mov_b32 v105, 0
    v_mov_b32 v106, 0
    v_mov_b32 v107, 0
    v_mov_b32 v108, 0
    v_mov_b32 v109, 0
    v_mov_b32 v110, 0
    v_mov_b32 v111, 0
    v_mov_b32 v112, 0
    v_mov_b32 v113, 0
    v_mov_b32 v114, 0
    v_mov_b32 v115, 0
    v_mov_b32 v116, 0
    v_mov_b32 v117, 0
    v_mov_b32 v118, 0
    v_mov_b32 v119, 0
    v_mov_b32 v120, 0
    v_mov_b32 v121, 0
    v_mov_b32 v122, 0
    v_mov_b32 v123, 0
    v_mov_b32 v124, 0
    v_mov_b32 v125, 0
    v_mov_b32 v126, 0
    v_mov_b32 v127, 0
    s_waitcnt vmcnt(0)
    s_barrier
    s_mul_i32 s10, s10, 112
    s_mul_i32 s11, s7, 7
    s_add_u32 s10, s10, s11
    s_lshl_b32 s11, s9, 2
    s_add_u32 s10, s10, s11
    s_lshl_b32 s10, s10, 10
    s_add_u32 s10, s10, 15204352
    s_add_u32 s50, s42, s10
    s_addc_u32 s51, s43, 0
    s_cmp_eq_u32 s9, 0
    s_cbranch_scc0 K5_H1
    ds_read_b128 v[128:131], v152 offset:0
    ds_read_b64_tr_b16 v[16:17], v144 offset:0
    ds_read_b64_tr_b16 v[18:19], v144 offset:896
    ds_read_b64_tr_b16 v[20:21], v144 offset:32
    ds_read_b64_tr_b16 v[22:23], v144 offset:928
    ds_read_b64_tr_b16 v[24:25], v144 offset:64
    ds_read_b64_tr_b16 v[26:27], v144 offset:960
    ds_read_b64_tr_b16 v[28:29], v144 offset:96
    ds_read_b64_tr_b16 v[30:31], v144 offset:992
    s_add_u32 m0, s52, 22784
    s_mul_i32 s46, s56, 1
    buffer_load_dwordx4 v13, s[68:71], s46 offen lds
    s_add_u32 m0, s53, 22784
    s_mul_i32 s46, s57, 1
    buffer_load_dwordx4 v14, s[72:75], s46 offen lds
    s_cmp_lt_u32 s3, 6
    s_cbranch_scc0 K5_SKa1
    s_add_u32 m0, s54, 22784
    s_mul_i32 s46, s58, 1
    buffer_load_dwordx4 v15, s[76:79], s46 offen lds
K5_SKa1:
    s_add_u32 m0, s52, 45568
    s_mul_i32 s46, s56, 2
    buffer_load_dwordx4 v13, s[68:71], s46 offen lds
    s_add_u32 m0, s53, 45568
    s_mul_i32 s46, s57, 2
    buffer_load_dwordx4 v14, s[72:75], s46 offen lds
    s_cmp_lt_u32 s3, 6
    s_cbranch_scc0 K5_SKa2
    s_add_u32 m0, s54, 45568
    s_mul_i32 s46, s58, 2
    buffer_load_dwordx4 v15, s[76:79], s46 offen lds
K5_SKa2:
    s_add_u32 m0, s52, 68352
    s_mul_i32 s46, s56, 3
    buffer_load_dwordx4 v13, s[68:71], s46 offen lds
    s_add_u32 m0, s53, 68352
    s_mul_i32 s46, s57, 3
    buffer_load_dwordx4 v14, s[72:75], s46 offen lds
    s_cmp_lt_u32 s3, 6
    s_cbranch_scc0 K5_SKa3
    s_add_u32 m0, s54, 68352
    s_mul_i32 s46, s58, 3
    buffer_load_dwordx4 v15, s[76:79], s46 offen lds
K5_SKa3:
    s_add_u32 m0, s52, 91136
    s_mul_i32 s46, s56, 4
    buffer_load_dwordx4 v13, s[68:71], s46 offen lds
    s_add_u32 m0, s53, 91136
    s_mul_i32 s46, s57, 4
    buffer_load_dwordx4 v14, s[72:75], s46 offen lds
    s_cmp_lt_u32 s3, 6
    s_cbranch_scc0 K5_SKa4
    s_add_u32 m0, s54, 91136
    s_mul_i32 s46, s58, 4
    buffer_load_dwordx4 v15, s[76:79], s46 offen lds
K5_SKa4:
    s_waitcnt lgkmcnt(6)
    v_mfma_f32_32x32x16_bf16 v[64:79], v[16:19], v[128:131], v[64:79]
    ds_read_b128 v[132:135], v152 offset:1024
    ds_read_b64_tr_b16 v[32:33], v144 offset:3584
    ds_read_b64_tr_b16 v[34:35], v144 offset:4480
    s_waitcnt lgkmcnt(7)
    v_mfma_f32_32x32x16_bf16 v[80:95], v[20:23], v[128:131], v[80:95]
    ds_read_b64_tr_b16 v[36:37], v144 offset:3616
    ds_read_b64_tr_b16 v[38:39], v144 offset:4512
    s_waitcnt lgkmcnt(7)
    v_mfma_f32_32x32x16_bf16 v[96:111], v[24:27], v[128:131], v[96:111]
    ds_read_b64_tr_b16 v[40:41], v144 offset:3648
    ds_read_b64_tr_b16 v[42:43], v144 offset:4544
    s_waitcnt vmcnt(6)
    s_barrier
    s_add_u32 m0, s52, 113920
    s_mul_i32 s46, s56, 5
    buffer_load_dwordx4 v13, s[68:71], s46 offen lds
    s_add_u32 m0, s53, 113920
    s_mul_i32 s46, s57, 5
    buffer_load_dwordx4 v14, s[72:75], s46 offen lds
    s_cmp_lt_u32 s3, 6
    s_cbranch_scc0 K5_SKa5
    s_add_u32 m0, s54, 113920
    s_mul_i32 s46, s58, 5
    buffer_load_dwordx4 v15, s[76:79], s46 offen lds
K5_SKa5:
    s_waitcnt lgkmcnt(7)
    v_mfma_f32_32x32x16_bf16 v[112:127], v[28:31], v[128:131], v[112:127]
    ds_read_b64_tr_b16 v[44:45], v144 offset:3680
    ds_read_b64_tr_b16 v[46:47], v144 offset:4576
    s_waitcnt lgkmcnt(6)
    v_mfma_f32_32x32x16_bf16 v[64:79], v[32:35], v[132:135], v[64:79]
    ds_read_b128 v[136:139], v153 offset:0
    ds_read_b64_tr_b16 v[48:49], v145 offset:0
    ds_read_b64_tr_b16 v[50:51], v145 offset:896
    s_waitcnt lgkmcnt(7)
    v_mfma_f32_32x32x16_bf16 v[80:95], v[36:39], v[132:135], v[80:95]
    ds_read_b64_tr_b16 v[52:53], v145 offset:32
    ds_read_b64_tr_b16 v[54:55], v145 offset:928
    s_waitcnt lgkmcnt(7)
    v_mfma_f32_32x32x16_bf16 v[96:111], v[40:43], v[132:135], v[96:111]
    ds_read_b64_tr_b16 v[56:57], v145 offset:64
    ds_read_b64_tr_b16 v[58:59], v145 offset:960
    s_waitcnt lgkmcnt(7)
    v_mfma_f32_32x32x16_bf16 v[112:127], v[44:47], v[132:135], v[112:127]
    ds_read_b64_tr_b16 v[60:61], v145 offset:96
    ds_read_b64_tr_b16 v[62:63], v145 offset:992
    s_waitcnt lgkmcnt(6)
    v_mfma_f32_32x32x16_bf16 v[64:79], v[48:51], v[136:139], v[64:79]
    ds_read_b128 v[140:143], v153 offset:1024
    ds_read_b64_tr_b16 v[16:17], v145 offset:3584
    ds_read_b64_tr_b16 v[18:19], v145 offset:4480
    s_waitcnt lgkmcnt(7)
    v_mfma_f32_32x32x16_bf16 v[80:95], v[52:55], v[136:139], v[80:95]
    ds_read_b64_tr_b16 v[20:21], v145 offset:3616
    ds_read_b64_tr_b16 v[22:23], v145 offset:4512
    s_waitcnt lgkmcnt(7)
    v_mfma_f32_32x32x16_bf16 v[96:111], v[56:59], v[136:139], v[96:111]
    ds_read_b64_tr_b16 v[24:25], v145 offset:3648
    ds_read_b64_tr_b16 v[26:27], v145 offset:4544
    s_waitcnt vmcnt(6)
    s_barrier
    s_add_u32 m0, s52, 136704
    s_mul_i32 s46, s56, 6
    buffer_load_dwordx4 v13, s[68:71], s46 offen lds
    s_add_u32 m0, s53, 136704
    s_mul_i32 s46, s57, 6
    buffer_load_dwordx4 v14, s[72:75], s46 offen lds
    s_cmp_lt_u32 s3, 6
    s_cbranch_scc0 K5_SKa6
    s_add_u32 m0, s54, 136704
    s_mul_i32 s46, s58, 6
    buffer_load_dwordx4 v15, s[76:79], s46 offen lds
K5_SKa6:
    s_waitcnt lgkmcnt(7)
    v_mfma_f32_32x32x16_bf16 v[112:127], v[60:63], v[136:139], v[112:127]
    ds_read_b64_tr_b16 v[28:29], v145 offset:3680
    ds_read_b64_tr_b16 v[30:31], v145 offset:4576
    s_waitcnt lgkmcnt(6)
    v_mfma_f32_32x32x16_bf16 v[64:79], v[16:19], v[140:143], v[64:79]
    ds_read_b128 v[128:131], v154 offset:0
    ds_read_b64_tr_b16 v[32:33], v146 offset:0
    ds_read_b64_tr_b16 v[34:35], v146 offset:896
    s_waitcnt lgkmcnt(7)
    v_mfma_f32_32x32x16_bf16 v[80:95], v[20:23], v[140:143], v[80:95]
    ds_read_b64_tr_b16 v[36:37], v146 offset:32
    ds_read_b64_tr_b16 v[38:39], v146 offset:928
    s_waitcnt lgkmcnt(7)
    v_mfma_f32_32x32x16_bf16 v[96:111], v[24:27], v[140:143], v[96:111]
    ds_read_b64_tr_b16 v[40:41], v146 offset:64
    ds_read_b64_tr_b16 v[42:43], v146 offset:960
    s_waitcnt lgkmcnt(7)
    v_mfma_f32_32x32x16_bf16 v[112:127], v[28:31], v[140:143], v[112:127]
    ds_read_b64_tr_b16 v[44:45], v146 offset:96
    ds_read_b64_tr_b16 v[46:47], v146 offset:992
    s_waitcnt lgkmcnt(6)
    v_mfma_f32_32x32x16_bf16 v[64:79], v[32:35], v[128:131], v[64:79]
    ds_read_b128 v[132:135], v154 offset:1024
    ds_read_b64_tr_b16 v[48:49], v146 offset:3584
    ds_read_b64_tr_b16 v[50:51], v146 offset:4480
    s_waitcnt lgkmcnt(7)
    v_mfma_f32_32x32x16_bf16 v[80:95], v[36:39], v[128:131], v[80:95]
    ds_read_b64_tr_b16 v[52:53], v146 offset:3616
    ds_read_b64_tr_b16 v[54:55], v146 offset:4512
    s_waitcnt lgkmcnt(7)
    v_mfma_f32_32x32x16_bf16 v[96:111], v[40:43], v[128:131], v[96:111]
    ds_read_b64_tr_b16 v[56:57], v146 offset:3648
    ds_read_b64_tr_b16 v[58:59], v146 offset:4544
    s_waitcnt vmcnt(6)
    s_barrier
    s_add_u32 m0, s52, 0
    s_mul_i32 s46, s56, 7
    buffer_load_dwordx4 v13, s[68:71], s46 offen lds
    s_add_u32 m0, s53, 0
    s_mul_i32 s46, s57, 7
    buffer_load_dwordx4 v14, s[72:75], s46 offen lds
    s_cmp_lt_u32 s3, 6
    s_cbranch_scc0 K5_SKa7
    s_add_u32 m0, s54, 0
    s_mul_i32 s46, s58, 7
    buffer_load_dwordx4 v15, s[76:79], s46 offen lds
K5_SKa7:
    s_waitcnt lgkmcnt(7)
    v_mfma_f32_32x32x16_bf16 v[112:127], v[44:47], v[128:131], v[112:127]
    ds_read_b64_tr_b16 v[60:61], v146 offset:3680
    ds_read_b64_tr_b16 v[62:63], v146 offset:4576
    s_waitcnt lgkmcnt(6)
    v_mfma_f32_32x32x16_bf16 v[64:79], v[48:51], v[132:135], v[64:79]
    ds_read_b128 v[136:139], v155 offset:0
    ds_read_b64_tr_b16 v[16:17], v147 offset:0
    ds_read_b64_tr_b16 v[18:19], v147 offset:896
    s_waitcnt lgkmcnt(7)
    v_mfma_f32_32x32x16_bf16 v[80:95], v[52:55], v[132:135], v[80:95]
    ds_read_b64_tr_b16 v[20:21], v147 offset:32
    ds_read_b64_tr_b16 v[22:23], v147 offset:928
    s_waitcnt lgkmcnt(7)
    v_mfma_f32_32x32x16_bf16 v[96:111], v[56:59], v[132:135], v[96:111]
    ds_read_b64_tr_b16 v[24:25], v147 offset:64
    ds_read_b64_tr_b16 v[26:27], v147 offset:960
    s_waitcnt lgkmcnt(7)
    v_mfma_f32_32x32x16_bf16 v[112:127], v[60:63], v[132:135], v[112:127]
    ds_read_b64_tr_b16 v[28:29], v147 offset:96
    ds_read_b64_tr_b16 v[30:31], v147 offset:992
    s_waitcnt lgkmcnt(6)
    v_mfma_f32_32x32x16_bf16 v[64:79], v[16:19], v[136:139], v[64:79]
    ds_read_b128 v[140:143], v155 offset:1024
    ds_read_b64_tr_b16 v[32:33], v147 offset:3584
    ds_read_b64_tr_b16 v[34:35], v147 offset:4480
    s_waitcnt lgkmcnt(7)
    v_mfma_f32_32x32x16_bf16 v[80:95], v[20:23], v[136:139], v[80:95]
    ds_read_b64_tr_b16 v[36:37], v147 offset:3616
    ds_read_b64_tr_b16 v[38:39], v147 offset:4512
    s_waitcnt lgkmcnt(7)
    v_mfma_f32_32x32x16_bf16 v[96:111], v[24:27], v[136:139], v[96:111]
    ds_read_b64_tr_b16 v[40:41], v147 offset:3648
    ds_read_b64_tr_b16 v[42:43], v147 offset:4544
    s_waitcnt vmcnt(6)
    s_barrier
    s_add_u32 m0, s52, 22784
    s_mul_i32 s46, s56, 8
    buffer_load_dwordx4 v13, s[68:71], s46 offen lds
    s_add_u32 m0, s53, 22784
    s_mul_i32 s46, s57, 8
    buffer_load_dwordx4 v14, s[72:75], s46 offen lds
    s_cmp_lt_u32 s3, 6
    s_cbranch_scc0 K5_SKa8
    s_add_u32 m0, s54, 22784
    s_mul_i32 s46, s58, 8
    buffer_load_dwordx4 v15, s[76:79], s46 offen lds
K5_SKa8:
    s_waitcnt lgkmcnt(7)
    v_mfma_f32_32x32x16_bf16 v[112:127], v[28:31], v[136:139], v[112:127]
    ds_read_b64_tr_b16 v[44:45], v147 offset:3680
    ds_read_b64_tr_b16 v[46:47], v147 offset:4576
    s_waitcnt lgkmcnt(6)
    v_mfma_f32_32x32x16_bf16 v[64:79], v[32:35], v[140:143], v[64:79]
    ds_read_b128 v[128:131], v156 offset:0
    ds_read_b64_tr_b16 v[48:49], v148 offset:0
    ds_read_b64_tr_b16 v[50:51], v148 offset:896
    s_waitcnt lgkmcnt(7)
    v_mfma_f32_32x32x16_bf16 v[80:95], v[36:39], v[140:143], v[80:95]
    ds_read_b64_tr_b16 v[52:53], v148 offset:32
    ds_read_b64_tr_b16 v[54:55], v148 offset:928
    s_waitcnt lgkmcnt(7)
    v_mfma_f32_32x32x16_bf16 v[96:111], v[40:43], v[140:143], v[96:111]
    ds_read_b64_tr_b16 v[56:57], v148 offset:64
    ds_read_b64_tr_b16 v[58:59], v148 offset:960
    s_waitcnt lgkmcnt(7)
    v_mfma_f32_32x32x16_bf16 v[112:127], v[44:47], v[140:143], v[112:127]
    ds_read_b64_tr_b16 v[60:61], v148 offset:96
    ds_read_b64_tr_b16 v[62:63], v148 offset:992
    s_waitcnt lgkmcnt(6)
    v_mfma_f32_32x32x16_bf16 v[64:79], v[48:51], v[128:131], v[64:79]
    ds_read_b128 v[132:135], v156 offset:1024
    ds_read_b64_tr_b16 v[16:17], v148 offset:3584
    ds_read_b64_tr_b16 v[18:19], v148 offset:4480
    s_waitcnt lgkmcnt(7)
    v_mfma_f32_32x32x16_bf16 v[80:95], v[52:55], v[128:131], v[80:95]
    ds_read_b64_tr_b16 v[20:21], v148 offset:3616
    ds_read_b64_tr_b16 v[22:23], v148 offset:4512
    s_waitcnt lgkmcnt(7)
    v_mfma_f32_32x32x16_bf16 v[96:111], v[56:59], v[128:131], v[96:111]
    ds_read_b64_tr_b16 v[24:25], v148 offset:3648
    ds_read_b64_tr_b16 v[26:27], v148 offset:4544
    s_waitcnt vmcnt(6)
    s_barrier
    s_add_u32 m0, s52, 45568
    s_mul_i32 s46, s56, 9
    buffer_load_dwordx4 v13, s[68:71], s46 offen lds
    s_add_u32 m0, s53, 45568
    s_mul_i32 s46, s57, 9
    buffer_load_dwordx4 v14, s[72:75], s46 offen lds
    s_cmp_lt_u32 s3, 6
    s_cbranch_scc0 K5_SKa9
    s_add_u32 m0, s54, 45568
    s_mul_i32 s46, s58, 9
    buffer_load_dwordx4 v15, s[76:79], s46 offen lds
K5_SKa9:
    s_waitcnt lgkmcnt(7)
    v_mfma_f32_32x32x16_bf16 v[112:127], v[60:63], v[128:131], v[112:127]
    ds_read_b64_tr_b16 v[28:29], v148 offset:3680
    ds_read_b64_tr_b16 v[30:31], v148 offset:4576
    s_waitcnt lgkmcnt(6)
    v_mfma_f32_32x32x16_bf16 v[64:79], v[16:19], v[132:135], v[64:79]
    ds_read_b128 v[136:139], v157 offset:0
    ds_read_b64_tr_b16 v[32:33], v149 offset:0
    ds_read_b64_tr_b16 v[34:35], v149 offset:896
    s_waitcnt lgkmcnt(7)
    v_mfma_f32_32x32x16_bf16 v[80:95], v[20:23], v[132:135], v[80:95]
    ds_read_b64_tr_b16 v[36:37], v149 offset:32
    ds_read_b64_tr_b16 v[38:39], v149 offset:928
    s_waitcnt lgkmcnt(7)
    v_mfma_f32_32x32x16_bf16 v[96:111], v[24:27], v[132:135], v[96:111]
    ds_read_b64_tr_b16 v[40:41], v149 offset:64
    ds_read_b64_tr_b16 v[42:43], v149 offset:960
    s_waitcnt lgkmcnt(7)
    v_mfma_f32_32x32x16_bf16 v[112:127], v[28:31], v[132:135], v[112:127]
    ds_read_b64_tr_b16 v[44:45], v149 offset:96
    ds_read_b64_tr_b16 v[46:47], v149 offset:992
    s_waitcnt lgkmcnt(6)
    v_mfma_f32_32x32x16_bf16 v[64:79], v[32:35], v[136:139], v[64:79]
    ds_read_b128 v[140:143], v157 offset:1024
    ds_read_b64_tr_b16 v[48:49], v149 offset:3584
    ds_read_b64_tr_b16 v[50:51], v149 offset:4480
    s_waitcnt lgkmcnt(7)
    v_mfma_f32_32x32x16_bf16 v[80:95], v[36:39], v[136:139], v[80:95]
    ds_read_b64_tr_b16 v[52:53], v149 offset:3616
    ds_read_b64_tr_b16 v[54:55], v149 offset:4512
    s_waitcnt lgkmcnt(7)
    v_mfma_f32_32x32x16_bf16 v[96:111], v[40:43], v[136:139], v[96:111]
    ds_read_b64_tr_b16 v[56:57], v149 offset:3648
    ds_read_b64_tr_b16 v[58:59], v149 offset:4544
    s_waitcnt vmcnt(6)
    s_barrier
    s_add_u32 m0, s52, 68352
    s_mul_i32 s46, s56, 10
    buffer_load_dwordx4 v13, s[68:71], s46 offen lds
    s_add_u32 m0, s53, 68352
    s_mul_i32 s46, s57, 10
    buffer_load_dwordx4 v14, s[72:75], s46 offen lds
    s_cmp_lt_u32 s3, 6
    s_cbranch_scc0 K5_SKa10
    s_add_u32 m0, s54, 68352
    s_mul_i32 s46, s58, 10
    buffer_load_dwordx4 v15, s[76:79], s46 offen lds
K5_SKa10:
    s_waitcnt lgkmcnt(7)
    v_mfma_f32_32x32x16_bf16 v[112:127], v[44:47], v[136:139], v[112:127]
    ds_read_b64_tr_b16 v[60:61], v149 offset:3680
    ds_read_b64_tr_b16 v[62:63], v149 offset:4576
    s_waitcnt lgkmcnt(6)
    v_mfma_f32_32x32x16_bf16 v[64:79], v[48:51], v[140:143], v[64:79]
    ds_read_b128 v[128:131], v158 offset:0
    ds_read_b64_tr_b16 v[16:17], v150 offset:0
    ds_read_b64_tr_b16 v[18:19], v150 offset:896
    s_waitcnt lgkmcnt(7)
    v_mfma_f32_32x32x16_bf16 v[80:95], v[52:55], v[140:143], v[80:95]
    ds_read_b64_tr_b16 v[20:21], v150 offset:32
    ds_read_b64_tr_b16 v[22:23], v150 offset:928
    s_waitcnt lgkmcnt(7)
    v_mfma_f32_32x32x16_bf16 v[96:111], v[56:59], v[140:143], v[96:111]
    ds_read_b64_tr_b16 v[24:25], v150 offset:64
    ds_read_b64_tr_b16 v[26:27], v150 offset:960
    s_waitcnt lgkmcnt(7)
    v_mfma_f32_32x32x16_bf16 v[112:127], v[60:63], v[140:143], v[112:127]
    ds_read_b64_tr_b16 v[28:29], v150 offset:96
    ds_read_b64_tr_b16 v[30:31], v150 offset:992
    s_waitcnt lgkmcnt(6)
    v_mfma_f32_32x32x16_bf16 v[64:79], v[16:19], v[128:131], v[64:79]
    ds_read_b128 v[132:135], v158 offset:1024
    ds_read_b64_tr_b16 v[32:33], v150 offset:3584
    ds_read_b64_tr_b16 v[34:35], v150 offset:4480
    s_waitcnt lgkmcnt(7)
    v_mfma_f32_32x32x16_bf16 v[80:95], v[20:23], v[128:131], v[80:95]
    ds_read_b64_tr_b16 v[36:37], v150 offset:3616
    ds_read_b64_tr_b16 v[38:39], v150 offset:4512
    s_waitcnt lgkmcnt(7)
    v_mfma_f32_32x32x16_bf16 v[96:111], v[24:27], v[128:131], v[96:111]
    ds_read_b64_tr_b16 v[40:41], v150 offset:3648
    ds_read_b64_tr_b16 v[42:43], v150 offset:4544
    s_waitcnt vmcnt(6)
    s_barrier
    s_add_u32 m0, s52, 91136
    s_mul_i32 s46, s56, 11
    buffer_load_dwordx4 v13, s[68:71], s46 offen lds
    s_add_u32 m0, s53, 91136
    s_mul_i32 s46, s57, 11
    buffer_load_dwordx4 v14, s[72:75], s46 offen lds
    s_cmp_lt_u32 s3, 6
    s_cbranch_scc0 K5_SKa11
    s_add_u32 m0, s54, 91136
    s_mul_i32 s46, s58, 11
    buffer_load_dwordx4 v15, s[76:79], s46 offen lds
K5_SKa11:
    s_waitcnt lgkmcnt(7)
    v_mfma_f32_32x32x16_bf16 v[112:127], v[28:31], v[128:131], v[112:127]
    ds_read_b64_tr_b16 v[44:45], v150 offset:3680
    ds_read_b64_tr_b16 v[46:47], v150 offset:4576
    s_waitcnt lgkmcnt(6)
    v_mfma_f32_32x32x16_bf16 v[64:79], v[32:35], v[132:135], v[64:79]
    ds_read_b128 v[136:139], v152 offset:0
    ds_read_b64_tr_b16 v[48:49], v144 offset:0
    ds_read_b64_tr_b16 v[50:51], v144 offset:896
    s_waitcnt lgkmcnt(7)
    v_mfma_f32_32x32x16_bf16 v[80:95], v[36:39], v[132:135], v[80:95]
    ds_read_b64_tr_b16 v[52:53], v144 offset:32
    ds_read_b64_tr_b16 v[54:55], v144 offset:928
    s_waitcnt lgkmcnt(7)
    v_mfma_f32_32x32x16_bf16 v[96:111], v[40:43], v[132:135], v[96:111]
    ds_read_b64_tr_b16 v[56:57], v144 offset:64
    ds_read_b64_tr_b16 v[58:59], v144 offset:960
    s_waitcnt lgkmcnt(7)
    v_mfma_f32_32x32x16_bf16 v[112:127], v[44:47], v[132:135], v[112:127]
    ds_read_b64_tr_b16 v[60:61], v144 offset:96
    ds_read_b64_tr_b16 v[62:63], v144 offset:992
    s_waitcnt lgkmcnt(6)
    v_mfma_f32_32x32x16_bf16 v[64:79], v[48:51], v[136:139], v[64:79]
    ds_read_b128 v[140:143], v152 offset:1024
    ds_read_b64_tr_b16 v[16:17], v144 offset:3584
    ds_read_b64_tr_b16 v[18:19], v144 offset:4480
    s_waitcnt lgkmcnt(7)
    v_mfma_f32_32x32x16_bf16 v[80:95], v[52:55], v[136:139], v[80:95]
    ds_read_b64_tr_b16 v[20:21], v144 offset:3616
    ds_read_b64_tr_b16 v[22:23], v144 offset:4512
    s_waitcnt lgkmcnt(7)
    v_mfma_f32_32x32x16_bf16 v[96:111], v[56:59], v[136:139], v[96:111]
    ds_read_b64_tr_b16 v[24:25], v144 offset:3648
    ds_read_b64_tr_b16 v[26:27], v144 offset:4544
    s_waitcnt vmcnt(6)
    s_barrier
    s_add_u32 m0, s52, 113920
    s_mul_i32 s46, s56, 12
    buffer_load_dwordx4 v13, s[68:71], s46 offen lds
    s_add_u32 m0, s53, 113920
    s_mul_i32 s46, s57, 12
    buffer_load_dwordx4 v14, s[72:75], s46 offen lds
    s_cmp_lt_u32 s3, 6
    s_cbranch_scc0 K5_SKa12
    s_add_u32 m0, s54, 113920
    s_mul_i32 s46, s58, 12
    buffer_load_dwordx4 v15, s[76:79], s46 offen lds
K5_SKa12:
    s_waitcnt lgkmcnt(7)
    v_mfma_f32_32x32x16_bf16 v[112:127], v[60:63], v[136:139], v[112:127]
    ds_read_b64_tr_b16 v[28:29], v144 offset:3680
    ds_read_b64_tr_b16 v[30:31], v144 offset:4576
    s_waitcnt lgkmcnt(6)
    v_mfma_f32_32x32x16_bf16 v[64:79], v[16:19], v[140:143], v[64:79]
    ds_read_b128 v[128:131], v153 offset:0
    ds_read_b64_tr_b16 v[32:33], v145 offset:0
    ds_read_b64_tr_b16 v[34:35], v145 offset:896
    s_waitcnt lgkmcnt(7)
    v_mfma_f32_32x32x16_bf16 v[80:95], v[20:23], v[140:143], v[80:95]
    ds_read_b64_tr_b16 v[36:37], v145 offset:32
    ds_read_b64_tr_b16 v[38:39], v145 offset:928
    s_waitcnt lgkmcnt(7)
    v_mfma_f32_32x32x16_bf16 v[96:111], v[24:27], v[140:143], v[96:111]
    ds_read_b64_tr_b16 v[40:41], v145 offset:64
    ds_read_b64_tr_b16 v[42:43], v145 offset:960
    s_waitcnt lgkmcnt(7)
    v_mfma_f32_32x32x16_bf16 v[112:127], v[28:31], v[140:143], v[112:127]
    ds_read_b64_tr_b16 v[44:45], v145 offset:96
    ds_read_b64_tr_b16 v[46:47], v145 offset:992
    s_waitcnt lgkmcnt(6)
    v_mfma_f32_32x32x16_bf16 v[64:79], v[32:35], v[128:131], v[64:79]
    ds_read_b128 v[132:135], v153 offset:1024
    ds_read_b64_tr_b16 v[48:49], v145 offset:3584
    ds_read_b64_tr_b16 v[50:51], v145 offset:4480
    s_waitcnt lgkmcnt(7)
    v_mfma_f32_32x32x16_bf16 v[80:95], v[36:39], v[128:131], v[80:95]
    ds_read_b64_tr_b16 v[52:53], v145 offset:3616
    ds_read_b64_tr_b16 v[54:55], v145 offset:4512
    s_waitcnt lgkmcnt(7)
    v_mfma_f32_32x32x16_bf16 v[96:111], v[40:43], v[128:131], v[96:111]
    ds_read_b64_tr_b16 v[56:57], v145 offset:3648
    ds_read_b64_tr_b16 v[58:59], v145 offset:4544
    s_waitcnt vmcnt(6)
    s_barrier
    s_add_u32 m0, s52, 136704
    s_mul_i32 s46, s56, 13
    buffer_load_dwordx4 v13, s[68:71], s46 offen lds
    s_add_u32 m0, s53, 136704
    s_mul_i32 s46, s57, 13
    buffer_load_dwordx4 v14, s[72:75], s46 offen lds
    s_cmp_lt_u32 s3, 6
    s_cbranch_scc0 K5_SKa13
    s_add_u32 m0, s54, 136704
    s_mul_i32 s46, s58, 13
    buffer_load_dwordx4 v15, s[76:79], s46 offen lds
K5_SKa13:
    s_waitcnt lgkmcnt(7)
    v_mfma_f32_32x32x16_bf16 v[112:127], v[44:47], v[128:131], v[112:127]
    ds_read_b64_tr_b16 v[60:61], v145 offset:3680
    ds_read_b64_tr_b16 v[62:63], v145 offset:4576
    s_waitcnt lgkmcnt(6)
    v_mfma_f32_32x32x16_bf16 v[64:79], v[48:51], v[132:135], v[64:79]
    ds_read_b128 v[136:139], v154 offset:0
    ds_read_b64_tr_b16 v[16:17], v146 offset:0
    ds_read_b64_tr_b16 v[18:19], v146 offset:896
    s_waitcnt lgkmcnt(7)
    v_mfma_f32_32x32x16_bf16 v[80:95], v[52:55], v[132:135], v[80:95]
    ds_read_b64_tr_b16 v[20:21], v146 offset:32
    ds_read_b64_tr_b16 v[22:23], v146 offset:928
    s_waitcnt lgkmcnt(7)
    v_mfma_f32_32x32x16_bf16 v[96:111], v[56:59], v[132:135], v[96:111]
    ds_read_b64_tr_b16 v[24:25], v146 offset:64
    ds_read_b64_tr_b16 v[26:27], v146 offset:960
    s_waitcnt lgkmcnt(7)
    v_mfma_f32_32x32x16_bf16 v[112:127], v[60:63], v[132:135], v[112:127]
    ds_read_b64_tr_b16 v[28:29], v146 offset:96
    ds_read_b64_tr_b16 v[30:31], v146 offset:992
    s_waitcnt lgkmcnt(6)
    v_mfma_f32_32x32x16_bf16 v[64:79], v[16:19], v[136:139], v[64:79]
    ds_read_b128 v[140:143], v154 offset:1024
    ds_read_b64_tr_b16 v[32:33], v146 offset:3584
    ds_read_b64_tr_b16 v[34:35], v146 offset:4480
    s_waitcnt lgkmcnt(7)
    v_mfma_f32_32x32x16_bf16 v[80:95], v[20:23], v[136:139], v[80:95]
    ds_read_b64_tr_b16 v[36:37], v146 offset:3616
    ds_read_b64_tr_b16 v[38:39], v146 offset:4512
    s_waitcnt lgkmcnt(7)
    v_mfma_f32_32x32x16_bf16 v[96:111], v[24:27], v[136:139], v[96:111]
    ds_read_b64_tr_b16 v[40:41], v146 offset:3648
    ds_read_b64_tr_b16 v[42:43], v146 offset:4544
    s_waitcnt vmcnt(6)
    s_barrier
    s_add_u32 m0, s52, 0
    s_mul_i32 s46, s56, 14
    buffer_load_dwordx4 v13, s[68:71], s46 offen lds
    s_add_u32 m0, s53, 0
    s_mul_i32 s46, s57, 14
    buffer_load_dwordx4 v14, s[72:75], s46 offen lds
    s_cmp_lt_u32 s3, 6
    s_cbranch_scc0 K5_SKa14
    s_add_u32 m0, s54, 0
    s_mul_i32 s46, s58, 14
    buffer_load_dwordx4 v15, s[76:79], s46 offen lds
K5_SKa14:
    s_waitcnt lgkmcnt(7)
    v_mfma_f32_32x32x16_bf16 v[112:127], v[28:31], v[136:139], v[112:127]
    ds_read_b64_tr_b16 v[44:45], v146 offset:3680
    ds_read_b64_tr_b16 v[46:47], v146 offset:4576
    s_waitcnt lgkmcnt(6)
    v_mfma_f32_32x32x16_bf16 v[64:79], v[32:35], v[140:143], v[64:79]
    ds_read_b128 v[128:131], v155 offset:0
    ds_read_b64_tr_b16 v[48:49], v147 offset:0
    ds_read_b64_tr_b16 v[50:51], v147 offset:896
    s_waitcnt lgkmcnt(7)
    v_mfma_f32_32x32x16_bf16 v[80:95], v[36:39], v[140:143], v[80:95]
    ds_read_b64_tr_b16 v[52:53], v147 offset:32
    ds_read_b64_tr_b16 v[54:55], v147 offset:928
    s_waitcnt lgkmcnt(7)
    v_mfma_f32_32x32x16_bf16 v[96:111], v[40:43], v[140:143], v[96:111]
    ds_read_b64_tr_b16 v[56:57], v147 offset:64
    ds_read_b64_tr_b16 v[58:59], v147 offset:960
    s_waitcnt lgkmcnt(7)
    v_mfma_f32_32x32x16_bf16 v[112:127], v[44:47], v[140:143], v[112:127]
    ds_read_b64_tr_b16 v[60:61], v147 offset:96
    ds_read_b64_tr_b16 v[62:63], v147 offset:992
    s_waitcnt lgkmcnt(6)
    v_mfma_f32_32x32x16_bf16 v[64:79], v[48:51], v[128:131], v[64:79]
    ds_read_b128 v[132:135], v155 offset:1024
    ds_read_b64_tr_b16 v[16:17], v147 offset:3584
    ds_read_b64_tr_b16 v[18:19], v147 offset:4480
    s_waitcnt lgkmcnt(7)
    v_mfma_f32_32x32x16_bf16 v[80:95], v[52:55], v[128:131], v[80:95]
    ds_read_b64_tr_b16 v[20:21], v147 offset:3616
    ds_read_b64_tr_b16 v[22:23], v147 offset:4512
    s_waitcnt lgkmcnt(7)
    v_mfma_f32_32x32x16_bf16 v[96:111], v[56:59], v[128:131], v[96:111]
    ds_read_b64_tr_b16 v[24:25], v147 offset:3648
    ds_read_b64_tr_b16 v[26:27], v147 offset:4544
    s_waitcnt vmcnt(6)
    s_barrier
    s_add_u32 m0, s52, 22784
    s_mul_i32 s46, s56, 15
    buffer_load_dwordx4 v13, s[68:71], s46 offen lds
    s_add_u32 m0, s53, 22784
    s_mul_i32 s46, s57, 15
    buffer_load_dwordx4 v14, s[72:75], s46 offen lds
    s_cmp_lt_u32 s3, 6
    s_cbranch_scc0 K5_SKa15
    s_add_u32 m0, s54, 22784
    s_mul_i32 s46, s58, 15
    buffer_load_dwordx4 v15, s[76:79], s46 offen lds
K5_SKa15:
    s_waitcnt lgkmcnt(7)
    v_mfma_f32_32x32x16_bf16 v[112:127], v[60:63], v[128:131], v[112:127]
    ds_read_b64_tr_b16 v[28:29], v147 offset:3680
    ds_read_b64_tr_b16 v[30:31], v147 offset:4576
    s_waitcnt lgkmcnt(6)
    v_mfma_f32_32x32x16_bf16 v[64:79], v[16:19], v[132:135], v[64:79]
    ds_read_b128 v[136:139], v156 offset:0
    ds_read_b64_tr_b16 v[32:33], v148 offset:0
    ds_read_b64_tr_b16 v[34:35], v148 offset:896
    s_waitcnt lgkmcnt(7)
    v_mfma_f32_32x32x16_bf16 v[80:95], v[20:23], v[132:135], v[80:95]
    ds_read_b64_tr_b16 v[36:37], v148 offset:32
    ds_read_b64_tr_b16 v[38:39], v148 offset:928
    s_waitcnt lgkmcnt(7)
    v_mfma_f32_32x32x16_bf16 v[96:111], v[24:27], v[132:135], v[96:111]
    ds_read_b64_tr_b16 v[40:41], v148 offset:64
    ds_read_b64_tr_b16 v[42:43], v148 offset:960
    s_waitcnt lgkmcnt(7)
    v_mfma_f32_32x32x16_bf16 v[112:127], v[28:31], v[132:135], v[112:127]
    ds_read_b64_tr_b16 v[44:45], v148 offset:96
    ds_read_b64_tr_b16 v[46:47], v148 offset:992
    s_waitcnt lgkmcnt(6)
    v_mfma_f32_32x32x16_bf16 v[64:79], v[32:35], v[136:139], v[64:79]
    ds_read_b128 v[140:143], v156 offset:1024
    ds_read_b64_tr_b16 v[48:49], v148 offset:3584
    ds_read_b64_tr_b16 v[50:51], v148 offset:4480
    s_waitcnt lgkmcnt(7)
    v_mfma_f32_32x32x16_bf16 v[80:95], v[36:39], v[136:139], v[80:95]
    ds_read_b64_tr_b16 v[52:53], v148 offset:3616
    ds_read_b64_tr_b16 v[54:55], v148 offset:4512
    s_waitcnt lgkmcnt(7)
    v_mfma_f32_32x32x16_bf16 v[96:111], v[40:43], v[136:139], v[96:111]
    ds_read_b64_tr_b16 v[56:57], v148 offset:3648
    ds_read_b64_tr_b16 v[58:59], v148 offset:4544
    s_waitcnt vmcnt(6)
    s_barrier
    s_waitcnt lgkmcnt(7)
    v_mfma_f32_32x32x16_bf16 v[112:127], v[44:47], v[136:139], v[112:127]
    ds_read_b64_tr_b16 v[60:61], v148 offset:3680
    ds_read_b64_tr_b16 v[62:63], v148 offset:4576
    s_waitcnt lgkmcnt(6)
    v_mfma_f32_32x32x16_bf16 v[64:79], v[48:51], v[140:143], v[64:79]
    ds_read_b128 v[128:131], v157 offset:0
    ds_read_b64_tr_b16 v[16:17], v149 offset:0
    ds_read_b64_tr_b16 v[18:19], v149 offset:896
    s_waitcnt lgkmcnt(7)
    v_mfma_f32_32x32x16_bf16 v[80:95], v[52:55], v[140:143], v[80:95]
    ds_read_b64_tr_b16 v[20:21], v149 offset:32
    ds_read_b64_tr_b16 v[22:23], v149 offset:928
    s_waitcnt lgkmcnt(7)
    v_mfma_f32_32x32x16_bf16 v[96:111], v[56:59], v[140:143], v[96:111]
    ds_read_b64_tr_b16 v[24:25], v149 offset:64
    ds_read_b64_tr_b16 v[26:27], v149 offset:960
    s_waitcnt lgkmcnt(7)
    v_mfma_f32_32x32x16_bf16 v[112:127], v[60:63], v[140:143], v[112:127]
    ds_read_b64_tr_b16 v[28:29], v149 offset:96
    ds_read_b64_tr_b16 v[30:31], v149 offset:992
    s_waitcnt lgkmcnt(6)
    v_mfma_f32_32x32x16_bf16 v[64:79], v[16:19], v[128:131], v[64:79]
    ds_read_b128 v[132:135], v157 offset:1024
    ds_read_b64_tr_b16 v[32:33], v149 offset:3584
    ds_read_b64_tr_b16 v[34:35], v149 offset:4480
    s_waitcnt lgkmcnt(7)
    v_mfma_f32_32x32x16_bf16 v[80:95], v[20:23], v[128:131], v[80:95]
    ds_read_b64_tr_b16 v[36:37], v149 offset:3616
    ds_read_b64_tr_b16 v[38:39], v149 offset:4512
    s_waitcnt lgkmcnt(7)
    v_mfma_f32_32x32x16_bf16 v[96:111], v[24:27], v[128:131], v[96:111]
    ds_read_b64_tr_b16 v[40:41], v149 offset:3648
    ds_read_b64_tr_b16 v[42:43], v149 offset:4544
    s_waitcnt vmcnt(4)
    s_barrier
    s_waitcnt lgkmcnt(7)
    v_mfma_f32_32x32x16_bf16 v[112:127], v[28:31], v[128:131], v[112:127]
    ds_read_b64_tr_b16 v[44:45], v149 offset:3680
    ds_read_b64_tr_b16 v[46:47], v149 offset:4576
    s_waitcnt lgkmcnt(6)
    v_mfma_f32_32x32x16_bf16 v[64:79], v[32:35], v[132:135], v[64:79]
    ds_read_b128 v[136:139], v158 offset:0
    ds_read_b64_tr_b16 v[48:49], v150 offset:0
    ds_read_b64_tr_b16 v[50:51], v150 offset:896
    s_waitcnt lgkmcnt(7)
    v_mfma_f32_32x32x16_bf16 v[80:95], v[36:39], v[132:135], v[80:95]
    ds_read_b64_tr_b16 v[52:53], v150 offset:32
    ds_read_b64_tr_b16 v[54:55], v150 offset:928
    s_waitcnt lgkmcnt(7)
    v_mfma_f32_32x32x16_bf16 v[96:111], v[40:43], v[132:135], v[96:111]
    ds_read_b64_tr_b16 v[56:57], v150 offset:64
    ds_read_b64_tr_b16 v[58:59], v150 offset:960
    s_waitcnt lgkmcnt(7)
    v_mfma_f32_32x32x16_bf16 v[112:127], v[44:47], v[132:135], v[112:127]
    ds_read_b64_tr_b16 v[60:61], v150 offset:96
    ds_read_b64_tr_b16 v[62:63], v150 offset:992
    s_waitcnt lgkmcnt(6)
    v_mfma_f32_32x32x16_bf16 v[64:79], v[48:51], v[136:139], v[64:79]
    ds_read_b128 v[140:143], v158 offset:1024
    ds_read_b64_tr_b16 v[16:17], v150 offset:3584
    ds_read_b64_tr_b16 v[18:19], v150 offset:4480
    s_waitcnt lgkmcnt(7)
    v_mfma_f32_32x32x16_bf16 v[80:95], v[52:55], v[136:139], v[80:95]
    ds_read_b64_tr_b16 v[20:21], v150 offset:3616
    ds_read_b64_tr_b16 v[22:23], v150 offset:4512
    s_waitcnt lgkmcnt(7)
    v_mfma_f32_32x32x16_bf16 v[96:111], v[56:59], v[136:139], v[96:111]
    ds_read_b64_tr_b16 v[24:25], v150 offset:3648
    ds_read_b64_tr_b16 v[26:27], v150 offset:4544
    s_waitcnt vmcnt(2)
    s_barrier
    s_waitcnt lgkmcnt(7)
    v_mfma_f32_32x32x16_bf16 v[112:127], v[60:63], v[136:139], v[112:127]
    ds_read_b64_tr_b16 v[28:29], v150 offset:3680
    ds_read_b64_tr_b16 v[30:31], v150 offset:4576
    s_waitcnt lgkmcnt(6)
    v_mfma_f32_32x32x16_bf16 v[64:79], v[16:19], v[140:143], v[64:79]
    ds_read_b128 v[128:131], v152 offset:0
    ds_read_b64_tr_b16 v[32:33], v144 offset:0
    ds_read_b64_tr_b16 v[34:35], v144 offset:896
    s_waitcnt lgkmcnt(7)
    v_mfma_f32_32x32x16_bf16 v[80:95], v[20:23], v[140:143], v[80:95]
    ds_read_b64_tr_b16 v[36:37], v144 offset:32
    ds_read_b64_tr_b16 v[38:39], v144 offset:928
    s_waitcnt lgkmcnt(7)
    v_mfma_f32_32x32x16_bf16 v[96:111], v[24:27], v[140:143], v[96:111]
    ds_read_b64_tr_b16 v[40:41], v144 offset:64
    ds_read_b64_tr_b16 v[42:43], v144 offset:960
    s_waitcnt lgkmcnt(7)
    v_mfma_f32_32x32x16_bf16 v[112:127], v[28:31], v[140:143], v[112:127]
    ds_read_b64_tr_b16 v[44:45], v144 offset:96
    ds_read_b64_tr_b16 v[46:47], v144 offset:992
    s_waitcnt lgkmcnt(6)
    v_mfma_f32_32x32x16_bf16 v[64:79], v[32:35], v[128:131], v[64:79]
    ds_read_b128 v[132:135], v152 offset:1024
    ds_read_b64_tr_b16 v[48:49], v144 offset:3584
    ds_read_b64_tr_b16 v[50:51], v144 offset:4480
    s_waitcnt lgkmcnt(7)
    v_mfma_f32_32x32x16_bf16 v[80:95], v[36:39], v[128:131], v[80:95]
    ds_read_b64_tr_b16 v[52:53], v144 offset:3616
    ds_read_b64_tr_b16 v[54:55], v144 offset:4512
    s_waitcnt lgkmcnt(7)
    v_mfma_f32_32x32x16_bf16 v[96:111], v[40:43], v[128:131], v[96:111]
    ds_read_b64_tr_b16 v[56:57], v144 offset:3648
    ds_read_b64_tr_b16 v[58:59], v144 offset:4544
    s_waitcnt vmcnt(0)
    s_barrier
    s_waitcnt lgkmcnt(7)
    v_mfma_f32_32x32x16_bf16 v[112:127], v[44:47], v[128:131], v[112:127]
    ds_read_b64_tr_b16 v[60:61], v144 offset:3680
    ds_read_b64_tr_b16 v[62:63], v144 offset:4576
    s_waitcnt lgkmcnt(6)
    v_mfma_f32_32x32x16_bf16 v[64:79], v[48:51], v[132:135], v[64:79]
    ds_read_b128 v[136:139], v153 offset:0
    ds_read_b64_tr_b16 v[16:17], v145 offset:0
    ds_read_b64_tr_b16 v[18:19], v145 offset:896
    s_waitcnt lgkmcnt(7)
    v_mfma_f32_32x32x16_bf16 v[80:95], v[52:55], v[132:135], v[80:95]
    ds_read_b64_tr_b16 v[20:21], v145 offset:32
    ds_read_b64_tr_b16 v[22:23], v145 offset:928
    s_waitcnt lgkmcnt(7)
    v_mfma_f32_32x32x16_bf16 v[96:111], v[56:59], v[132:135], v[96:111]
    ds_read_b64_tr_b16 v[24:25], v145 offset:64
    ds_read_b64_tr_b16 v[26:27], v145 offset:960
    s_waitcnt lgkmcnt(7)
    v_mfma_f32_32x32x16_bf16 v[112:127], v[60:63], v[132:135], v[112:127]
    ds_read_b64_tr_b16 v[28:29], v145 offset:96
    ds_read_b64_tr_b16 v[30:31], v145 offset:992
    s_waitcnt lgkmcnt(6)
    v_mfma_f32_32x32x16_bf16 v[64:79], v[16:19], v[136:139], v[64:79]
    ds_read_b128 v[140:143], v153 offset:1024
    ds_read_b64_tr_b16 v[32:33], v145 offset:3584
    ds_read_b64_tr_b16 v[34:35], v145 offset:4480
    s_waitcnt lgkmcnt(7)
    v_mfma_f32_32x32x16_bf16 v[80:95], v[20:23], v[136:139], v[80:95]
    ds_read_b64_tr_b16 v[36:37], v145 offset:3616
    ds_read_b64_tr_b16 v[38:39], v145 offset:4512
    s_waitcnt lgkmcnt(7)
    v_mfma_f32_32x32x16_bf16 v[96:111], v[24:27], v[136:139], v[96:111]
    ds_read_b64_tr_b16 v[40:41], v145 offset:3648
    ds_read_b64_tr_b16 v[42:43], v145 offset:4544
    s_waitcnt lgkmcnt(7)
    v_mfma_f32_32x32x16_bf16 v[112:127], v[28:31], v[136:139], v[112:127]
    ds_read_b64_tr_b16 v[44:45], v145 offset:3680
    ds_read_b64_tr_b16 v[46:47], v145 offset:4576
    s_waitcnt lgkmcnt(6)
    v_mfma_f32_32x32x16_bf16 v[64:79], v[32:35], v[140:143], v[64:79]
    s_waitcnt lgkmcnt(4)
    v_mfma_f32_32x32x16_bf16 v[80:95], v[36:39], v[140:143], v[80:95]
    s_waitcnt lgkmcnt(2)
    v_mfma_f32_32x32x16_bf16 v[96:111], v[40:43], v[140:143], v[96:111]
    s_waitcnt lgkmcnt(0)
    v_mfma_f32_32x32x16_bf16 v[112:127], v[44:47], v[140:143], v[112:127]
    s_nop 15
    v_max_f32 v64, 0, v64
    v_max_f32 v65, 0, v65
    v_max_f32 v66, 0, v66
    v_max_f32 v67, 0, v67
    v_max_f32 v68, 0, v68
    v_max_f32 v69, 0, v69
    v_max_f32 v70, 0, v70
    v_max_f32 v71, 0, v71
    v_mul_f32 v64, v64, v72
    v_mul_f32 v65, v65, v73
    v_mul_f32 v66, v66, v74
    v_mul_f32 v67, v67, v75
    v_mul_f32 v68, v68, v76
    v_mul_f32 v69, v69, v77
    v_mul_f32 v70, v70, v78
    v_mul_f32 v71, v71, v79
    v_cvt_pk_bf16_f32 v72, v64, v65
    v_cvt_pk_bf16_f32 v73, v66, v67
    v_cvt_pk_bf16_f32 v74, v68, v69
    v_cvt_pk_bf16_f32 v75, v70, v71
    global_store_dwordx4 v6, v[72:75], s[50:51] offset:0
    v_max_f32 v80, 0, v80
    v_max_f32 v81, 0, v81
    v_max_f32 v82, 0, v82
    v_max_f32 v83, 0, v83
    v_max_f32 v84, 0, v84
    v_max_f32 v85, 0, v85
    v_max_f32 v86, 0, v86
    v_max_f32 v87, 0, v87
    v_mul_f32 v80, v80, v88
    v_mul_f32 v81, v81, v89
    v_mul_f32 v82, v82, v90
    v_mul_f32 v83, v83, v91
    v_mul_f32 v84, v84, v92
    v_mul_f32 v85, v85, v93
    v_mul_f32 v86, v86, v94
    v_mul_f32 v87, v87, v95
    v_cvt_pk_bf16_f32 v88, v80, v81
    v_cvt_pk_bf16_f32 v89, v82, v83
    v_cvt_pk_bf16_f32 v90, v84, v85
    v_cvt_pk_bf16_f32 v91, v86, v87
    global_store_dwordx4 v6, v[88:91], s[50:51] offset:1024
    v_max_f32 v96, 0, v96
    v_max_f32 v97, 0, v97
    v_max_f32 v98, 0, v98
    v_max_f32 v99, 0, v99
    v_max_f32 v100, 0, v100
    v_max_f32 v101, 0, v101
    v_max_f32 v102, 0, v102
    v_max_f32 v103, 0, v103
    v_mul_f32 v96, v96, v104
    v_mul_f32 v97, v97, v105
    v_mul_f32 v98, v98, v106
    v_mul_f32 v99, v99, v107
    v_mul_f32 v100, v100, v108
    v_mul_f32 v101, v101, v109
    v_mul_f32 v102, v102, v110
    v_mul_f32 v103, v103, v111
    v_cvt_pk_bf16_f32 v104, v96, v97
    v_cvt_pk_bf16_f32 v105, v98, v99
    v_cvt_pk_bf16_f32 v106, v100, v101
    v_cvt_pk_bf16_f32 v107, v102, v103
    global_store_dwordx4 v6, v[104:107], s[50:51] offset:2048
    v_max_f32 v112, 0, v112
    v_max_f32 v113, 0, v113
    v_max_f32 v114, 0, v114
    v_max_f32 v115, 0, v115
    v_max_f32 v116, 0, v116
    v_max_f32 v117, 0, v117
    v_max_f32 v118, 0, v118
    v_max_f32 v119, 0, v119
    v_mul_f32 v112, v112, v120
    v_mul_f32 v113, v113, v121
    v_mul_f32 v114, v114, v122
    v_mul_f32 v115, v115, v123
    v_mul_f32 v116, v116, v124
    v_mul_f32 v117, v117, v125
    v_mul_f32 v118, v118, v126
    v_mul_f32 v119, v119, v127
    v_cvt_pk_bf16_f32 v120, v112, v113
    v_cvt_pk_bf16_f32 v121, v114, v115
    v_cvt_pk_bf16_f32 v122, v116, v117
    v_cvt_pk_bf16_f32 v123, v118, v119
    global_store_dwordx4 v6, v[120:123], s[50:51] offset:3072
    s_branch K5_DONE
K5_H1:
    ds_read_b128 v[128:131], v152 offset:0
    ds_read_b64_tr_b16 v[16:17], v144 offset:0
    ds_read_b64_tr_b16 v[18:19], v144 offset:896
    ds_read_b64_tr_b16 v[20:21], v144 offset:32
    ds_read_b64_tr_b16 v[22:23], v144 offset:928
    ds_read_b64_tr_b16 v[24:25], v144 offset:64
    ds_read_b64_tr_b16 v[26:27], v144 offset:960
    ds_read_b128 v[132:135], v152 offset:1024
    ds_read_b64_tr_b16 v[28:29], v144 offset:3584
    ds_read_b64_tr_b16 v[30:31], v144 offset:4480
    s_add_u32 m0, s52, 22784
    s_mul_i32 s46, s56, 1
    buffer_load_dwordx4 v13, s[68:71], s46 offen lds
    s_add_u32 m0, s53, 22784
    s_mul_i32 s46, s57, 1
    buffer_load_dwordx4 v14, s[72:75], s46 offen lds
    s_cmp_lt_u32 s3, 6
    s_cbranch_scc0 K5_SKb1
    s_add_u32 m0, s54, 22784
    s_mul_i32 s46, s58, 1
    buffer_load_dwordx4 v15, s[76:79], s46 offen lds
K5_SKb1:
    s_add_u32 m0, s52, 45568
    s_mul_i32 s46, s56, 2
    buffer_load_dwordx4 v13, s[68:71], s46 offen lds
    s_add_u32 m0, s53, 45568
    s_mul_i32 s46, s57, 2
    buffer_load_dwordx4 v14, s[72:75], s46 offen lds
    s_cmp_lt_u32 s3, 6
    s_cbranch_scc0 K5_SKb2
    s_add_u32 m0, s54, 45568
    s_mul_i32 s46, s58, 2
    buffer_load_dwordx4 v15, s[76:79], s46 offen lds
K5_SKb2:
    s_add_u32 m0, s52, 68352
    s_mul_i32 s46, s56, 3
    buffer_load_dwordx4 v13, s[68:71], s46 offen lds
    s_add_u32 m0, s53, 68352
    s_mul_i32 s46, s57, 3
    buffer_load_dwordx4 v14, s[72:75], s46 offen lds
    s_cmp_lt_u32 s3, 6
    s_cbranch_scc0 K5_SKb3
    s_add_u32 m0, s54, 68352
    s_mul_i32 s46, s58, 3
    buffer_load_dwordx4 v15, s[76:79], s46 offen lds
K5_SKb3:
    s_add_u32 m0, s52, 91136
    s_mul_i32 s46, s56, 4
    buffer_load_dwordx4 v13, s[68:71], s46 offen lds
    s_add_u32 m0, s53, 91136
    s_mul_i32 s46, s57, 4
    buffer_load_dwordx4 v14, s[72:75], s46 offen lds
    s_cmp_lt_u32 s3, 6
    s_cbranch_scc0 K5_SKb4
    s_add_u32 m0, s54, 91136
    s_mul_i32 s46, s58, 4
    buffer_load_dwordx4 v15, s[76:79], s46 offen lds
K5_SKb4:
    s_waitcnt lgkmcnt(7)
    v_mfma_f32_32x32x16_bf16 v[64:79], v[16:19], v[128:131], v[64:79]
    ds_read_b64_tr_b16 v[32:33], v144 offset:3616
    ds_read_b64_tr_b16 v[34:35], v144 offset:4512
    s_waitcnt vmcnt(6)
    s_barrier
    s_add_u32 m0, s52, 113920
    s_mul_i32 s46, s56, 5
    buffer_load_dwordx4 v13, s[68:71], s46 offen lds
    s_add_u32 m0, s53, 113920
    s_mul_i32 s46, s57, 5
    buffer_load_dwordx4 v14, s[72:75], s46 offen lds
    s_cmp_lt_u32 s3, 6
    s_cbranch_scc0 K5_SKb5
    s_add_u32 m0, s54, 113920
    s_mul_i32 s46, s58, 5
    buffer_load_dwordx4 v15, s[76:79], s46 offen lds
K5_SKb5:
    s_waitcnt lgkmcnt(7)
    v_mfma_f32_32x32x16_bf16 v[80:95], v[20:23], v[128:131], v[80:95]
    ds_read_b64_tr_b16 v[36:37], v144 offset:3648
    ds_read_b64_tr_b16 v[38:39], v144 offset:4544
    s_waitcnt lgkmcnt(7)
    v_mfma_f32_32x32x16_bf16 v[96:111], v[24:27], v[128:131], v[96:111]
    ds_read_b128 v[136:139], v153 offset:0
    ds_read_b64_tr_b16 v[40:41], v145 offset:0
    ds_read_b64_tr_b16 v[42:43], v145 offset:896
    s_waitcnt lgkmcnt(7)
    v_mfma_f32_32x32x16_bf16 v[64:79], v[28:31], v[132:135], v[64:79]
    ds_read_b64_tr_b16 v[44:45], v145 offset:32
    ds_read_b64_tr_b16 v[46:47], v145 offset:928
    s_waitcnt lgkmcnt(7)
    v_mfma_f32_32x32x16_bf16 v[80:95], v[32:35], v[132:135], v[80:95]
    ds_read_b64_tr_b16 v[48:49], v145 offset:64
    ds_read_b64_tr_b16 v[50:51], v145 offset:960
    s_waitcnt lgkmcnt(7)
    v_mfma_f32_32x32x16_bf16 v[96:111], v[36:39], v[132:135], v[96:111]
    ds_read_b128 v[140:143], v153 offset:1024
    ds_read_b64_tr_b16 v[52:53], v145 offset:3584
    ds_read_b64_tr_b16 v[54:55], v145 offset:4480
    s_waitcnt lgkmcnt(7)
    v_mfma_f32_32x32x16_bf16 v[64:79], v[40:43], v[136:139], v[64:79]
    ds_read_b64_tr_b16 v[56:57], v145 offset:3616
    ds_read_b64_tr_b16 v[58:59], v145 offset:4512
    s_waitcnt vmcnt(6)
    s_barrier
    s_add_u32 m0, s52, 136704
    s_mul_i32 s46, s56, 6
    buffer_load_dwordx4 v13, s[68:71], s46 offen lds
    s_add_u32 m0, s53, 136704
    s_mul_i32 s46, s57, 6
    buffer_load_dwordx4 v14, s[72:75], s46 offen lds
    s_cmp_lt_u32 s3, 6
    s_cbranch_scc0 K5_SKb6
    s_add_u32 m0, s54, 136704
    s_mul_i32 s46, s58, 6
    buffer_load_dwordx4 v15, s[76:79], s46 offen lds
K5_SKb6:
    s_waitcnt lgkmcnt(7)
    v_mfma_f32_32x32x16_bf16 v[80:95], v[44:47], v[136:139], v[80:95]
    ds_read_b64_tr_b16 v[60:61], v145 offset:3648
    ds_read_b64_tr_b16 v[62:63], v145 offset:4544
    s_waitcnt lgkmcnt(7)
    v_mfma_f32_32x32x16_bf16 v[96:111], v[48:51], v[136:139], v[96:111]
    ds_read_b128 v[128:131], v154 offset:0
    ds_read_b64_tr_b16 v[16:17], v146 offset:0
    ds_read_b64_tr_b16 v[18:19], v146 offset:896
    s_waitcnt lgkmcnt(7)
    v_mfma_f32_32x32x16_bf16 v[64:79], v[52:55], v[140:143], v[64:79]
    ds_read_b64_tr_b16 v[20:21], v146 offset:32
    ds_read_b64_tr_b16 v[22:23], v146 offset:928
    s_waitcnt lgkmcnt(7)
    v_mfma_f32_32x32x16_bf16 v[80:95], v[56:59], v[140:143], v[80:95]
    ds_read_b64_tr_b16 v[24:25], v146 offset:64
    ds_read_b64_tr_b16 v[26:27], v146 offset:960
    s_waitcnt lgkmcnt(7)
    v_mfma_f32_32x32x16_bf16 v[96:111], v[60:63], v[140:143], v[96:111]
    ds_read_b128 v[132:135], v154 offset:1024
    ds_read_b64_tr_b16 v[28:29], v146 offset:3584
    ds_read_b64_tr_b16 v[30:31], v146 offset:4480
    s_waitcnt lgkmcnt(7)
    v_mfma_f32_32x32x16_bf16 v[64:79], v[16:19], v[128:131], v[64:79]
    ds_read_b64_tr_b16 v[32:33], v146 offset:3616
    ds_read_b64_tr_b16 v[34:35], v146 offset:4512
    s_waitcnt vmcnt(6)
    s_barrier
    s_add_u32 m0, s52, 0
    s_mul_i32 s46, s56, 7
    buffer_load_dwordx4 v13, s[68:71], s46 offen lds
    s_add_u32 m0, s53, 0
    s_mul_i32 s46, s57, 7
    buffer_load_dwordx4 v14, s[72:75], s46 offen lds
    s_cmp_lt_u32 s3, 6
    s_cbranch_scc0 K5_SKb7
    s_add_u32 m0, s54, 0
    s_mul_i32 s46, s58, 7
    buffer_load_dwordx4 v15, s[76:79], s46 offen lds
K5_SKb7:
    s_waitcnt lgkmcnt(7)
    v_mfma_f32_32x32x16_bf16 v[80:95], v[20:23], v[128:131], v[80:95]
    ds_read_b64_tr_b16 v[36:37], v146 offset:3648
    ds_read_b64_tr_b16 v[38:39], v146 offset:4544
    s_waitcnt lgkmcnt(7)
    v_mfma_f32_32x32x16_bf16 v[96:111], v[24:27], v[128:131], v[96:111]
    ds_read_b128 v[136:139], v155 offset:0
    ds_read_b64_tr_b16 v[40:41], v147 offset:0
    ds_read_b64_tr_b16 v[42:43], v147 offset:896
    s_waitcnt lgkmcnt(7)
    v_mfma_f32_32x32x16_bf16 v[64:79], v[28:31], v[132:135], v[64:79]
    ds_read_b64_tr_b16 v[44:45], v147 offset:32
    ds_read_b64_tr_b16 v[46:47], v147 offset:928
    s_waitcnt lgkmcnt(7)
    v_mfma_f32_32x32x16_bf16 v[80:95], v[32:35], v[132:135], v[80:95]
    ds_read_b64_tr_b16 v[48:49], v147 offset:64
    ds_read_b64_tr_b16 v[50:51], v147 offset:960
    s_waitcnt lgkmcnt(7)
    v_mfma_f32_32x32x16_bf16 v[96:111], v[36:39], v[132:135], v[96:111]
    ds_read_b128 v[140:143], v155 offset:1024
    ds_read_b64_tr_b16 v[52:53], v147 offset:3584
    ds_read_b64_tr_b16 v[54:55], v147 offset:4480
    s_waitcnt lgkmcnt(7)
    v_mfma_f32_32x32x16_bf16 v[64:79], v[40:43], v[136:139], v[64:79]
    ds_read_b64_tr_b16 v[56:57], v147 offset:3616
    ds_read_b64_tr_b16 v[58:59], v147 offset:4512
    s_waitcnt vmcnt(6)
    s_barrier
    s_add_u32 m0, s52, 22784
    s_mul_i32 s46, s56, 8
    buffer_load_dwordx4 v13, s[68:71], s46 offen lds
    s_add_u32 m0, s53, 22784
    s_mul_i32 s46, s57, 8
    buffer_load_dwordx4 v14, s[72:75], s46 offen lds
    s_cmp_lt_u32 s3, 6
    s_cbranch_scc0 K5_SKb8
    s_add_u32 m0, s54, 22784
    s_mul_i32 s46, s58, 8
    buffer_load_dwordx4 v15, s[76:79], s46 offen lds
K5_SKb8:
    s_waitcnt lgkmcnt(7)
    v_mfma_f32_32x32x16_bf16 v[80:95], v[44:47], v[136:139], v[80:95]
    ds_read_b64_tr_b16 v[60:61], v147 offset:3648
    ds_read_b64_tr_b16 v[62:63], v147 offset:4544
    s_waitcnt lgkmcnt(7)
    v_mfma_f32_32x32x16_bf16 v[96:111], v[48:51], v[136:139], v[96:111]
    ds_read_b128 v[128:131], v156 offset:0
    ds_read_b64_tr_b16 v[16:17], v148 offset:0
    ds_read_b64_tr_b16 v[18:19], v148 offset:896
    s_waitcnt lgkmcnt(7)
    v_mfma_f32_32x32x16_bf16 v[64:79], v[52:55], v[140:143], v[64:79]
    ds_read_b64_tr_b16 v[20:21], v148 offset:32
    ds_read_b64_tr_b16 v[22:23], v148 offset:928
    s_waitcnt lgkmcnt(7)
    v_mfma_f32_32x32x16_bf16 v[80:95], v[56:59], v[140:143], v[80:95]
    ds_read_b64_tr_b16 v[24:25], v148 offset:64
    ds_read_b64_tr_b16 v[26:27], v148 offset:960
    s_waitcnt lgkmcnt(7)
    v_mfma_f32_32x32x16_bf16 v[96:111], v[60:63], v[140:143], v[96:111]
    ds_read_b128 v[132:135], v156 offset:1024
    ds_read_b64_tr_b16 v[28:29], v148 offset:3584
    ds_read_b64_tr_b16 v[30:31], v148 offset:4480
    s_waitcnt lgkmcnt(7)
    v_mfma_f32_32x32x16_bf16 v[64:79], v[16:19], v[128:131], v[64:79]
    ds_read_b64_tr_b16 v[32:33], v148 offset:3616
    ds_read_b64_tr_b16 v[34:35], v148 offset:4512
    s_waitcnt vmcnt(6)
    s_barrier
    s_add_u32 m0, s52, 45568
    s_mul_i32 s46, s56, 9
    buffer_load_dwordx4 v13, s[68:71], s46 offen lds
    s_add_u32 m0, s53, 45568
    s_mul_i32 s46, s57, 9
    buffer_load_dwordx4 v14, s[72:75], s46 offen lds
    s_cmp_lt_u32 s3, 6
    s_cbranch_scc0 K5_SKb9
    s_add_u32 m0, s54, 45568
    s_mul_i32 s46, s58, 9
    buffer_load_dwordx4 v15, s[76:79], s46 offen lds
K5_SKb9:
    s_waitcnt lgkmcnt(7)
    v_mfma_f32_32x32x16_bf16 v[80:95], v[20:23], v[128:131], v[80:95]
    ds_read_b64_tr_b16 v[36:37], v148 offset:3648
    ds_read_b64_tr_b16 v[38:39], v148 offset:4544
    s_waitcnt lgkmcnt(7)
    v_mfma_f32_32x32x16_bf16 v[96:111], v[24:27], v[128:131], v[96:111]
    ds_read_b128 v[136:139], v157 offset:0
    ds_read_b64_tr_b16 v[40:41], v149 offset:0
    ds_read_b64_tr_b16 v[42:43], v149 offset:896
    s_waitcnt lgkmcnt(7)
    v_mfma_f32_32x32x16_bf16 v[64:79], v[28:31], v[132:135], v[64:79]
    ds_read_b64_tr_b16 v[44:45], v149 offset:32
    ds_read_b64_tr_b16 v[46:47], v149 offset:928
    s_waitcnt lgkmcnt(7)
    v_mfma_f32_32x32x16_bf16 v[80:95], v[32:35], v[132:135], v[80:95]
    ds_read_b64_tr_b16 v[48:49], v149 offset:64
    ds_read_b64_tr_b16 v[50:51], v149 offset:960
    s_waitcnt lgkmcnt(7)
    v_mfma_f32_32x32x16_bf16 v[96:111], v[36:39], v[132:135], v[96:111]
    ds_read_b128 v[140:143], v157 offset:1024
    ds_read_b64_tr_b16 v[52:53], v149 offset:3584
    ds_read_b64_tr_b16 v[54:55], v149 offset:4480
    s_waitcnt lgkmcnt(7)
    v_mfma_f32_32x32x16_bf16 v[64:79], v[40:43], v[136:139], v[64:79]
    ds_read_b64_tr_b16 v[56:57], v149 offset:3616
    ds_read_b64_tr_b16 v[58:59], v149 offset:4512
    s_waitcnt vmcnt(6)
    s_barrier
    s_add_u32 m0, s52, 68352
    s_mul_i32 s46, s56, 10
    buffer_load_dwordx4 v13, s[68:71], s46 offen lds
    s_add_u32 m0, s53, 68352
    s_mul_i32 s46, s57, 10
    buffer_load_dwordx4 v14, s[72:75], s46 offen lds
    s_cmp_lt_u32 s3, 6
    s_cbranch_scc0 K5_SKb10
    s_add_u32 m0, s54, 68352
    s_mul_i32 s46, s58, 10
    buffer_load_dwordx4 v15, s[76:79], s46 offen lds
K5_SKb10:
    s_waitcnt lgkmcnt(7)
    v_mfma_f32_32x32x16_bf16 v[80:95], v[44:47], v[136:139], v[80:95]
    ds_read_b64_tr_b16 v[60:61], v149 offset:3648
    ds_read_b64_tr_b16 v[62:63], v149 offset:4544
    s_waitcnt lgkmcnt(7)
    v_mfma_f32_32x32x16_bf16 v[96:111], v[48:51], v[136:139], v[96:111]
    ds_read_b128 v[128:131], v158 offset:0
    ds_read_b64_tr_b16 v[16:17], v150 offset:0
    ds_read_b64_tr_b16 v[18:19], v150 offset:896
    s_waitcnt lgkmcnt(7)
    v_mfma_f32_32x32x16_bf16 v[64:79], v[52:55], v[140:143], v[64:79]
    ds_read_b64_tr_b16 v[20:21], v150 offset:32
    ds_read_b64_tr_b16 v[22:23], v150 offset:928
    s_waitcnt lgkmcnt(7)
    v_mfma_f32_32x32x16_bf16 v[80:95], v[56:59], v[140:143], v[80:95]
    ds_read_b64_tr_b16 v[24:25], v150 offset:64
    ds_read_b64_tr_b16 v[26:27], v150 offset:960
    s_waitcnt lgkmcnt(7)
    v_mfma_f32_32x32x16_bf16 v[96:111], v[60:63], v[140:143], v[96:111]
    ds_read_b128 v[132:135], v158 offset:1024
    ds_read_b64_tr_b16 v[28:29], v150 offset:3584
    ds_read_b64_tr_b16 v[30:31], v150 offset:4480
    s_waitcnt lgkmcnt(7)
    v_mfma_f32_32x32x16_bf16 v[64:79], v[16:19], v[128:131], v[64:79]
    ds_read_b64_tr_b16 v[32:33], v150 offset:3616
    ds_read_b64_tr_b16 v[34:35], v150 offset:4512
    s_waitcnt vmcnt(6)
    s_barrier
    s_add_u32 m0, s52, 91136
    s_mul_i32 s46, s56, 11
    buffer_load_dwordx4 v13, s[68:71], s46 offen lds
    s_add_u32 m0, s53, 91136
    s_mul_i32 s46, s57, 11
    buffer_load_dwordx4 v14, s[72:75], s46 offen lds
    s_cmp_lt_u32 s3, 6
    s_cbranch_scc0 K5_SKb11
    s_add_u32 m0, s54, 91136
    s_mul_i32 s46, s58, 11
    buffer_load_dwordx4 v15, s[76:79], s46 offen lds
K5_SKb11:
    s_waitcnt lgkmcnt(7)
    v_mfma_f32_32x32x16_bf16 v[80:95], v[20:23], v[128:131], v[80:95]
    ds_read_b64_tr_b16 v[36:37], v150 offset:3648
    ds_read_b64_tr_b16 v[38:39], v150 offset:4544
    s_waitcnt lgkmcnt(7)
    v_mfma_f32_32x32x16_bf16 v[96:111], v[24:27], v[128:131], v[96:111]
    ds_read_b128 v[136:139], v152 offset:0
    ds_read_b64_tr_b16 v[40:41], v144 offset:0
    ds_read_b64_tr_b16 v[42:43], v144 offset:896
    s_waitcnt lgkmcnt(7)
    v_mfma_f32_32x32x16_bf16 v[64:79], v[28:31], v[132:135], v[64:79]
    ds_read_b64_tr_b16 v[44:45], v144 offset:32
    ds_read_b64_tr_b16 v[46:47], v144 offset:928
    s_waitcnt lgkmcnt(7)
    v_mfma_f32_32x32x16_bf16 v[80:95], v[32:35], v[132:135], v[80:95]
    ds_read_b64_tr_b16 v[48:49], v144 offset:64
    ds_read_b64_tr_b16 v[50:51], v144 offset:960
    s_waitcnt lgkmcnt(7)
    v_mfma_f32_32x32x16_bf16 v[96:111], v[36:39], v[132:135], v[96:111]
    ds_read_b128 v[140:143], v152 offset:1024
    ds_read_b64_tr_b16 v[52:53], v144 offset:3584
    ds_read_b64_tr_b16 v[54:55], v144 offset:4480
    s_waitcnt lgkmcnt(7)
    v_mfma_f32_32x32x16_bf16 v[64:79], v[40:43], v[136:139], v[64:79]
    ds_read_b64_tr_b16 v[56:57], v144 offset:3616
    ds_read_b64_tr_b16 v[58:59], v144 offset:4512
    s_waitcnt vmcnt(6)
    s_barrier
    s_add_u32 m0, s52, 113920
    s_mul_i32 s46, s56, 12
    buffer_load_dwordx4 v13, s[68:71], s46 offen lds
    s_add_u32 m0, s53, 113920
    s_mul_i32 s46, s57, 12
    buffer_load_dwordx4 v14, s[72:75], s46 offen lds
    s_cmp_lt_u32 s3, 6
    s_cbranch_scc0 K5_SKb12
    s_add_u32 m0, s54, 113920
    s_mul_i32 s46, s58, 12
    buffer_load_dwordx4 v15, s[76:79], s46 offen lds
K5_SKb12:
    s_waitcnt lgkmcnt(7)
    v_mfma_f32_32x32x16_bf16 v[80:95], v[44:47], v[136:139], v[80:95]
    ds_read_b64_tr_b16 v[60:61], v144 offset:3648
    ds_read_b64_tr_b16 v[62:63], v144 offset:4544
    s_waitcnt lgkmcnt(7)
    v_mfma_f32_32x32x16_bf16 v[96:111], v[48:51], v[136:139], v[96:111]
    ds_read_b128 v[128:131], v153 offset:0
    ds_read_b64_tr_b16 v[16:17], v145 offset:0
    ds_read_b64_tr_b16 v[18:19], v145 offset:896
    s_waitcnt lgkmcnt(7)
    v_mfma_f32_32x32x16_bf16 v[64:79], v[52:55], v[140:143], v[64:79]
    ds_read_b64_tr_b16 v[20:21], v145 offset:32
    ds_read_b64_tr_b16 v[22:23], v145 offset:928
    s_waitcnt lgkmcnt(7)
    v_mfma_f32_32x32x16_bf16 v[80:95], v[56:59], v[140:143], v[80:95]
    ds_read_b64_tr_b16 v[24:25], v145 offset:64
    ds_read_b64_tr_b16 v[26:27], v145 offset:960
    s_waitcnt lgkmcnt(7)
    v_mfma_f32_32x32x16_bf16 v[96:111], v[60:63], v[140:143], v[96:111]
    ds_read_b128 v[132:135], v153 offset:1024
    ds_read_b64_tr_b16 v[28:29], v145 offset:3584
    ds_read_b64_tr_b16 v[30:31], v145 offset:4480
    s_waitcnt lgkmcnt(7)
    v_mfma_f32_32x32x16_bf16 v[64:79], v[16:19], v[128:131], v[64:79]
    ds_read_b64_tr_b16 v[32:33], v145 offset:3616
    ds_read_b64_tr_b16 v[34:35], v145 offset:4512
    s_waitcnt vmcnt(6)
    s_barrier
    s_add_u32 m0, s52, 136704
    s_mul_i32 s46, s56, 13
    buffer_load_dwordx4 v13, s[68:71], s46 offen lds
    s_add_u32 m0, s53, 136704
    s_mul_i32 s46, s57, 13
    buffer_load_dwordx4 v14, s[72:75], s46 offen lds
    s_cmp_lt_u32 s3, 6
    s_cbranch_scc0 K5_SKb13
    s_add_u32 m0, s54, 136704
    s_mul_i32 s46, s58, 13
    buffer_load_dwordx4 v15, s[76:79], s46 offen lds
K5_SKb13:
    s_waitcnt lgkmcnt(7)
    v_mfma_f32_32x32x16_bf16 v[80:95], v[20:23], v[128:131], v[80:95]
    ds_read_b64_tr_b16 v[36:37], v145 offset:3648
    ds_read_b64_tr_b16 v[38:39], v145 offset:4544
    s_waitcnt lgkmcnt(7)
    v_mfma_f32_32x32x16_bf16 v[96:111], v[24:27], v[128:131], v[96:111]
    ds_read_b128 v[136:139], v154 offset:0
    ds_read_b64_tr_b16 v[40:41], v146 offset:0
    ds_read_b64_tr_b16 v[42:43], v146 offset:896
    s_waitcnt lgkmcnt(7)
    v_mfma_f32_32x32x16_bf16 v[64:79], v[28:31], v[132:135], v[64:79]
    ds_read_b64_tr_b16 v[44:45], v146 offset:32
    ds_read_b64_tr_b16 v[46:47], v146 offset:928
    s_waitcnt lgkmcnt(7)
    v_mfma_f32_32x32x16_bf16 v[80:95], v[32:35], v[132:135], v[80:95]
    ds_read_b64_tr_b16 v[48:49], v146 offset:64
    ds_read_b64_tr_b16 v[50:51], v146 offset:960
    s_waitcnt lgkmcnt(7)
    v_mfma_f32_32x32x16_bf16 v[96:111], v[36:39], v[132:135], v[96:111]
    ds_read_b128 v[140:143], v154 offset:1024
    ds_read_b64_tr_b16 v[52:53], v146 offset:3584
    ds_read_b64_tr_b16 v[54:55], v146 offset:4480
    s_waitcnt lgkmcnt(7)
    v_mfma_f32_32x32x16_bf16 v[64:79], v[40:43], v[136:139], v[64:79]
    ds_read_b64_tr_b16 v[56:57], v146 offset:3616
    ds_read_b64_tr_b16 v[58:59], v146 offset:4512
    s_waitcnt vmcnt(6)
    s_barrier
    s_add_u32 m0, s52, 0
    s_mul_i32 s46, s56, 14
    buffer_load_dwordx4 v13, s[68:71], s46 offen lds
    s_add_u32 m0, s53, 0
    s_mul_i32 s46, s57, 14
    buffer_load_dwordx4 v14, s[72:75], s46 offen lds
    s_cmp_lt_u32 s3, 6
    s_cbranch_scc0 K5_SKb14
    s_add_u32 m0, s54, 0
    s_mul_i32 s46, s58, 14
    buffer_load_dwordx4 v15, s[76:79], s46 offen lds
K5_SKb14:
    s_waitcnt lgkmcnt(7)
    v_mfma_f32_32x32x16_bf16 v[80:95], v[44:47], v[136:139], v[80:95]
    ds_read_b64_tr_b16 v[60:61], v146 offset:3648
    ds_read_b64_tr_b16 v[62:63], v146 offset:4544
    s_waitcnt lgkmcnt(7)
    v_mfma_f32_32x32x16_bf16 v[96:111], v[48:51], v[136:139], v[96:111]
    ds_read_b128 v[128:131], v155 offset:0
    ds_read_b64_tr_b16 v[16:17], v147 offset:0
    ds_read_b64_tr_b16 v[18:19], v147 offset:896
    s_waitcnt lgkmcnt(7)
    v_mfma_f32_32x32x16_bf16 v[64:79], v[52:55], v[140:143], v[64:79]
    ds_read_b64_tr_b16 v[20:21], v147 offset:32
    ds_read_b64_tr_b16 v[22:23], v147 offset:928
    s_waitcnt lgkmcnt(7)
    v_mfma_f32_32x32x16_bf16 v[80:95], v[56:59], v[140:143], v[80:95]
    ds_read_b64_tr_b16 v[24:25], v147 offset:64
    ds_read_b64_tr_b16 v[26:27], v147 offset:960
    s_waitcnt lgkmcnt(7)
    v_mfma_f32_32x32x16_bf16 v[96:111], v[60:63], v[140:143], v[96:111]
    ds_read_b128 v[132:135], v155 offset:1024
    ds_read_b64_tr_b16 v[28:29], v147 offset:3584
    ds_read_b64_tr_b16 v[30:31], v147 offset:4480
    s_waitcnt lgkmcnt(7)
    v_mfma_f32_32x32x16_bf16 v[64:79], v[16:19], v[128:131], v[64:79]
    ds_read_b64_tr_b16 v[32:33], v147 offset:3616
    ds_read_b64_tr_b16 v[34:35], v147 offset:4512
    s_waitcnt vmcnt(6)
    s_barrier
    s_add_u32 m0, s52, 22784
    s_mul_i32 s46, s56, 15
    buffer_load_dwordx4 v13, s[68:71], s46 offen lds
    s_add_u32 m0, s53, 22784
    s_mul_i32 s46, s57, 15
    buffer_load_dwordx4 v14, s[72:75], s46 offen lds
    s_cmp_lt_u32 s3, 6
    s_cbranch_scc0 K5_SKb15
    s_add_u32 m0, s54, 22784
    s_mul_i32 s46, s58, 15
    buffer_load_dwordx4 v15, s[76:79], s46 offen lds
K5_SKb15:
    s_waitcnt lgkmcnt(7)
    v_mfma_f32_32x32x16_bf16 v[80:95], v[20:23], v[128:131], v[80:95]
    ds_read_b64_tr_b16 v[36:37], v147 offset:3648
    ds_read_b64_tr_b16 v[38:39], v147 offset:4544
    s_waitcnt lgkmcnt(7)
    v_mfma_f32_32x32x16_bf16 v[96:111], v[24:27], v[128:131], v[96:111]
    ds_read_b128 v[136:139], v156 offset:0
    ds_read_b64_tr_b16 v[40:41], v148 offset:0
    ds_read_b64_tr_b16 v[42:43], v148 offset:896
    s_waitcnt lgkmcnt(7)
    v_mfma_f32_32x32x16_bf16 v[64:79], v[28:31], v[132:135], v[64:79]
    ds_read_b64_tr_b16 v[44:45], v148 offset:32
    ds_read_b64_tr_b16 v[46:47], v148 offset:928
    s_waitcnt lgkmcnt(7)
    v_mfma_f32_32x32x16_bf16 v[80:95], v[32:35], v[132:135], v[80:95]
    ds_read_b64_tr_b16 v[48:49], v148 offset:64
    ds_read_b64_tr_b16 v[50:51], v148 offset:960
    s_waitcnt lgkmcnt(7)
    v_mfma_f32_32x32x16_bf16 v[96:111], v[36:39], v[132:135], v[96:111]
    ds_read_b128 v[140:143], v156 offset:1024
    ds_read_b64_tr_b16 v[52:53], v148 offset:3584
    ds_read_b64_tr_b16 v[54:55], v148 offset:4480
    s_waitcnt lgkmcnt(7)
    v_mfma_f32_32x32x16_bf16 v[64:79], v[40:43], v[136:139], v[64:79]
    ds_read_b64_tr_b16 v[56:57], v148 offset:3616
    ds_read_b64_tr_b16 v[58:59], v148 offset:4512
    s_waitcnt vmcnt(6)
    s_barrier
    s_waitcnt lgkmcnt(7)
    v_mfma_f32_32x32x16_bf16 v[80:95], v[44:47], v[136:139], v[80:95]
    ds_read_b64_tr_b16 v[60:61], v148 offset:3648
    ds_read_b64_tr_b16 v[62:63], v148 offset:4544
    s_waitcnt lgkmcnt(7)
    v_mfma_f32_32x32x16_bf16 v[96:111], v[48:51], v[136:139], v[96:111]
    ds_read_b128 v[128:131], v157 offset:0
    ds_read_b64_tr_b16 v[16:17], v149 offset:0
    ds_read_b64_tr_b16 v[18:19], v149 offset:896
    s_waitcnt lgkmcnt(7)
    v_mfma_f32_32x32x16_bf16 v[64:79], v[52:55], v[140:143], v[64:79]
    ds_read_b64_tr_b16 v[20:21], v149 offset:32
    ds_read_b64_tr_b16 v[22:23], v149 offset:928
    s_waitcnt lgkmcnt(7)
    v_mfma_f32_32x32x16_bf16 v[80:95], v[56:59], v[140:143], v[80:95]
    ds_read_b64_tr_b16 v[24:25], v149 offset:64
    ds_read_b64_tr_b16 v[26:27], v149 offset:960
    s_waitcnt lgkmcnt(7)
    v_mfma_f32_32x32x16_bf16 v[96:111], v[60:63], v[140:143], v[96:111]
    ds_read_b128 v[132:135], v157 offset:1024
    ds_read_b64_tr_b16 v[28:29], v149 offset:3584
    ds_read_b64_tr_b16 v[30:31], v149 offset:4480
    s_waitcnt lgkmcnt(7)
    v_mfma_f32_32x32x16_bf16 v[64:79], v[16:19], v[128:131], v[64:79]
    ds_read_b64_tr_b16 v[32:33], v149 offset:3616
    ds_read_b64_tr_b16 v[34:35], v149 offset:4512
    s_waitcnt vmcnt(4)
    s_barrier
    s_waitcnt lgkmcnt(7)
    v_mfma_f32_32x32x16_bf16 v[80:95], v[20:23], v[128:131], v[80:95]
    ds_read_b64_tr_b16 v[36:37], v149 offset:3648
    ds_read_b64_tr_b16 v[38:39], v149 offset:4544
    s_waitcnt lgkmcnt(7)
    v_mfma_f32_32x32x16_bf16 v[96:111], v[24:27], v[128:131], v[96:111]
    ds_read_b128 v[136:139], v158 offset:0
    ds_read_b64_tr_b16 v[40:41], v150 offset:0
    ds_read_b64_tr_b16 v[42:43], v150 offset:896
    s_waitcnt lgkmcnt(7)
    v_mfma_f32_32x32x16_bf16 v[64:79], v[28:31], v[132:135], v[64:79]
    ds_read_b64_tr_b16 v[44:45], v150 offset:32
    ds_read_b64_tr_b16 v[46:47], v150 offset:928
    s_waitcnt lgkmcnt(7)
    v_mfma_f32_32x32x16_bf16 v[80:95], v[32:35], v[132:135], v[80:95]
    ds_read_b64_tr_b16 v[48:49], v150 offset:64
    ds_read_b64_tr_b16 v[50:51], v150 offset:960
    s_waitcnt lgkmcnt(7)
    v_mfma_f32_32x32x16_bf16 v[96:111], v[36:39], v[132:135], v[96:111]
    ds_read_b128 v[140:143], v158 offset:1024
    ds_read_b64_tr_b16 v[52:53], v150 offset:3584
    ds_read_b64_tr_b16 v[54:55], v150 offset:4480
    s_waitcnt lgkmcnt(7)
    v_mfma_f32_32x32x16_bf16 v[64:79], v[40:43], v[136:139], v[64:79]
    ds_read_b64_tr_b16 v[56:57], v150 offset:3616
    ds_read_b64_tr_b16 v[58:59], v150 offset:4512
    s_waitcnt vmcnt(2)
    s_barrier
    s_waitcnt lgkmcnt(7)
    v_mfma_f32_32x32x16_bf16 v[80:95], v[44:47], v[136:139], v[80:95]
    ds_read_b64_tr_b16 v[60:61], v150 offset:3648
    ds_read_b64_tr_b16 v[62:63], v150 offset:4544
    s_waitcnt lgkmcnt(7)
    v_mfma_f32_32x32x16_bf16 v[96:111], v[48:51], v[136:139], v[96:111]
    ds_read_b128 v[128:131], v152 offset:0
    ds_read_b64_tr_b16 v[16:17], v144 offset:0
    ds_read_b64_tr_b16 v[18:19], v144 offset:896
    s_waitcnt lgkmcnt(7)
    v_mfma_f32_32x32x16_bf16 v[64:79], v[52:55], v[140:143], v[64:79]
    ds_read_b64_tr_b16 v[20:21], v144 offset:32
    ds_read_b64_tr_b16 v[22:23], v144 offset:928
    s_waitcnt lgkmcnt(7)
    v_mfma_f32_32x32x16_bf16 v[80:95], v[56:59], v[140:143], v[80:95]
    ds_read_b64_tr_b16 v[24:25], v144 offset:64
    ds_read_b64_tr_b16 v[26:27], v144 offset:960
    s_waitcnt lgkmcnt(7)
    v_mfma_f32_32x32x16_bf16 v[96:111], v[60:63], v[140:143], v[96:111]
    ds_read_b128 v[132:135], v152 offset:1024
    ds_read_b64_tr_b16 v[28:29], v144 offset:3584
    ds_read_b64_tr_b16 v[30:31], v144 offset:4480
    s_waitcnt lgkmcnt(7)
    v_mfma_f32_32x32x16_bf16 v[64:79], v[16:19], v[128:131], v[64:79]
    ds_read_b64_tr_b16 v[32:33], v144 offset:3616
    ds_read_b64_tr_b16 v[34:35], v144 offset:4512
    s_waitcnt vmcnt(0)
    s_barrier
    s_waitcnt lgkmcnt(7)
    v_mfma_f32_32x32x16_bf16 v[80:95], v[20:23], v[128:131], v[80:95]
    ds_read_b64_tr_b16 v[36:37], v144 offset:3648
    ds_read_b64_tr_b16 v[38:39], v144 offset:4544
    s_waitcnt lgkmcnt(7)
    v_mfma_f32_32x32x16_bf16 v[96:111], v[24:27], v[128:131], v[96:111]
    ds_read_b128 v[136:139], v153 offset:0
    ds_read_b64_tr_b16 v[40:41], v145 offset:0
    ds_read_b64_tr_b16 v[42:43], v145 offset:896
    s_waitcnt lgkmcnt(7)
    v_mfma_f32_32x32x16_bf16 v[64:79], v[28:31], v[132:135], v[64:79]
    ds_read_b64_tr_b16 v[44:45], v145 offset:32
    ds_read_b64_tr_b16 v[46:47], v145 offset:928
    s_waitcnt lgkmcnt(7)
    v_mfma_f32_32x32x16_bf16 v[80:95], v[32:35], v[132:135], v[80:95]
    ds_read_b64_tr_b16 v[48:49], v145 offset:64
    ds_read_b64_tr_b16 v[50:51], v145 offset:960
    s_waitcnt lgkmcnt(7)
    v_mfma_f32_32x32x16_bf16 v[96:111], v[36:39], v[132:135], v[96:111]
    ds_read_b128 v[140:143], v153 offset:1024
    ds_read_b64_tr_b16 v[52:53], v145 offset:3584
    ds_read_b64_tr_b16 v[54:55], v145 offset:4480
    s_waitcnt lgkmcnt(7)
    v_mfma_f32_32x32x16_bf16 v[64:79], v[40:43], v[136:139], v[64:79]
    ds_read_b64_tr_b16 v[56:57], v145 offset:3616
    ds_read_b64_tr_b16 v[58:59], v145 offset:4512
    s_waitcnt lgkmcnt(7)
    v_mfma_f32_32x32x16_bf16 v[80:95], v[44:47], v[136:139], v[80:95]
    ds_read_b64_tr_b16 v[60:61], v145 offset:3648
    ds_read_b64_tr_b16 v[62:63], v145 offset:4544
    s_waitcnt lgkmcnt(7)
    v_mfma_f32_32x32x16_bf16 v[96:111], v[48:51], v[136:139], v[96:111]
    s_waitcnt lgkmcnt(4)
    v_mfma_f32_32x32x16_bf16 v[64:79], v[52:55], v[140:143], v[64:79]
    s_waitcnt lgkmcnt(2)
    v_mfma_f32_32x32x16_bf16 v[80:95], v[56:59], v[140:143], v[80:95]
    s_waitcnt lgkmcnt(0)
    v_mfma_f32_32x32x16_bf16 v[96:111], v[60:63], v[140:143], v[96:111]
    s_nop 15
    v_max_f32 v64, 0, v64
    v_max_f32 v65, 0, v65
    v_max_f32 v66, 0, v66
    v_max_f32 v67, 0, v67
    v_max_f32 v68, 0, v68
    v_max_f32 v69, 0, v69
    v_max_f32 v70, 0, v70
    v_max_f32 v71, 0, v71
    v_mul_f32 v64, v64, v72
    v_mul_f32 v65, v65, v73
    v_mul_f32 v66, v66, v74
    v_mul_f32 v67, v67, v75
    v_mul_f32 v68, v68, v76
    v_mul_f32 v69, v69, v77
    v_mul_f32 v70, v70, v78
    v_mul_f32 v71, v71, v79
    v_cvt_pk_bf16_f32 v72, v64, v65
    v_cvt_pk_bf16_f32 v73, v66, v67
    v_cvt_pk_bf16_f32 v74, v68, v69
    v_cvt_pk_bf16_f32 v75, v70, v71
    global_store_dwordx4 v6, v[72:75], s[50:51] offset:0
    v_max_f32 v80, 0, v80
    v_max_f32 v81, 0, v81
    v_max_f32 v82, 0, v82
    v_max_f32 v83, 0, v83
    v_max_f32 v84, 0, v84
    v_max_f32 v85, 0, v85
    v_max_f32 v86, 0, v86
    v_max_f32 v87, 0, v87
    v_mul_f32 v80, v80, v88
    v_mul_f32 v81, v81, v89
    v_mul_f32 v82, v82, v90
    v_mul_f32 v83, v83, v91
    v_mul_f32 v84, v84, v92
    v_mul_f32 v85, v85, v93
    v_mul_f32 v86, v86, v94
    v_mul_f32 v87, v87, v95
    v_cvt_pk_bf16_f32 v88, v80, v81
    v_cvt_pk_bf16_f32 v89, v82, v83
    v_cvt_pk_bf16_f32 v90, v84, v85
    v_cvt_pk_bf16_f32 v91, v86, v87
    global_store_dwordx4 v6, v[88:91], s[50:51] offset:1024
    v_max_f32 v96, 0, v96
    v_max_f32 v97, 0, v97
    v_max_f32 v98, 0, v98
    v_max_f32 v99, 0, v99
    v_max_f32 v100, 0, v100
    v_max_f32 v101, 0, v101
    v_max_f32 v102, 0, v102
    v_max_f32 v103, 0, v103
    v_mul_f32 v96, v96, v104
    v_mul_f32 v97, v97, v105
    v_mul_f32 v98, v98, v106
    v_mul_f32 v99, v99, v107
    v_mul_f32 v100, v100, v108
    v_mul_f32 v101, v101, v109
    v_mul_f32 v102, v102, v110
    v_mul_f32 v103, v103, v111
    v_cvt_pk_bf16_f32 v104, v96, v97
    v_cvt_pk_bf16_f32 v105, v98, v99
    v_cvt_pk_bf16_f32 v106, v100, v101
    v_cvt_pk_bf16_f32 v107, v102, v103
    global_store_dwordx4 v6, v[104:107], s[50:51] offset:2048
K5_DONE:
K5_END:
    s_endpgm
.globl ffn2_kernel
.p2align 8
.type ffn2_kernel,@function
ffn2_kernel:
    s_load_dwordx16 s[16:31], s[0:1], 0
    s_load_dwordx8 s[32:39], s[0:1], 64
    s_load_dwordx4 s[40:43], s[0:1], 96
    s_cmp_ge_u32 s2, 256
    s_cbranch_scc1 K6_END
    v_and_b32 v1, 63, v0
    v_lshrrev_b32 v2, 6, v0
    s_nop 0
    v_readfirstlane_b32 s3, v2
    s_and_b32 s4, s2, 7
    s_lshr_b32 s5, s2, 3
    s_lshr_b32 s6, s4, 1
    s_lshl_b32 s6, s6, 3
    s_and_b32 s7, s5, 7
    s_add_u32 s6, s6, s7
    s_and_b32 s7, s4, 1
    s_lshl_b32 s7, s7, 2
    s_lshr_b32 s8, s5, 3
    s_add_u32 s7, s7, s8
    v_lshlrev_b32 v6, 4, v1
    v_and_b32 v3, 31, v1
    v_lshrrev_b32 v4, 5, v1
    s_waitcnt lgkmcnt(0)
    s_mul_i32 s9, s3, 28
    s_mul_i32 s10, s6, 224
    s_add_u32 s10, s10, s9
    s_lshl_b32 s10, s10, 10
    s_add_u32 s10, s10, 15204352
    s_add_u32 s44, s42, s10
    s_addc_u32 s45, s43, 0
    s_add_u32 s46, s44, 114688
    s_addc_u32 s47, s45, 0
    s_lshl_b32 s10, s7, 7
    s_add_u32 s48, s32, s10
    s_addc_u32 s49, s33, 0
    s_sub_u32 s50, 1835008, s10
    s_mov_b32 s51, 0x00020000
    v_lshrrev_b32 v9, 3, v1
    v_lshlrev_b32 v9, 10, v9
    v_and_b32 v2, 7, v1
    v_lshl_add_u32 v9, v2, 4, v9
    s_lshl_b32 s14, s9, 14
    s_lshl_b32 s15, s3, 14
    v_lshrrev_b32 v11, 5, v1
    v_lshlrev_b32 v11, 2, v11
    v_bfe_u32 v2, v1, 2, 2
    v_add_u32 v11, v11, v2
    v_lshlrev_b32 v11, 7, v11
    v_bfe_u32 v2, v1, 4, 1
    v_lshl_add_u32 v11, v2, 5, v11
    v_and_b32 v2, 3, v1
    v_lshl_add_u32 v11, v2, 3, v11
    v_add_u32 v11, s15, v11
    s_lshr_b32 s56, s3, 1
    s_and_b32 s57, s3, 1
    s_lshl_b32 s58, s6, 1
    s_add_u32 s58, s58, s56
    s_lshl_b32 s58, s58, 15
    s_lshl_b32 s59, s7, 1
    s_add_u32 s59, s59, s57
    s_lshl_b32 s13, s59, 6
    s_add_u32 s58, s58, s13
    v_lshlrev_b32 v7, 10, v3
    v_lshl_add_u32 v7, v4, 3, v7
    v_add_u32 v7, s58, v7
    s_add_u32 s52, s42, 11010048
    s_addc_u32 s53, s43, 0
    global_load_dwordx2 a[64:65], v7, s[52:53] offset:0
    global_load_dwordx2 a[66:67], v7, s[52:53] offset:16
    global_load_dwordx2 a[68:69], v7, s[52:53] offset:32
    global_load_dwordx2 a[70:71], v7, s[52:53] offset:48
    s_lshl_b32 s13, s59, 7
    v_lshlrev_b32 v8, 4, v4
    v_add_u32 v8, s13, v8
    s_add_u32 s54, s42, 59392
    s_addc_u32 s55, s43, 0
    global_load_dwordx4 a[72:75], v8, s[54:55] offset:0
    global_load_dwordx4 a[76:79], v8, s[54:55] offset:32
    global_load_dwordx4 a[80:83], v8, s[54:55] offset:64
    global_load_dwordx4 a[84:87], v8, s[54:55] offset:96
    s_add_u32 m0, s15, 0
    s_add_u32 s11, s14, 0
    buffer_load_dwordx4 v9, s[48:51], s11 offen lds
    s_add_u32 m0, s15, 1024
    s_add_u32 s11, s14, 8192
    buffer_load_dwordx4 v9, s[48:51], s11 offen lds
    global_load_dwordx4 v[16:19], v6, s[44:45] offset:0
    global_load_dwordx4 v[20:23], v6, s[46:47] offset:0
    s_add_u32 m0, s15, 2048
    s_add_u32 s11, s14, 16384
    buffer_load_dwordx4 v9, s[48:51], s11 offen lds
    s_add_u32 m0, s15, 3072
    s_add_u32 s11, s14, 24576
    buffer_load_dwordx4 v9, s[48:51], s11 offen lds
    global_load_dwordx4 v[24:27], v6, s[44:45] offset:1024
    global_load_dwordx4 v[28:31], v6, s[46:47] offset:1024
    s_add_u32 m0, s15, 4096
    s_add_u32 s11, s14, 32768
    buffer_load_dwordx4 v9, s[48:51], s11 offen lds
    s_add_u32 m0, s15, 5120
    s_add_u32 s11, s14, 40960
    buffer_load_dwordx4 v9, s[48:51], s11 offen lds
    global_load_dwordx4 v[32:35], v6, s[44:45] offset:2048
    global_load_dwordx4 v[36:39], v6, s[46:47] offset:2048
    s_add_u32 m0, s15, 6144
    s_add_u32 s11, s14, 49152
    buffer_load_dwordx4 v9, s[48:51], s11 offen lds
    s_add_u32 m0, s15, 7168
    s_add_u32 s11, s14, 57344
    buffer_load_dwordx4 v9, s[48:51], s11 offen lds
    global_load_dwordx4 v[40:43], v6, s[44:45] offset:3072
    global_load_dwordx4 v[44:47], v6, s[46:47] offset:3072
    s_add_u32 s44, s44, 4096
    s_addc_u32 s45, s45, 0
    s_add_u32 s46, s46, 4096
    s_addc_u32 s47, s47, 0
    s_add_u32 m0, s15, 8192
    s_add_u32 s11, s14, 65536
    buffer_load_dwordx4 v9, s[48:51], s11 offen lds
    s_add_u32 m0, s15, 9216
    s_add_u32 s11, s14, 73728
    buffer_load_dwordx4 v9, s[48:51], s11 offen lds
    global_load_dwordx4 v[48:51], v6, s[44:45] offset:0
    global_load_dwordx4 v[52:55], v6, s[46:47] offset:0
    s_add_u32 m0, s15, 10240
    s_add_u32 s11, s14, 81920
    buffer_load_dwordx4 v9, s[48:51], s11 offen lds
    s_add_u32 m0, s15, 11264
    s_add_u32 s11, s14, 90112
    buffer_load_dwordx4 v9, s[48:51], s11 offen lds
    global_load_dwordx4 v[56:59], v6, s[44:45] offset:1024
    global_load_dwordx4 v[60:63], v6, s[46:47] offset:1024
    s_add_u32 m0, s15, 12288
    s_add_u32 s11, s14, 98304
    buffer_load_dwordx4 v9, s[48:51], s11 offen lds
    s_add_u32 m0, s15, 13312
    s_add_u32 s11, s14, 106496
    buffer_load_dwordx4 v9, s[48:51], s11 offen lds
    global_load_dwordx4 v[64:67], v6, s[44:45] offset:2048
    global_load_dwordx4 v[68:71], v6, s[46:47] offset:2048
    s_add_u32 m0, s15, 14336
    s_add_u32 s11, s14, 114688
    buffer_load_dwordx4 v9, s[48:51], s11 offen lds
    s_add_u32 m0, s15, 15360
    s_add_u32 s11, s14, 122880
    buffer_load_dwordx4 v9, s[48:51], s11 offen lds
    global_load_dwordx4 v[72:75], v6, s[44:45] offset:3072
    global_load_dwordx4 v[76:79], v6, s[46:47] offset:3072
    s_add_u32 s44, s44, 4096
    s_addc_u32 s45, s45, 0
    s_add_u32 s46, s46, 4096
    s_addc_u32 s47, s47, 0
    global_load_dwordx4 v[80:83], v6, s[44:45] offset:0
    global_load_dwordx4 v[84:87], v6, s[46:47] offset:0
    global_load_dwordx4 v[88:91], v6, s[44:45] offset:1024
    global_load_dwordx4 v[92:95], v6, s[46:47] offset:1024
    global_load_dwordx4 v[96:99], v6, s[44:45] offset:2048
    global_load_dwordx4 v[100:103], v6, s[46:47] offset:2048
    global_load_dwordx4 v[104:107], v6, s[44:45] offset:3072
    global_load_dwordx4 v[108:111], v6, s[46:47] offset:3072
    s_add_u32 s44, s44, 4096
    s_addc_u32 s45, s45, 0
    s_add_u32 s46, s46, 4096
    s_addc_u32 s47, s47, 0
    global_load_dwordx4 v[112:115], v6, s[44:45] offset:0
    global_load_dwordx4 v[116:119], v6, s[46:47] offset:0
    global_load_dwordx4 v[120:123], v6, s[44:45] offset:1024
    global_load_dwordx4 v[124:127], v6, s[46:47] offset:1024
    global_load_dwordx4 v[128:131], v6, s[44:45] offset:2048
    global_load_dwordx4 v[132:135], v6, s[46:47] offset:2048
    global_load_dwordx4 v[136:139], v6, s[44:45] offset:3072
    global_load_dwordx4 v[140:143], v6, s[46:47] offset:3072
    s_add_u32 s44, s44, 4096
    s_addc_u32 s45, s45, 0
    s_add_u32 s46, s46, 4096
    s_addc_u32 s47, s47, 0
    global_load_dwordx4 v[144:147], v6, s[44:45] offset:0
    global_load_dwordx4 v[148:151], v6, s[46:47] offset:0
    global_load_dwordx4 v[152:155], v6, s[44:45] offset:1024
    global_load_dwordx4 v[156:159], v6, s[46:47] offset:1024
    global_load_dwordx4 v[160:163], v6, s[44:45] offset:2048
    global_load_dwordx4 v[164:167], v6, s[46:47] offset:2048
    global_load_dwordx4 v[168:171], v6, s[44:45] offset:3072
    global_load_dwordx4 v[172:175], v6, s[46:47] offset:3072
    s_add_u32 s44, s44, 4096
    s_addc_u32 s45, s45, 0
    s_add_u32 s46, s46, 4096
    s_addc_u32 s47, s47, 0
    global_load_dwordx4 v[176:179], v6, s[44:45] offset:0
    global_load_dwordx4 v[180:183], v6, s[46:47] offset:0
    global_load_dwordx4 v[184:187], v6, s[44:45] offset:1024
    global_load_dwordx4 v[188:191], v6, s[46:47] offset:1024
    global_load_dwordx4 v[192:195], v6, s[44:45] offset:2048
    global_load_dwordx4 v[196:199], v6, s[46:47] offset:2048
    global_load_dwordx4 v[200:203], v6, s[44:45] offset:3072
    global_load_dwordx4 v[204:207], v6, s[46:47] offset:3072
    s_add_u32 s44, s44, 4096
    s_addc_u32 s45, s45, 0
    s_add_u32 s46, s46, 4096
    s_addc_u32 s47, s47, 0
    v_accvgpr_write_b32 a0, 0
    v_accvgpr_write_b32 a1, 0
    v_accvgpr_write_b32 a2, 0
    v_accvgpr_write_b32 a3, 0
    v_accvgpr_write_b32 a4, 0
    v_accvgpr_write_b32 a5, 0
    v_accvgpr_write_b32 a6, 0
    v_accvgpr_write_b32 a7, 0
    v_accvgpr_write_b32 a8, 0
    v_accvgpr_write_b32 a9, 0
    v_accvgpr_write_b32 a10, 0
    v_accvgpr_write_b32 a11, 0
    v_accvgpr_write_b32 a12, 0
    v_accvgpr_write_b32 a13, 0
    v_accvgpr_write_b32 a14, 0
    v_accvgpr_write_b32 a15, 0
    v_accvgpr_write_b32 a16, 0
    v_accvgpr_write_b32 a17, 0
    v_accvgpr_write_b32 a18, 0
    v_accvgpr_write_b32 a19, 0
    v_accvgpr_write_b32 a20, 0
    v_accvgpr_write_b32 a21, 0
    v_accvgpr_write_b32 a22, 0
    v_accvgpr_write_b32 a23, 0
    v_accvgpr_write_b32 a24, 0
    v_accvgpr_write_b32 a25, 0
    v_accvgpr_write_b32 a26, 0
    v_accvgpr_write_b32 a27, 0
    v_accvgpr_write_b32 a28, 0
    v_accvgpr_write_b32 a29, 0
    v_accvgpr_write_b32 a30, 0
    v_accvgpr_write_b32 a31, 0
    v_accvgpr_write_b32 a32, 0
    v_accvgpr_write_b32 a33, 0
    v_accvgpr_write_b32 a34, 0
    v_accvgpr_write_b32 a35, 0
    v_accvgpr_write_b32 a36, 0
    v_accvgpr_write_b32 a37, 0
    v_accvgpr_write_b32 a38, 0
    v_accvgpr_write_b32 a39, 0
    v_accvgpr_write_b32 a40, 0
    v_accvgpr_write_b32 a41, 0
    v_accvgpr_write_b32 a42, 0
    v_accvgpr_write_b32 a43, 0
    v_accvgpr_write_b32 a44, 0
    v_accvgpr_write_b32 a45, 0
    v_accvgpr_write_b32 a46, 0
    v_accvgpr_write_b32 a47, 0
    v_accvgpr_write_b32 a48, 0
    v_accvgpr_write_b32 a49, 0
    v_accvgpr_write_b32 a50, 0
    v_accvgpr_write_b32 a51, 0
    v_accvgpr_write_b32 a52, 0
    v_accvgpr_write_b32 a53, 0
    v_accvgpr_write_b32 a54, 0
    v_accvgpr_write_b32 a55, 0
    v_accvgpr_write_b32 a56, 0
    v_accvgpr_write_b32 a57, 0
    v_accvgpr_write_b32 a58, 0
    v_accvgpr_write_b32 a59, 0
    v_accvgpr_write_b32 a60, 0
    v_accvgpr_write_b32 a61, 0
    v_accvgpr_write_b32 a62, 0
    v_accvgpr_write_b32 a63, 0
    s_waitcnt vmcnt(62)
    ds_read_b64_tr_b16 v[208:209], v11 offset:0
    ds_read_b64_tr_b16 v[210:211], v11 offset:1024
    ds_read_b64_tr_b16 v[212:213], v11 offset:64
    ds_read_b64_tr_b16 v[214:215], v11 offset:1088
    s_waitcnt vmcnt(58)
    ds_read_b64_tr_b16 v[216:217], v11 offset:2048
    ds_read_b64_tr_b16 v[218:219], v11 offset:3072
    ds_read_b64_tr_b16 v[220:221], v11 offset:2112
    ds_read_b64_tr_b16 v[222:223], v11 offset:3136
    s_waitcnt vmcnt(54)
    ds_read_b64_tr_b16 v[224:225], v11 offset:4096
    ds_read_b64_tr_b16 v[226:227], v11 offset:5120
    ds_read_b64_tr_b16 v[228:229], v11 offset:4160
    ds_read_b64_tr_b16 v[230:231], v11 offset:5184
    s_waitcnt vmcnt(60) lgkmcnt(8)
    v_mfma_f32_32x32x16_bf16 a[0:15], v[208:211], v[16:19], a[0:15]
    v_mfma_f32_32x32x16_bf16 a[16:31], v[212:215], v[16:19], a[16:31]
    v_mfma_f32_32x32x16_bf16 a[32:47], v[208:211], v[20:23], a[32:47]
    v_mfma_f32_32x32x16_bf16 a[48:63], v[212:215], v[20:23], a[48:63]
    s_add_u32 m0, s15, 0
    s_add_u32 s11, s14, 131072
    buffer_load_dwordx4 v9, s[48:51], s11 offen lds
    s_add_u32 m0, s15, 1024
    s_add_u32 s11, s14, 139264
    buffer_load_dwordx4 v9, s[48:51], s11 offen lds
    global_load_dwordx4 v[16:19], v6, s[44:45] offset:0
    global_load_dwordx4 v[20:23], v6, s[46:47] offset:0
    s_waitcnt vmcnt(54)
    ds_read_b64_tr_b16 v[208:209], v11 offset:6144
    ds_read_b64_tr_b16 v[210:211], v11 offset:7168
    ds_read_b64_tr_b16 v[212:213], v11 offset:6208
    ds_read_b64_tr_b16 v[214:215], v11 offset:7232
    s_waitcnt vmcnt(60) lgkmcnt(8)
    v_mfma_f32_32x32x16_bf16 a[0:15], v[216:219], v[24:27], a[0:15]
    v_mfma_f32_32x32x16_bf16 a[16:31], v[220:223], v[24:27], a[16:31]
    v_mfma_f32_32x32x16_bf16 a[32:47], v[216:219], v[28:31], a[32:47]
    v_mfma_f32_32x32x16_bf16 a[48:63], v[220:223], v[28:31], a[48:63]
    s_add_u32 m0, s15, 2048
    s_add_u32 s11, s14, 147456
    buffer_load_dwordx4 v9, s[48:51], s11 offen lds
    s_add_u32 m0, s15, 3072
    s_add_u32 s11, s14, 155648
    buffer_load_dwordx4 v9, s[48:51], s11 offen lds
    global_load_dwordx4 v[24:27], v6, s[44:45] offset:1024
    global_load_dwordx4 v[28:31], v6, s[46:47] offset:1024
    s_waitcnt vmcnt(54)
    ds_read_b64_tr_b16 v[216:217], v11 offset:8192
    ds_read_b64_tr_b16 v[218:219], v11 offset:9216
    ds_read_b64_tr_b16 v[220:221], v11 offset:8256
    ds_read_b64_tr_b16 v[222:223], v11 offset:9280
    s_waitcnt vmcnt(60) lgkmcnt(8)
    v_mfma_f32_32x32x16_bf16 a[0:15], v[224:227], v[32:35], a[0:15]
    v_mfma_f32_32x32x16_bf16 a[16:31], v[228:231], v[32:35], a[16:31]
    v_mfma_f32_32x32x16_bf16 a[32:47], v[224:227], v[36:39], a[32:47]
    v_mfma_f32_32x32x16_bf16 a[48:63], v[228:231], v[36:39], a[48:63]
    s_add_u32 m0, s15, 4096
    s_add_u32 s11, s14, 163840
    buffer_load_dwordx4 v9, s[48:51], s11 offen lds
    s_add_u32 m0, s15, 5120
    s_add_u32 s11, s14, 172032
    buffer_load_dwordx4 v9, s[48:51], s11 offen lds
    global_load_dwordx4 v[32:35], v6, s[44:45] offset:2048
    global_load_dwordx4 v[36:39], v6, s[46:47] offset:2048
    s_waitcnt vmcnt(54)
    ds_read_b64_tr_b16 v[224:225], v11 offset:10240
    ds_read_b64_tr_b16 v[226:227], v11 offset:11264
    ds_read_b64_tr_b16 v[228:229], v11 offset:10304
    ds_read_b64_tr_b16 v[230:231], v11 offset:11328
    s_waitcnt vmcnt(60) lgkmcnt(8)
    v_mfma_f32_32x32x16_bf16 a[0:15], v[208:211], v[40:43], a[0:15]
    v_mfma_f32_32x32x16_bf16 a[16:31], v[212:215], v[40:43], a[16:31]
    v_mfma_f32_32x32x16_bf16 a[32:47], v[208:211], v[44:47], a[32:47]
    v_mfma_f32_32x32x16_bf16 a[48:63], v[212:215], v[44:47], a[48:63]
    s_add_u32 m0, s15, 6144
    s_add_u32 s11, s14, 180224
    buffer_load_dwordx4 v9, s[48:51], s11 offen lds
    s_add_u32 m0, s15, 7168
    s_add_u32 s11, s14, 188416
    buffer_load_dwordx4 v9, s[48:51], s11 offen lds
    global_load_dwordx4 v[40:43], v6, s[44:45] offset:3072
    global_load_dwordx4 v[44:47], v6, s[46:47] offset:3072
    s_add_u32 s44, s44, 4096
    s_addc_u32 s45, s45, 0
    s_add_u32 s46, s46, 4096
    s_addc_u32 s47, s47, 0
    s_waitcnt vmcnt(54)
    ds_read_b64_tr_b16 v[208:209], v11 offset:12288
    ds_read_b64_tr_b16 v[210:211], v11 offset:13312
    ds_read_b64_tr_b16 v[212:213], v11 offset:12352
    ds_read_b64_tr_b16 v[214:215], v11 offset:13376
    s_waitcnt vmcnt(60) lgkmcnt(8)
    v_mfma_f32_32x32x16_bf16 a[0:15], v[216:219], v[48:51], a[0:15]
    v_mfma_f32_32x32x16_bf16 a[16:31], v[220:223], v[48:51], a[16:31]
    v_mfma_f32_32x32x16_bf16 a[32:47], v[216:219], v[52:55], a[32:47]
    v_mfma_f32_32x32x16_bf16 a[48:63], v[220:223], v[52:55], a[48:63]
    s_add_u32 m0, s15, 8192
    s_add_u32 s11, s14, 196608
    buffer_load_dwordx4 v9, s[48:51], s11 offen lds
    s_add_u32 m0, s15, 9216
    s_add_u32 s11, s14, 204800
    buffer_load_dwordx4 v9, s[48:51], s11 offen lds
    s_waitcnt vmcnt(52)
    ds_read_b64_tr_b16 v[216:217], v11 offset:14336
    ds_read_b64_tr_b16 v[218:219], v11 offset:15360
    ds_read_b64_tr_b16 v[220:221], v11 offset:14400
    ds_read_b64_tr_b16 v[222:223], v11 offset:15424
    s_waitcnt vmcnt(58) lgkmcnt(8)
    v_mfma_f32_32x32x16_bf16 a[0:15], v[224:227], v[56:59], a[0:15]
    v_mfma_f32_32x32x16_bf16 a[16:31], v[228:231], v[56:59], a[16:31]
    v_mfma_f32_32x32x16_bf16 a[32:47], v[224:227], v[60:63], a[32:47]
    v_mfma_f32_32x32x16_bf16 a[48:63], v[228:231], v[60:63], a[48:63]
    s_add_u32 m0, s15, 10240
    s_add_u32 s11, s14, 212992
    buffer_load_dwordx4 v9, s[48:51], s11 offen lds
    s_add_u32 m0, s15, 11264
    s_add_u32 s11, s14, 221184
    buffer_load_dwordx4 v9, s[48:51], s11 offen lds
    s_waitcnt vmcnt(18)
    ds_read_b64_tr_b16 v[224:225], v11 offset:0
    ds_read_b64_tr_b16 v[226:227], v11 offset:1024
    ds_read_b64_tr_b16 v[228:229], v11 offset:64
    ds_read_b64_tr_b16 v[230:231], v11 offset:1088
    s_waitcnt vmcnt(56) lgkmcnt(8)
    v_mfma_f32_32x32x16_bf16 a[0:15], v[208:211], v[64:67], a[0:15]
    v_mfma_f32_32x32x16_bf16 a[16:31], v[212:215], v[64:67], a[16:31]
    v_mfma_f32_32x32x16_bf16 a[32:47], v[208:211], v[68:71], a[32:47]
    v_mfma_f32_32x32x16_bf16 a[48:63], v[212:215], v[68:71], a[48:63]
    s_add_u32 m0, s15, 12288
    s_add_u32 s11, s14, 229376
    buffer_load_dwordx4 v9, s[48:51], s11 offen lds
    s_add_u32 m0, s15, 13312
    s_add_u32 s11, s14, 237568
    buffer_load_dwordx4 v9, s[48:51], s11 offen lds
    s_waitcnt vmcnt(16)
    ds_read_b64_tr_b16 v[208:209], v11 offset:2048
    ds_read_b64_tr_b16 v[210:211], v11 offset:3072
    ds_read_b64_tr_b16 v[212:213], v11 offset:2112
    ds_read_b64_tr_b16 v[214:215], v11 offset:3136
    s_waitcnt vmcnt(54) lgkmcnt(8)
    v_mfma_f32_32x32x16_bf16 a[0:15], v[216:219], v[72:75], a[0:15]
    v_mfma_f32_32x32x16_bf16 a[16:31], v[220:223], v[72:75], a[16:31]
    v_mfma_f32_32x32x16_bf16 a[32:47], v[216:219], v[76:79], a[32:47]
    v_mfma_f32_32x32x16_bf16 a[48:63], v[220:223], v[76:79], a[48:63]
    s_add_u32 m0, s15, 14336
    s_add_u32 s11, s14, 245760
    buffer_load_dwordx4 v9, s[48:51], s11 offen lds
    s_add_u32 m0, s15, 15360
    s_add_u32 s11, s14, 253952
    buffer_load_dwordx4 v9, s[48:51], s11 offen lds
    s_waitcnt vmcnt(14)
    ds_read_b64_tr_b16 v[216:217], v11 offset:4096
    ds_read_b64_tr_b16 v[218:219], v11 offset:5120
    ds_read_b64_tr_b16 v[220:221], v11 offset:4160
    ds_read_b64_tr_b16 v[222:223], v11 offset:5184
    s_waitcnt vmcnt(54) lgkmcnt(8)
    v_mfma_f32_32x32x16_bf16 a[0:15], v[224:227], v[80:83], a[0:15]
    v_mfma_f32_32x32x16_bf16 a[16:31], v[228:231], v[80:83], a[16:31]
    v_mfma_f32_32x32x16_bf16 a[32:47], v[224:227], v[84:87], a[32:47]
    v_mfma_f32_32x32x16_bf16 a[48:63], v[228:231], v[84:87], a[48:63]
    s_add_u32 m0, s15, 0
    s_add_u32 s11, s14, 262144
    buffer_load_dwordx4 v9, s[48:51], s11 offen lds
    s_add_u32 m0, s15, 1024
    s_add_u32 s11, s14, 270336
    buffer_load_dwordx4 v9, s[48:51], s11 offen lds
    s_waitcnt vmcnt(12)
    ds_read_b64_tr_b16 v[224:225], v11 offset:6144
    ds_read_b64_tr_b16 v[226:227], v11 offset:7168
    ds_read_b64_tr_b16 v[228:229], v11 offset:6208
    ds_read_b64_tr_b16 v[230:231], v11 offset:7232
    s_waitcnt vmcnt(54) lgkmcnt(8)
    v_mfma_f32_32x32x16_bf16 a[0:15], v[208:211], v[88:91], a[0:15]
    v_mfma_f32_32x32x16_bf16 a[16:31], v[212:215], v[88:91], a[16:31]
    v_mfma_f32_32x32x16_bf16 a[32:47], v[208:211], v[92:95], a[32:47]
    v_mfma_f32_32x32x16_bf16 a[48:63], v[212:215], v[92:95], a[48:63]
    s_add_u32 m0, s15, 2048
    s_add_u32 s11, s14, 278528
    buffer_load_dwordx4 v9, s[48:51], s11 offen lds
    s_add_u32 m0, s15, 3072
    s_add_u32 s11, s14, 286720
    buffer_load_dwordx4 v9, s[48:51], s11 offen lds
    s_waitcnt vmcnt(10)
    ds_read_b64_tr_b16 v[208:209], v11 offset:8192
    ds_read_b64_tr_b16 v[210:211], v11 offset:9216
    ds_read_b64_tr_b16 v[212:213], v11 offset:8256
    ds_read_b64_tr_b16 v[214:215], v11 offset:9280
    s_waitcnt vmcnt(54) lgkmcnt(8)
    v_mfma_f32_32x32x16_bf16 a[0:15], v[216:219], v[96:99], a[0:15]
    v_mfma_f32_32x32x16_bf16 a[16:31], v[220:223], v[96:99], a[16:31]
    v_mfma_f32_32x32x16_bf16 a[32:47], v[216:219], v[100:103], a[32:47]
    v_mfma_f32_32x32x16_bf16 a[48:63], v[220:223], v[100:103], a[48:63]
    s_add_u32 m0, s15, 4096
    s_add_u32 s11, s14, 294912
    buffer_load_dwordx4 v9, s[48:51], s11 offen lds
    s_add_u32 m0, s15, 5120
    s_add_u32 s11, s14, 303104
    buffer_load_dwordx4 v9, s[48:51], s11 offen lds
    s_waitcnt vmcnt(10)
    ds_read_b64_tr_b16 v[216:217], v11 offset:10240
    ds_read_b64_tr_b16 v[218:219], v11 offset:11264
    ds_read_b64_tr_b16 v[220:221], v11 offset:10304
    ds_read_b64_tr_b16 v[222:223], v11 offset:11328
    s_waitcnt vmcnt(54) lgkmcnt(8)
    v_mfma_f32_32x32x16_bf16 a[0:15], v[224:227], v[104:107], a[0:15]
    v_mfma_f32_32x32x16_bf16 a[16:31], v[228:231], v[104:107], a[16:31]
    v_mfma_f32_32x32x16_bf16 a[32:47], v[224:227], v[108:111], a[32:47]
    v_mfma_f32_32x32x16_bf16 a[48:63], v[228:231], v[108:111], a[48:63]
    s_add_u32 m0, s15, 6144
    s_add_u32 s11, s14, 311296
    buffer_load_dwordx4 v9, s[48:51], s11 offen lds
    s_add_u32 m0, s15, 7168
    s_add_u32 s11, s14, 319488
    buffer_load_dwordx4 v9, s[48:51], s11 offen lds
    s_waitcnt vmcnt(10)
    ds_read_b64_tr_b16 v[224:225], v11 offset:12288
    ds_read_b64_tr_b16 v[226:227], v11 offset:13312
    ds_read_b64_tr_b16 v[228:229], v11 offset:12352
    ds_read_b64_tr_b16 v[230:231], v11 offset:13376
    s_waitcnt vmcnt(54) lgkmcnt(8)
    v_mfma_f32_32x32x16_bf16 a[0:15], v[208:211], v[112:115], a[0:15]
    v_mfma_f32_32x32x16_bf16 a[16:31], v[212:215], v[112:115], a[16:31]
    v_mfma_f32_32x32x16_bf16 a[32:47], v[208:211], v[116:119], a[32:47]
    v_mfma_f32_32x32x16_bf16 a[48:63], v[212:215], v[116:119], a[48:63]
    s_add_u32 m0, s15, 8192
    s_add_u32 s11, s14, 327680
    buffer_load_dwordx4 v9, s[48:51], s11 offen lds
    s_add_u32 m0, s15, 9216
    s_add_u32 s11, s14, 335872
    buffer_load_dwordx4 v9, s[48:51], s11 offen lds
    s_waitcnt vmcnt(10)
    ds_read_b64_tr_b16 v[208:209], v11 offset:14336
    ds_read_b64_tr_b16 v[210:211], v11 offset:15360
    ds_read_b64_tr_b16 v[212:213], v11 offset:14400
    ds_read_b64_tr_b16 v[214:215], v11 offset:15424
    s_waitcnt vmcnt(54) lgkmcnt(8)
    v_mfma_f32_32x32x16_bf16 a[0:15], v[216:219], v[120:123], a[0:15]
    v_mfma_f32_32x32x16_bf16 a[16:31], v[220:223], v[120:123], a[16:31]
    v_mfma_f32_32x32x16_bf16 a[32:47], v[216:219], v[124:127], a[32:47]
    v_mfma_f32_32x32x16_bf16 a[48:63], v[220:223], v[124:127], a[48:63]
    s_add_u32 m0, s15, 10240
    s_add_u32 s11, s14, 344064
    buffer_load_dwordx4 v9, s[48:51], s11 offen lds
    s_add_u32 m0, s15, 11264
    s_add_u32 s11, s14, 352256
    buffer_load_dwordx4 v9, s[48:51], s11 offen lds
    s_waitcnt vmcnt(10)
    ds_read_b64_tr_b16 v[216:217], v11 offset:0
    ds_read_b64_tr_b16 v[218:219], v11 offset:1024
    ds_read_b64_tr_b16 v[220:221], v11 offset:64
    ds_read_b64_tr_b16 v[222:223], v11 offset:1088
    s_waitcnt vmcnt(54) lgkmcnt(8)
    v_mfma_f32_32x32x16_bf16 a[0:15], v[224:227], v[128:131], a[0:15]
    v_mfma_f32_32x32x16_bf16 a[16:31], v[228:231], v[128:131], a[16:31]
    v_mfma_f32_32x32x16_bf16 a[32:47], v[224:227], v[132:135], a[32:47]
    v_mfma_f32_32x32x16_bf16 a[48:63], v[228:231], v[132:135], a[48:63]
    s_add_u32 m0, s15, 12288
    s_add_u32 s11, s14, 360448
    buffer_load_dwordx4 v9, s[48:51], s11 offen lds
    s_add_u32 m0, s15, 13312
    s_add_u32 s11, s14, 368640
    buffer_load_dwordx4 v9, s[48:51], s11 offen lds
    s_waitcnt vmcnt(10)
    ds_read_b64_tr_b16 v[224:225], v11 offset:2048
    ds_read_b64_tr_b16 v[226:227], v11 offset:3072
    ds_read_b64_tr_b16 v[228:229], v11 offset:2112
    ds_read_b64_tr_b16 v[230:231], v11 offset:3136
    s_waitcnt vmcnt(54) lgkmcnt(8)
    v_mfma_f32_32x32x16_bf16 a[0:15], v[208:211], v[136:139], a[0:15]
    v_mfma_f32_32x32x16_bf16 a[16:31], v[212:215], v[136:139], a[16:31]
    v_mfma_f32_32x32x16_bf16 a[32:47], v[208:211], v[140:143], a[32:47]
    v_mfma_f32_32x32x16_bf16 a[48:63], v[212:215], v[140:143], a[48:63]
    s_add_u32 m0, s15, 14336
    s_add_u32 s11, s14, 376832
    buffer_load_dwordx4 v9, s[48:51], s11 offen lds
    s_add_u32 m0, s15, 15360
    s_add_u32 s11, s14, 385024
    buffer_load_dwordx4 v9, s[48:51], s11 offen lds
    s_waitcnt vmcnt(10)
    ds_read_b64_tr_b16 v[208:209], v11 offset:4096
    ds_read_b64_tr_b16 v[210:211], v11 offset:5120
    ds_read_b64_tr_b16 v[212:213], v11 offset:4160
    ds_read_b64_tr_b16 v[214:215], v11 offset:5184
    s_waitcnt vmcnt(54) lgkmcnt(8)
    v_mfma_f32_32x32x16_bf16 a[0:15], v[216:219], v[144:147], a[0:15]
    v_mfma_f32_32x32x16_bf16 a[16:31], v[220:223], v[144:147], a[16:31]
    v_mfma_f32_32x32x16_bf16 a[32:47], v[216:219], v[148:151], a[32:47]
    v_mfma_f32_32x32x16_bf16 a[48:63], v[220:223], v[148:151], a[48:63]
    s_add_u32 m0, s15, 0
    s_add_u32 s11, s14, 393216
    buffer_load_dwordx4 v9, s[48:51], s11 offen lds
    s_add_u32 m0, s15, 1024
    s_add_u32 s11, s14, 401408
    buffer_load_dwordx4 v9, s[48:51], s11 offen lds
    s_waitcnt vmcnt(10)
    ds_read_b64_tr_b16 v[216:217], v11 offset:6144
    ds_read_b64_tr_b16 v[218:219], v11 offset:7168
    ds_read_b64_tr_b16 v[220:221], v11 offset:6208
    ds_read_b64_tr_b16 v[222:223], v11 offset:7232
    s_waitcnt vmcnt(54) lgkmcnt(8)
    v_mfma_f32_32x32x16_bf16 a[0:15], v[224:227], v[152:155], a[0:15]
    v_mfma_f32_32x32x16_bf16 a[16:31], v[228:231], v[152:155], a[16:31]
    v_mfma_f32_32x32x16_bf16 a[32:47], v[224:227], v[156:159], a[32:47]
    v_mfma_f32_32x32x16_bf16 a[48:63], v[228:231], v[156:159], a[48:63]
    s_add_u32 m0, s15, 2048
    s_add_u32 s11, s14, 409600
    buffer_load_dwordx4 v9, s[48:51], s11 offen lds
    s_add_u32 m0, s15, 3072
    s_add_u32 s11, s14, 417792
    buffer_load_dwordx4 v9, s[48:51], s11 offen lds
    s_waitcnt vmcnt(10)
    ds_read_b64_tr_b16 v[224:225], v11 offset:8192
    ds_read_b64_tr_b16 v[226:227], v11 offset:9216
    ds_read_b64_tr_b16 v[228:229], v11 offset:8256
    ds_read_b64_tr_b16 v[230:231], v11 offset:9280
    s_waitcnt vmcnt(54) lgkmcnt(8)
    v_mfma_f32_32x32x16_bf16 a[0:15], v[208:211], v[160:163], a[0:15]
    v_mfma_f32_32x32x16_bf16 a[16:31], v[212:215], v[160:163], a[16:31]
    v_mfma_f32_32x32x16_bf16 a[32:47], v[208:211], v[164:167], a[32:47]
    v_mfma_f32_32x32x16_bf16 a[48:63], v[212:215], v[164:167], a[48:63]
    s_add_u32 m0, s15, 4096
    s_add_u32 s11, s14, 425984
    buffer_load_dwordx4 v9, s[48:51], s11 offen lds
    s_add_u32 m0, s15, 5120
    s_add_u32 s11, s14, 434176
    buffer_load_dwordx4 v9, s[48:51], s11 offen lds
    s_waitcnt vmcnt(10)
    ds_read_b64_tr_b16 v[208:209], v11 offset:10240
    ds_read_b64_tr_b16 v[210:211], v11 offset:11264
    ds_read_b64_tr_b16 v[212:213], v11 offset:10304
    ds_read_b64_tr_b16 v[214:215], v11 offset:11328
    s_waitcnt vmcnt(54) lgkmcnt(8)
    v_mfma_f32_32x32x16_bf16 a[0:15], v[216:219], v[168:171], a[0:15]
    v_mfma_f32_32x32x16_bf16 a[16:31], v[220:223], v[168:171], a[16:31]
    v_mfma_f32_32x32x16_bf16 a[32:47], v[216:219], v[172:175], a[32:47]
    v_mfma_f32_32x32x16_bf16 a[48:63], v[220:223], v[172:175], a[48:63]
    s_add_u32 m0, s15, 6144
    s_add_u32 s11, s14, 442368
    buffer_load_dwordx4 v9, s[48:51], s11 offen lds
    s_add_u32 m0, s15, 7168
    s_add_u32 s11, s14, 450560
    buffer_load_dwordx4 v9, s[48:51], s11 offen lds
    s_waitcnt vmcnt(10)
    ds_read_b64_tr_b16 v[216:217], v11 offset:12288
    ds_read_b64_tr_b16 v[218:219], v11 offset:13312
    ds_read_b64_tr_b16 v[220:221], v11 offset:12352
    ds_read_b64_tr_b16 v[222:223], v11 offset:13376
    s_waitcnt vmcnt(54) lgkmcnt(8)
    v_mfma_f32_32x32x16_bf16 a[0:15], v[224:227], v[176:179], a[0:15]
    v_mfma_f32_32x32x16_bf16 a[16:31], v[228:231], v[176:179], a[16:31]
    v_mfma_f32_32x32x16_bf16 a[32:47], v[224:227], v[180:183], a[32:47]
    v_mfma_f32_32x32x16_bf16 a[48:63], v[228:231], v[180:183], a[48:63]
    s_waitcnt vmcnt(8)
    ds_read_b64_tr_b16 v[224:225], v11 offset:14336
    ds_read_b64_tr_b16 v[226:227], v11 offset:15360
    ds_read_b64_tr_b16 v[228:229], v11 offset:14400
    ds_read_b64_tr_b16 v[230:231], v11 offset:15424
    s_waitcnt vmcnt(52) lgkmcnt(8)
    v_mfma_f32_32x32x16_bf16 a[0:15], v[208:211], v[184:187], a[0:15]
    v_mfma_f32_32x32x16_bf16 a[16:31], v[212:215], v[184:187], a[16:31]
    v_mfma_f32_32x32x16_bf16 a[32:47], v[208:211], v[188:191], a[32:47]
    v_mfma_f32_32x32x16_bf16 a[48:63], v[212:215], v[188:191], a[48:63]
    s_waitcnt vmcnt(6)
    ds_read_b64_tr_b16 v[208:209], v11 offset:0
    ds_read_b64_tr_b16 v[210:211], v11 offset:1024
    ds_read_b64_tr_b16 v[212:213], v11 offset:64
    ds_read_b64_tr_b16 v[214:215], v11 offset:1088
    s_waitcnt vmcnt(50) lgkmcnt(8)
    v_mfma_f32_32x32x16_bf16 a[0:15], v[216:219], v[192:195], a[0:15]
    v_mfma_f32_32x32x16_bf16 a[16:31], v[220:223], v[192:195], a[16:31]
    v_mfma_f32_32x32x16_bf16 a[32:47], v[216:219], v[196:199], a[32:47]
    v_mfma_f32_32x32x16_bf16 a[48:63], v[220:223], v[196:199], a[48:63]
    s_waitcnt vmcnt(4)
    ds_read_b64_tr_b16 v[216:217], v11 offset:2048
    ds_read_b64_tr_b16 v[218:219], v11 offset:3072
    ds_read_b64_tr_b16 v[220:221], v11 offset:2112
    ds_read_b64_tr_b16 v[222:223], v11 offset:3136
    s_waitcnt vmcnt(48) lgkmcnt(8)
    v_mfma_f32_32x32x16_bf16 a[0:15], v[224:227], v[200:203], a[0:15]
    v_mfma_f32_32x32x16_bf16 a[16:31], v[228:231], v[200:203], a[16:31]
    v_mfma_f32_32x32x16_bf16 a[32:47], v[224:227], v[204:207], a[32:47]
    v_mfma_f32_32x32x16_bf16 a[48:63], v[228:231], v[204:207], a[48:63]
    s_waitcnt vmcnt(2)
    ds_read_b64_tr_b16 v[224:225], v11 offset:4096
    ds_read_b64_tr_b16 v[226:227], v11 offset:5120
    ds_read_b64_tr_b16 v[228:229], v11 offset:4160
    ds_read_b64_tr_b16 v[230:231], v11 offset:5184
    s_waitcnt vmcnt(44) lgkmcnt(8)
    v_mfma_f32_32x32x16_bf16 a[0:15], v[208:211], v[16:19], a[0:15]
    v_mfma_f32_32x32x16_bf16 a[16:31], v[212:215], v[16:19], a[16:31]
    v_mfma_f32_32x32x16_bf16 a[32:47], v[208:211], v[20:23], a[32:47]
    v_mfma_f32_32x32x16_bf16 a[48:63], v[212:215], v[20:23], a[48:63]
    s_waitcnt vmcnt(0)
    ds_read_b64_tr_b16 v[208:209], v11 offset:6144
    ds_read_b64_tr_b16 v[210:211], v11 offset:7168
    ds_read_b64_tr_b16 v[212:213], v11 offset:6208
    ds_read_b64_tr_b16 v[214:215], v11 offset:7232
    s_waitcnt vmcnt(40) lgkmcnt(8)
    v_mfma_f32_32x32x16_bf16 a[0:15], v[216:219], v[24:27], a[0:15]
    v_mfma_f32_32x32x16_bf16 a[16:31], v[220:223], v[24:27], a[16:31]
    v_mfma_f32_32x32x16_bf16 a[32:47], v[216:219], v[28:31], a[32:47]
    v_mfma_f32_32x32x16_bf16 a[48:63], v[220:223], v[28:31], a[48:63]
    s_waitcnt vmcnt(36) lgkmcnt(4)
    v_mfma_f32_32x32x16_bf16 a[0:15], v[224:227], v[32:35], a[0:15]
    v_mfma_f32_32x32x16_bf16 a[16:31], v[228:231], v[32:35], a[16:31]
    v_mfma_f32_32x32x16_bf16 a[32:47], v[224:227], v[36:39], a[32:47]
    v_mfma_f32_32x32x16_bf16 a[48:63], v[228:231], v[36:39], a[48:63]
    s_waitcnt vmcnt(32) lgkmcnt(0)
    v_mfma_f32_32x32x16_bf16 a[0:15], v[208:211], v[40:43], a[0:15]
    v_mfma_f32_32x32x16_bf16 a[16:31], v[212:215], v[40:43], a[16:31]
    v_mfma_f32_32x32x16_bf16 a[32:47], v[208:211], v[44:47], a[32:47]
    v_mfma_f32_32x32x16_bf16 a[48:63], v[212:215], v[44:47], a[48:63]
    s_barrier
    s_nop 7
    s_lshl_b32 s12, s3, 14
    v_add_u32 v10, s12, v6
    v_accvgpr_read_b32 v96, a0
    v_accvgpr_read_b32 v97, a1
    v_accvgpr_read_b32 v98, a2
    v_accvgpr_read_b32 v99, a3
    v_accvgpr_read_b32 v100, a4
    v_accvgpr_read_b32 v101, a5
    v_accvgpr_read_b32 v102, a6
    v_accvgpr_read_b32 v103, a7
    v_accvgpr_read_b32 v104, a8
    v_accvgpr_read_b32 v105, a9
    v_accvgpr_read_b32 v106, a10
    v_accvgpr_read_b32 v107, a11
    v_accvgpr_read_b32 v108, a12
    v_accvgpr_read_b32 v109, a13
    v_accvgpr_read_b32 v110, a14
    v_accvgpr_read_b32 v111, a15
    ds_write_b128 v10, v[96:99] offset:0
    ds_write_b128 v10, v[100:103] offset:1024
    ds_write_b128 v10, v[104:107] offset:2048
    ds_write_b128 v10, v[108:111] offset:3072
    v_accvgpr_read_b32 v112, a16
    v_accvgpr_read_b32 v113, a17
    v_accvgpr_read_b32 v114, a18
    v_accvgpr_read_b32 v115, a19
    v_accvgpr_read_b32 v116, a20
    v_accvgpr_read_b32 v117, a21
    v_accvgpr_read_b32 v118, a22
    v_accvgpr_read_b32 v119, a23
    v_accvgpr_read_b32 v120, a24
    v_accvgpr_read_b32 v121, a25
    v_accvgpr_read_b32 v122, a26
    v_accvgpr_read_b32 v123, a27
    v_accvgpr_read_b32 v124, a28
    v_accvgpr_read_b32 v125, a29
    v_accvgpr_read_b32 v126, a30
    v_accvgpr_read_b32 v127, a31
    ds_write_b128 v10, v[112:115] offset:4096
    ds_write_b128 v10, v[116:119] offset:5120
    ds_write_b128 v10, v[120:123] offset:6144
    ds_write_b128 v10, v[124:127] offset:7168
    v_accvgpr_read_b32 v96, a32
    v_accvgpr_read_b32 v97, a33
    v_accvgpr_read_b32 v98, a34
    v_accvgpr_read_b32 v99, a35
    v_accvgpr_read_b32 v100, a36
    v_accvgpr_read_b32 v101, a37
    v_accvgpr_read_b32 v102, a38
    v_accvgpr_read_b32 v103, a39
    v_accvgpr_read_b32 v104, a40
    v_accvgpr_read_b32 v105, a41
    v_accvgpr_read_b32 v106, a42
    v_accvgpr_read_b32 v107, a43
    v_accvgpr_read_b32 v108, a44
    v_accvgpr_read_b32 v109, a45
    v_accvgpr_read_b32 v110, a46
    v_accvgpr_read_b32 v111, a47
    ds_write_b128 v10, v[96:99] offset:8192
    ds_write_b128 v10, v[100:103] offset:9216
    ds_write_b128 v10, v[104:107] offset:10240
    ds_write_b128 v10, v[108:111] offset:11264
    v_accvgpr_read_b32 v112, a48
    v_accvgpr_read_b32 v113, a49
    v_accvgpr_read_b32 v114, a50
    v_accvgpr_read_b32 v115, a51
    v_accvgpr_read_b32 v116, a52
    v_accvgpr_read_b32 v117, a53
    v_accvgpr_read_b32 v118, a54
    v_accvgpr_read_b32 v119, a55
    v_accvgpr_read_b32 v120, a56
    v_accvgpr_read_b32 v121, a57
    v_accvgpr_read_b32 v122, a58
    v_accvgpr_read_b32 v123, a59
    v_accvgpr_read_b32 v124, a60
    v_accvgpr_read_b32 v125, a61
    v_accvgpr_read_b32 v126, a62
    v_accvgpr_read_b32 v127, a63
    ds_write_b128 v10, v[112:115] offset:12288
    ds_write_b128 v10, v[116:119] offset:13312
    ds_write_b128 v10, v[120:123] offset:14336
    ds_write_b128 v10, v[124:127] offset:15360
    s_waitcnt lgkmcnt(0)
    s_barrier
    s_lshl_b32 s12, s3, 12
    v_add_u32 v10, s12, v6
    ds_read_b128 v[96:99], v10 offset:0
    ds_read_b128 v[100:103], v10 offset:1024
    ds_read_b128 v[104:107], v10 offset:2048
    ds_read_b128 v[108:111], v10 offset:3072
    ds_read_b128 v[112:115], v10 offset:16384
    ds_read_b128 v[116:119], v10 offset:17408
    ds_read_b128 v[120:123], v10 offset:18432
    ds_read_b128 v[124:127], v10 offset:19456
    ds_read_b128 v[128:131], v10 offset:32768
    ds_read_b128 v[132:135], v10 offset:33792
    ds_read_b128 v[136:139], v10 offset:34816
    ds_read_b128 v[140:143], v10 offset:35840
    ds_read_b128 v[144:147], v10 offset:49152
    ds_read_b128 v[148:151], v10 offset:50176
    ds_read_b128 v[152:155], v10 offset:51200
    ds_read_b128 v[156:159], v10 offset:52224
    v_accvgpr_read_b32 v32, a72
    v_accvgpr_read_b32 v33, a73
    v_accvgpr_read_b32 v34, a74
    v_accvgpr_read_b32 v35, a75
    v_accvgpr_read_b32 v36, a76
    v_accvgpr_read_b32 v37, a77
    v_accvgpr_read_b32 v38, a78
    v_accvgpr_read_b32 v39, a79
    v_accvgpr_read_b32 v40, a80
    v_accvgpr_read_b32 v41, a81
    v_accvgpr_read_b32 v42, a82
    v_accvgpr_read_b32 v43, a83
    v_accvgpr_read_b32 v44, a84
    v_accvgpr_read_b32 v45, a85
    v_accvgpr_read_b32 v46, a86
    v_accvgpr_read_b32 v47, a87
    v_accvgpr_read_b32 v16, a64
    v_accvgpr_read_b32 v17, a65
    v_accvgpr_read_b32 v18, a66
    v_accvgpr_read_b32 v19, a67
    v_accvgpr_read_b32 v20, a68
    v_accvgpr_read_b32 v21, a69
    v_accvgpr_read_b32 v22, a70
    v_accvgpr_read_b32 v23, a71
    v_lshlrev_b32 v48, 16, v16
    v_and_b32 v49, 0xffff0000, v16
    v_lshlrev_b32 v50, 16, v17
    v_and_b32 v51, 0xffff0000, v17
    v_lshlrev_b32 v52, 16, v18
    v_and_b32 v53, 0xffff0000, v18
    v_lshlrev_b32 v54, 16, v19
    v_and_b32 v55, 0xffff0000, v19
    v_lshlrev_b32 v56, 16, v20
    v_and_b32 v57, 0xffff0000, v20
    v_lshlrev_b32 v58, 16, v21
    v_and_b32 v59, 0xffff0000, v21
    v_lshlrev_b32 v60, 16, v22
    v_and_b32 v61, 0xffff0000, v22
    v_lshlrev_b32 v62, 16, v23
    v_and_b32 v63, 0xffff0000, v23
    s_waitcnt lgkmcnt(0)
    v_add_f32 v96, v96, v112
    v_add_f32 v128, v128, v144
    v_add_f32 v97, v97, v113
    v_add_f32 v129, v129, v145
    v_add_f32 v98, v98, v114
    v_add_f32 v130, v130, v146
    v_add_f32 v99, v99, v115
    v_add_f32 v131, v131, v147
    v_add_f32 v100, v100, v116
    v_add_f32 v132, v132, v148
    v_add_f32 v101, v101, v117
    v_add_f32 v133, v133, v149
    v_add_f32 v102, v102, v118
    v_add_f32 v134, v134, v150
    v_add_f32 v103, v103, v119
    v_add_f32 v135, v135, v151
    v_add_f32 v104, v104, v120
    v_add_f32 v136, v136, v152
    v_add_f32 v105, v105, v121
    v_add_f32 v137, v137, v153
    v_add_f32 v106, v106, v122
    v_add_f32 v138, v138, v154
    v_add_f32 v107, v107, v123
    v_add_f32 v139, v139, v155
    v_add_f32 v108, v108, v124
    v_add_f32 v140, v140, v156
    v_add_f32 v109, v109, v125
    v_add_f32 v141, v141, v157
    v_add_f32 v110, v110, v126
    v_add_f32 v142, v142, v158
    v_add_f32 v111, v111, v127
    v_add_f32 v143, v143, v159
    v_add_f32 v96, v96, v128
    v_add_f32 v97, v97, v129
    v_add_f32 v98, v98, v130
    v_add_f32 v99, v99, v131
    v_add_f32 v100, v100, v132
    v_add_f32 v101, v101, v133
    v_add_f32 v102, v102, v134
    v_add_f32 v103, v103, v135
    v_add_f32 v104, v104, v136
    v_add_f32 v105, v105, v137
    v_add_f32 v106, v106, v138
    v_add_f32 v107, v107, v139
    v_add_f32 v108, v108, v140
    v_add_f32 v109, v109, v141
    v_add_f32 v110, v110, v142
    v_add_f32 v111, v111, v143
    v_cvt_pk_bf16_f32 v96, v96, v96
    v_lshlrev_b32 v96, 16, v96
    v_mul_f32 v96, v96, v32
    v_cvt_pk_bf16_f32 v96, v96, v96
    v_lshlrev_b32 v96, 16, v96
    v_cvt_pk_bf16_f32 v97, v97, v97
    v_lshlrev_b32 v97, 16, v97
    v_mul_f32 v97, v97, v33
    v_cvt_pk_bf16_f32 v97, v97, v97
    v_lshlrev_b32 v97, 16, v97
    v_cvt_pk_bf16_f32 v98, v98, v98
    v_lshlrev_b32 v98, 16, v98
    v_mul_f32 v98, v98, v34
    v_cvt_pk_bf16_f32 v98, v98, v98
    v_lshlrev_b32 v98, 16, v98
    v_cvt_pk_bf16_f32 v99, v99, v99
    v_lshlrev_b32 v99, 16, v99
    v_mul_f32 v99, v99, v35
    v_cvt_pk_bf16_f32 v99, v99, v99
    v_lshlrev_b32 v99, 16, v99
    v_cvt_pk_bf16_f32 v100, v100, v100
    v_lshlrev_b32 v100, 16, v100
    v_mul_f32 v100, v100, v36
    v_cvt_pk_bf16_f32 v100, v100, v100
    v_lshlrev_b32 v100, 16, v100
    v_cvt_pk_bf16_f32 v101, v101, v101
    v_lshlrev_b32 v101, 16, v101
    v_mul_f32 v101, v101, v37
    v_cvt_pk_bf16_f32 v101, v101, v101
    v_lshlrev_b32 v101, 16, v101
    v_cvt_pk_bf16_f32 v102, v102, v102
    v_lshlrev_b32 v102, 16, v102
    v_mul_f32 v102, v102, v38
    v_cvt_pk_bf16_f32 v102, v102, v102
    v_lshlrev_b32 v102, 16, v102
    v_cvt_pk_bf16_f32 v103, v103, v103
    v_lshlrev_b32 v103, 16, v103
    v_mul_f32 v103, v103, v39
    v_cvt_pk_bf16_f32 v103, v103, v103
    v_lshlrev_b32 v103, 16, v103
    v_cvt_pk_bf16_f32 v104, v104, v104
    v_lshlrev_b32 v104, 16, v104
    v_mul_f32 v104, v104, v40
    v_cvt_pk_bf16_f32 v104, v104, v104
    v_lshlrev_b32 v104, 16, v104
    v_cvt_pk_bf16_f32 v105, v105, v105
    v_lshlrev_b32 v105, 16, v105
    v_mul_f32 v105, v105, v41
    v_cvt_pk_bf16_f32 v105, v105, v105
    v_lshlrev_b32 v105, 16, v105
    v_cvt_pk_bf16_f32 v106, v106, v106
    v_lshlrev_b32 v106, 16, v106
    v_mul_f32 v106, v106, v42
    v_cvt_pk_bf16_f32 v106, v106, v106
    v_lshlrev_b32 v106, 16, v106
    v_cvt_pk_bf16_f32 v107, v107, v107
    v_lshlrev_b32 v107, 16, v107
    v_mul_f32 v107, v107, v43
    v_cvt_pk_bf16_f32 v107, v107, v107
    v_lshlrev_b32 v107, 16, v107
    v_cvt_pk_bf16_f32 v108, v108, v108
    v_lshlrev_b32 v108, 16, v108
    v_mul_f32 v108, v108, v44
    v_cvt_pk_bf16_f32 v108, v108, v108
    v_lshlrev_b32 v108, 16, v108
    v_cvt_pk_bf16_f32 v109, v109, v109
    v_lshlrev_b32 v109, 16, v109
    v_mul_f32 v109, v109, v45
    v_cvt_pk_bf16_f32 v109, v109, v109
    v_lshlrev_b32 v109, 16, v109
    v_cvt_pk_bf16_f32 v110, v110, v110
    v_lshlrev_b32 v110, 16, v110
    v_mul_f32 v110, v110, v46
    v_cvt_pk_bf16_f32 v110, v110, v110
    v_lshlrev_b32 v110, 16, v110
    v_cvt_pk_bf16_f32 v111, v111, v111
    v_lshlrev_b32 v111, 16, v111
    v_mul_f32 v111, v111, v47
    v_cvt_pk_bf16_f32 v111, v111, v111
    v_lshlrev_b32 v111, 16, v111
    v_add_f32 v96, v96, v48
    v_add_f32 v97, v97, v49
    v_add_f32 v98, v98, v50
    v_add_f32 v99, v99, v51
    v_add_f32 v100, v100, v52
    v_add_f32 v101, v101, v53
    v_add_f32 v102, v102, v54
    v_add_f32 v103, v103, v55
    v_add_f32 v104, v104, v56
    v_add_f32 v105, v105, v57
    v_add_f32 v106, v106, v58
    v_add_f32 v107, v107, v59
    v_add_f32 v108, v108, v60
    v_add_f32 v109, v109, v61
    v_add_f32 v110, v110, v62
    v_add_f32 v111, v111, v63
    v_cvt_pk_bf16_f32 v16, v96, v97
    v_cvt_pk_bf16_f32 v17, v98, v99
    v_cvt_pk_bf16_f32 v18, v100, v101
    v_cvt_pk_bf16_f32 v19, v102, v103
    v_cvt_pk_bf16_f32 v20, v104, v105
    v_cvt_pk_bf16_f32 v21, v106, v107
    v_cvt_pk_bf16_f32 v22, v108, v109
    v_cvt_pk_bf16_f32 v23, v110, v111
    global_store_dwordx2 v7, v[16:17], s[38:39] offset:0
    global_store_dwordx2 v7, v[18:19], s[38:39] offset:16
    global_store_dwordx2 v7, v[20:21], s[38:39] offset:32
    global_store_dwordx2 v7, v[22:23], s[38:39] offset:48
K6_END:
    s_endpgm
.section .rodata,"a"
.p2align 6
.amdhsa_kernel mod_kernel
  .amdhsa_next_free_vgpr 128
  .amdhsa_next_free_sgpr 102
  .amdhsa_accum_offset 128
  .amdhsa_group_segment_fixed_size 0
  .amdhsa_kernarg_size 112
  .amdhsa_user_sgpr_count 2
  .amdhsa_user_sgpr_kernarg_segment_ptr 1
  .amdhsa_system_sgpr_workgroup_id_x 1
.end_amdhsa_kernel
.p2align 6
.amdhsa_kernel qkv_kernel
  .amdhsa_next_free_vgpr 128
  .amdhsa_next_free_sgpr 102
  .amdhsa_accum_offset 128
  .amdhsa_group_segment_fixed_size 0
  .amdhsa_kernarg_size 112
  .amdhsa_user_sgpr_count 2
  .amdhsa_user_sgpr_kernarg_segment_ptr 1
  .amdhsa_system_sgpr_workgroup_id_x 1
.end_amdhsa_kernel
.p2align 6
.amdhsa_kernel attn_kernel
  .amdhsa_next_free_vgpr 256
  .amdhsa_next_free_sgpr 102
  .amdhsa_accum_offset 256
  .amdhsa_group_segment_fixed_size 0
  .amdhsa_kernarg_size 112
  .amdhsa_user_sgpr_count 2
  .amdhsa_user_sgpr_kernarg_segment_ptr 1
  .amdhsa_system_sgpr_workgroup_id_x 1
.end_amdhsa_kernel
.p2align 6
.amdhsa_kernel ffn1_kernel
  .amdhsa_next_free_vgpr 256
  .amdhsa_next_free_sgpr 102
  .amdhsa_accum_offset 256
  .amdhsa_group_segment_fixed_size 0
  .amdhsa_kernarg_size 112
  .amdhsa_user_sgpr_count 2
  .amdhsa_user_sgpr_kernarg_segment_ptr 1
  .amdhsa_system_sgpr_workgroup_id_x 1
.end_amdhsa_kernel
.p2align 6
.amdhsa_kernel ffn2_kernel
  .amdhsa_next_free_vgpr 344
  .amdhsa_next_free_sgpr 102
  .amdhsa_accum_offset 256
  .amdhsa_group_segment_fixed_size 0
  .amdhsa_kernarg_size 112
  .amdhsa_user_sgpr_count 2
  .amdhsa_user_sgpr_kernarg_segment_ptr 1
  .amdhsa_system_sgpr_workgroup_id_x 1
.end_amdhsa_kernel
```
